```python
import torch

def _softmax(x, axis=-1):
    return torch.softmax(x, dim=axis)
def _gelu(x):
    return torch.nn.functional.gelu(x, approximate="tanh")
def _silu(x):
    return torch.nn.functional.silu(x)
def _sigmoid(x):
    return torch.sigmoid(x)
def _layernorm(x, axis=-1, eps=1e-5):
    m = x.mean(dim=axis, keepdim=True)
    v = x.var(dim=axis, keepdim=True, unbiased=False)
    return (x - m) / torch.sqrt(v + eps)
def _scatter_add(tgt, idx, src, axis=0):
    return tgt.clone().index_add_(axis, idx, src)
def _segment_sum(src, seg, n):
    out = torch.zeros((n,) + src.shape[1:], dtype=src.dtype)
    return out.index_add_(0, seg, src)
def _pad(x, pw):
    flat = tuple(v for pair in reversed(pw) for v in pair)
    return torch.nn.functional.pad(x, flat)

kernel_name = 'gather_scatter__hybrid_graph_tf_nagphormer__graph'

def setup_inputs():

    _w = (lambda a: (lambda t: t.to(torch.bfloat16) if t.is_floating_point() else t)(torch.as_tensor(a)))
    N, deg, D = 25000, 16, 128
    E = N * deg
    src = (lambda lo, hi, *s: torch.randint(lo, hi, s))(0, N, E).to(torch.int64)
    dst = (lambda lo, hi, *s: torch.randint(lo, hi, s))(0, N, E).to(torch.int64)
    deg_cnt = torch.bincount(dst, minlength=N).to(float) + 1.0
    sc = 1.0 / D ** 0.5
    return {
        "x": _w((lambda *s: torch.randn(*s, dtype=torch.bfloat16) * 0.1)(N, D)),
        "src": _w(src),
        "dst": _w(dst),
        "deg_inv_sqrt": _w(1.0 / (lambda _x: torch.sqrt(torch.as_tensor(_x)))(deg_cnt)),
        "wq": _w((lambda *s: torch.randn(*s, dtype=torch.bfloat16) * 1.6)(D, D) * sc),
        "wk": _w((lambda *s: torch.randn(*s, dtype=torch.bfloat16) * 1.6)(D, D) * sc),
        "wv": _w((lambda *s: torch.randn(*s, dtype=torch.bfloat16) * 0.1)(D, D) * sc),
        "wo": _w((lambda *s: torch.randn(*s, dtype=torch.bfloat16) * 0.1)(D, D) * sc),
        "w_r": _w((lambda *s: torch.randn(*s, dtype=torch.bfloat16) * 0.1)(D)),
    }

def reference(x, src, dst, deg_inv_sqrt, wq, wk, wv, wo, w_r):
    N, D = x.shape[0], x.shape[1]
    K = 7
    h = x
    toks = [x]
    for _ in range(K):
        msg = h[src] * deg_inv_sqrt[src, None] * deg_inv_sqrt[dst, None]
        h = _segment_sum(msg, dst, N)
        toks.append(h)
    tok = torch.stack(toks, axis=1)
    t = _layernorm(tok, axis=-1)
    q   = torch.einsum('nkd,de->nke', t, wq)
    key = torch.einsum('nkd,de->nke', t, wk)
    v   = torch.einsum('nkd,de->nke', t, wv)
    scale = 1.0 / (D ** 0.5)
    attn = _softmax(torch.einsum('nkd,nld->nkl', q, key) * scale, axis=-1)
    o = torch.einsum('nkl,nld->nkd', attn, v)
    o = tok + torch.einsum('nkd,de->nke', o, wo)
    r = _layernorm(o, axis=-1)
    alpha = _softmax(torch.einsum('nkd,d->nk', r, w_r), axis=-1)
    return torch.einsum('nk,nkd->nd', alpha, o)
```

```asm
; @launch kernel=prep_kernel grid=(229,1,1) block=(1024,1,1) lds=65536
; @launch kernel=hops_kernel grid=(256,1,1) block=(1024,1,1) lds=161536
; @launch kernel=final_kernel grid=(256,1,1) block=(256,1,1) lds=107264
.amdgcn_target "amdgcn-amd-amdhsa--gfx950"
.text
.globl prep_kernel
.p2align 8
.type prep_kernel,@function
prep_kernel:
  s_cmp_ge_u32 s2, 229
  s_cbranch_scc1 KP_END
  s_load_dwordx2 s[4:5], s[0:1], 88
  v_lshrrev_b32 v2, 6, v0
  v_and_b32 v1, 63, v0
  s_nop 0
  v_readfirstlane_b32 s22, v2
  s_cmp_ge_u32 s2, 131
  s_cbranch_scc1 KP_X
  s_cmp_eq_u32 s2, 128
  s_cbranch_scc1 KP_WM
  s_cmp_eq_u32 s2, 129
  s_cbranch_scc1 KP_WU
  s_cmp_eq_u32 s2, 130
  s_cbranch_scc1 KP_SW
  s_cmp_ge_u32 s2, 100
  s_cbranch_scc1 KP_CSR
  s_load_dwordx4 s[8:11], s[0:1], 8
  s_mul_i32 s3, s2, 16000
  v_lshlrev_b32 v2, 4, v0
  v_add_u32 v2, s3, v2
  v_mov_b32 v3, 0
  v_lshlrev_b32 v4, 2, v0
  v_cmp_gt_u32 vcc, 128, v0
  s_and_saveexec_b64 s[30:31], vcc
  ds_write_b32 v4, v3
  s_mov_b64 exec, s[30:31]
  s_waitcnt lgkmcnt(0)
  s_mov_b32 s12, s8
  s_mov_b32 s13, s9
  s_mov_b32 s14, 1600000
  s_mov_b32 s15, 0x20000
  s_mov_b32 s16, s10
  s_mov_b32 s17, s11
  s_mov_b32 s18, 1600000
  s_mov_b32 s19, 0x20000
  v_cmp_gt_u32 vcc, 1000, v0
  s_and_saveexec_b64 s[30:31], vcc
  s_cbranch_execz KC_C1
  buffer_load_dwordx4 v[8:11], v2, s[16:19], 0 offen
  buffer_load_dwordx4 v[12:15], v2, s[12:15], 0 offen
KC_C1:
  s_mov_b64 exec, s[30:31]
  s_barrier
  s_mov_b32 s20, 21913099
  s_movk_i32 s21, 196
  s_and_saveexec_b64 s[30:31], vcc
  s_cbranch_execz KC_C2
  s_waitcnt vmcnt(1)
  v_mov_b32 v3, 1
  v_mul_hi_u32 v16, v8, s20
  v_mul_lo_u32 v20, v16, s21
  v_sub_u32 v20, v8, v20
  v_lshlrev_b32 v16, 2, v16
  ds_add_rtn_u32 v24, v16, v3
  v_mul_hi_u32 v17, v9, s20
  v_mul_lo_u32 v21, v17, s21
  v_sub_u32 v21, v9, v21
  v_lshlrev_b32 v17, 2, v17
  ds_add_rtn_u32 v25, v17, v3
  v_mul_hi_u32 v18, v10, s20
  v_mul_lo_u32 v22, v18, s21
  v_sub_u32 v22, v10, v22
  v_lshlrev_b32 v18, 2, v18
  ds_add_rtn_u32 v26, v18, v3
  v_mul_hi_u32 v19, v11, s20
  v_mul_lo_u32 v23, v19, s21
  v_sub_u32 v23, v11, v23
  v_lshlrev_b32 v19, 2, v19
  ds_add_rtn_u32 v27, v19, v3
KC_C2:
  s_mov_b64 exec, s[30:31]
  s_waitcnt lgkmcnt(0)
  s_barrier
  s_cmp_lg_u32 s22, 0
  s_cbranch_scc1 KC_C3
  v_lshlrev_b32 v4, 3, v1
  ds_read_b64 v[6:7], v4
  s_waitcnt lgkmcnt(0)
  v_add_u32 v5, v6, v7
  v_mov_b32 v28, v5
  s_nop 1
  v_add_u32_dpp v28, v28, v28 row_shr:1 row_mask:0xf bank_mask:0xf bound_ctrl:0
  s_nop 1
  v_add_u32_dpp v28, v28, v28 row_shr:2 row_mask:0xf bank_mask:0xf bound_ctrl:0
  s_nop 1
  v_add_u32_dpp v28, v28, v28 row_shr:4 row_mask:0xf bank_mask:0xf bound_ctrl:0
  s_nop 1
  v_add_u32_dpp v28, v28, v28 row_shr:8 row_mask:0xf bank_mask:0xf bound_ctrl:0
  s_nop 1
  v_add_u32_dpp v28, v28, v28 row_bcast:15 row_mask:0xa bank_mask:0xf
  s_nop 1
  v_add_u32_dpp v28, v28, v28 row_bcast:31 row_mask:0xc bank_mask:0xf
  v_sub_u32 v28, v28, v5
  v_add_u32 v29, v28, v6
  ds_write_b64 v4, v[28:29] offset:1024
  v_mul_u32_u24 v5, 800, v1
  s_lshl_b32 s3, s2, 2
  s_add_u32 s3, s3, 66611712
  v_add_u32 v5, s3, v5
  global_store_dword v5, v28, s[4:5] sc1
  global_store_dword v5, v29, s[4:5] offset:400 sc1
  v_mov_b32 v6, 4000
  v_mov_b32 v5, s3
  v_add_u32 v5, 51200, v5
  v_cmp_eq_u32 vcc, 0, v1
  s_and_saveexec_b64 s[32:33], vcc
  global_store_dword v5, v6, s[4:5] sc1
  s_mov_b64 exec, s[32:33]
KC_C3:
  s_waitcnt lgkmcnt(0)
  s_barrier
  v_cmp_gt_u32 vcc, 1000, v0
  s_and_saveexec_b64 s[30:31], vcc
  ds_read_b32 v28, v16 offset:1024
  ds_read_b32 v29, v17 offset:1024
  ds_read_b32 v30, v18 offset:1024
  ds_read_b32 v31, v19 offset:1024
  s_waitcnt vmcnt(0) lgkmcnt(0)
  v_add_u32 v28, v28, v24
  v_lshlrev_b32 v28, 2, v28
  v_lshl_or_b32 v12, v20, 16, v12
  ds_write_b32 v28, v12 offset:2048
  v_add_u32 v29, v29, v25
  v_lshlrev_b32 v29, 2, v29
  v_lshl_or_b32 v13, v21, 16, v13
  ds_write_b32 v29, v13 offset:2048
  v_add_u32 v30, v30, v26
  v_lshlrev_b32 v30, 2, v30
  v_lshl_or_b32 v14, v22, 16, v14
  ds_write_b32 v30, v14 offset:2048
  v_add_u32 v31, v31, v27
  v_lshlrev_b32 v31, 2, v31
  v_lshl_or_b32 v15, v23, 16, v15
  ds_write_b32 v31, v15 offset:2048
  s_mov_b64 exec, s[30:31]
  s_waitcnt lgkmcnt(0)
  s_barrier
  s_and_saveexec_b64 s[30:31], vcc
  s_cbranch_execz KC_C4
  v_lshlrev_b32 v4, 4, v0
  ds_read_b128 v[8:11], v4 offset:2048
  s_mul_i32 s3, s2, 16000
  s_add_u32 s3, s3, 65011712
  v_add_u32 v4, s3, v4
  s_waitcnt lgkmcnt(0)
  global_store_dwordx4 v4, v[8:11], s[4:5] sc1
KC_C4:
  s_mov_b64 exec, s[30:31]
  s_waitcnt vmcnt(0)
  s_barrier
  s_load_dwordx2 s[6:7], s[0:1], 80
  s_and_b32 s3, s2, 3
  s_lshl_b32 s3, s3, 5
  v_mov_b32 v4, s3
  v_mov_b32 v5, 1
  s_waitcnt lgkmcnt(0)
  v_cmp_eq_u32 vcc, 0, v0
  s_and_saveexec_b64 s[30:31], vcc
  s_cbranch_execz KC_C5
  global_atomic_add v4, v5, s[6:7] sc1
KC_C5:
  s_mov_b64 exec, s[30:31]
KP_CSR:
  s_load_dwordx2 s[6:7], s[0:1], 80
  s_waitcnt lgkmcnt(0)
  s_cmp_lg_u32 s22, 0
  s_cbranch_scc1 KP_W1
  s_cmp_lg_u32 s2, 100
  s_cbranch_scc1 KP_W2
  v_and_b32 v4, 3, v1
  v_lshlrev_b32 v4, 5, v4
KP_W0:
  global_load_dword v5, v4, s[6:7] sc1
  s_waitcnt vmcnt(0)
  v_cmp_gt_u32 vcc, 25, v5
  s_cbranch_vccnz KP_W0
  v_mov_b32 v4, 128
  v_mov_b32 v5, 1
  v_cmp_eq_u32 vcc, 0, v1
  s_and_saveexec_b64 s[30:31], vcc
  global_store_dword v4, v5, s[6:7] sc1
  s_mov_b64 exec, s[30:31]
  s_branch KP_W1
KP_W2:
  v_mov_b32 v4, 128
KP_W3:
  global_load_dword v5, v4, s[6:7] sc1
  s_waitcnt vmcnt(0)
  v_cmp_eq_u32 vcc, 0, v5
  s_cbranch_vccnz KP_W3
KP_W1:
  s_barrier
  v_mov_b32 v3, 0
  v_lshlrev_b32 v4, 2, v0
  v_cmp_gt_u32 vcc, 640, v0
  s_and_saveexec_b64 s[30:31], vcc
  ds_write_b32 v4, v3 offset:0
  ds_write_b32 v4, v3 offset:2560
  ds_write_b32 v4, v3 offset:5120
  s_mov_b64 exec, s[30:31]
  s_waitcnt lgkmcnt(0)
  s_add_u32 s8, s4, 66611712
  s_addc_u32 s9, s5, 0
  s_mov_b32 s10, 51600
  s_mov_b32 s11, 0x20000
  s_add_u32 s12, s4, 65011712
  s_addc_u32 s13, s5, 0
  s_mov_b32 s14, 1600000
  s_mov_b32 s15, 0x20000
  s_add_u32 s16, s4, 66677248
  s_addc_u32 s17, s5, 0
  s_mov_b32 s18, 1048576
  s_mov_b32 s19, 0x20000
  s_mul_i32 s3, s2, 400
  v_lshlrev_b32 v5, 4, v1
  v_add_u32 v5, s22, v5
  v_cmp_gt_u32 vcc, 100, v5
  v_cmp_gt_u32 s[32:33], 7, v1
  s_and_b64 vcc, vcc, s[32:33]
  v_lshlrev_b32 v6, 2, v5
  v_add_u32 v6, s3, v6
  v_mov_b32 v7, 0x7ffffff0
  s_nop 0
  v_cndmask_b32 v6, v7, v6, vcc
  buffer_load_dword v8, v6, s[8:11], 0 offen sc1
  buffer_load_dword v9, v6, s[8:11], 0 offen offset:400 sc1
  v_lshlrev_b32 v10, 2, v1
  v_add_u32 v10, s3, v10
  buffer_load_dword v11, v10, s[8:11], 0 offen sc1
  v_cmp_gt_u32 s[34:35], 36, v1
  v_add_u32 v12, 256, v10
  s_nop 0
  v_cndmask_b32 v12, v7, v12, s[34:35]
  buffer_load_dword v12, v12, s[8:11], 0 offen sc1
  s_waitcnt vmcnt(2)
  v_sub_u32 v9, v9, v8
  v_mul_u32_u24 v5, 4000, v5
  v_add_u32 v8, v8, v5
  s_nop 0
  v_readlane_b32 s40, v8, 0
  v_readlane_b32 s48, v9, 0
  v_readlane_b32 s41, v8, 1
  v_readlane_b32 s49, v9, 1
  v_readlane_b32 s42, v8, 2
  v_readlane_b32 s50, v9, 2
  v_readlane_b32 s43, v8, 3
  v_readlane_b32 s51, v9, 3
  v_readlane_b32 s44, v8, 4
  v_readlane_b32 s52, v9, 4
  v_readlane_b32 s45, v8, 5
  v_readlane_b32 s53, v9, 5
  v_readlane_b32 s46, v8, 6
  v_readlane_b32 s54, v9, 6
  v_add_u32 v13, s40, v1
  v_lshlrev_b32 v13, 2, v13
  v_cmp_gt_u32 vcc, s48, v1
  s_nop 1
  v_cndmask_b32 v13, v7, v13, vcc
  buffer_load_dword v16, v13, s[12:15], 0 offen sc1
  v_add_u32 v13, s41, v1
  v_lshlrev_b32 v13, 2, v13
  v_cmp_gt_u32 vcc, s49, v1
  s_nop 1
  v_cndmask_b32 v13, v7, v13, vcc
  buffer_load_dword v17, v13, s[12:15], 0 offen sc1
  v_add_u32 v13, s42, v1
  v_lshlrev_b32 v13, 2, v13
  v_cmp_gt_u32 vcc, s50, v1
  s_nop 1
  v_cndmask_b32 v13, v7, v13, vcc
  buffer_load_dword v18, v13, s[12:15], 0 offen sc1
  v_add_u32 v13, s43, v1
  v_lshlrev_b32 v13, 2, v13
  v_cmp_gt_u32 vcc, s51, v1
  s_nop 1
  v_cndmask_b32 v13, v7, v13, vcc
  buffer_load_dword v19, v13, s[12:15], 0 offen sc1
  v_add_u32 v13, s44, v1
  v_lshlrev_b32 v13, 2, v13
  v_cmp_gt_u32 vcc, s52, v1
  s_nop 1
  v_cndmask_b32 v13, v7, v13, vcc
  buffer_load_dword v20, v13, s[12:15], 0 offen sc1
  v_add_u32 v13, s45, v1
  v_lshlrev_b32 v13, 2, v13
  v_cmp_gt_u32 vcc, s53, v1
  s_nop 1
  v_cndmask_b32 v13, v7, v13, vcc
  buffer_load_dword v21, v13, s[12:15], 0 offen sc1
  v_add_u32 v13, s46, v1
  v_lshlrev_b32 v13, 2, v13
  v_cmp_gt_u32 vcc, s54, v1
  s_nop 1
  v_cndmask_b32 v13, v7, v13, vcc
  buffer_load_dword v22, v13, s[12:15], 0 offen sc1
  s_waitcnt vmcnt(7)
  v_add_u32 v11, v11, v12
  s_nop 1
  v_add_u32_dpp v11, v11, v11 row_shr:1 row_mask:0xf bank_mask:0xf bound_ctrl:0
  s_nop 1
  v_add_u32_dpp v11, v11, v11 row_shr:2 row_mask:0xf bank_mask:0xf bound_ctrl:0
  s_nop 1
  v_add_u32_dpp v11, v11, v11 row_shr:4 row_mask:0xf bank_mask:0xf bound_ctrl:0
  s_nop 1
  v_add_u32_dpp v11, v11, v11 row_shr:8 row_mask:0xf bank_mask:0xf bound_ctrl:0
  s_nop 1
  v_add_u32_dpp v11, v11, v11 row_bcast:15 row_mask:0xa bank_mask:0xf
  s_nop 1
  v_add_u32_dpp v11, v11, v11 row_bcast:31 row_mask:0xc bank_mask:0xf
  s_nop 1
  v_readlane_b32 s24, v11, 63
  s_barrier
  v_mov_b32 v3, 1
  s_movk_i32 s27, 15104
  s_movk_i32 s28, 5120
  s_waitcnt vmcnt(6)
  v_lshrrev_b32 v24, 16, v16
  v_and_b32 v40, 0xffff, v16
  v_cmp_le_u32 vcc, s28, v40
  v_cmp_le_u32 s[36:37], s27, v40
  v_mul_u32_u24 v24, 3, v24
  v_add_u32 v14, 4864, v40
  v_subrev_u32 v15, 15104, v40
  v_cndmask_b32 v40, v40, v14, vcc
  v_cndmask_b32 v40, v40, v15, s[36:37]
  v_addc_co_u32 v24, vcc, 0, v24, vcc
  v_addc_co_u32 v24, vcc, 0, v24, s[36:37]
  v_lshlrev_b32 v24, 2, v24
  v_cmp_gt_u32 vcc, s48, v1
  s_and_saveexec_b64 s[30:31], vcc
  ds_add_rtn_u32 v32, v24, v3 offset:0
  s_mov_b64 exec, s[30:31]
  s_waitcnt vmcnt(5)
  v_lshrrev_b32 v25, 16, v17
  v_and_b32 v41, 0xffff, v17
  v_cmp_le_u32 vcc, s28, v41
  v_cmp_le_u32 s[36:37], s27, v41
  v_mul_u32_u24 v25, 3, v25
  v_add_u32 v14, 4864, v41
  v_subrev_u32 v15, 15104, v41
  v_cndmask_b32 v41, v41, v14, vcc
  v_cndmask_b32 v41, v41, v15, s[36:37]
  v_addc_co_u32 v25, vcc, 0, v25, vcc
  v_addc_co_u32 v25, vcc, 0, v25, s[36:37]
  v_lshlrev_b32 v25, 2, v25
  v_cmp_gt_u32 vcc, s49, v1
  s_and_saveexec_b64 s[30:31], vcc
  ds_add_rtn_u32 v33, v25, v3 offset:0
  s_mov_b64 exec, s[30:31]
  s_waitcnt vmcnt(4)
  v_lshrrev_b32 v26, 16, v18
  v_and_b32 v42, 0xffff, v18
  v_cmp_le_u32 vcc, s28, v42
  v_cmp_le_u32 s[36:37], s27, v42
  v_mul_u32_u24 v26, 3, v26
  v_add_u32 v14, 4864, v42
  v_subrev_u32 v15, 15104, v42
  v_cndmask_b32 v42, v42, v14, vcc
  v_cndmask_b32 v42, v42, v15, s[36:37]
  v_addc_co_u32 v26, vcc, 0, v26, vcc
  v_addc_co_u32 v26, vcc, 0, v26, s[36:37]
  v_lshlrev_b32 v26, 2, v26
  v_cmp_gt_u32 vcc, s50, v1
  s_and_saveexec_b64 s[30:31], vcc
  ds_add_rtn_u32 v34, v26, v3 offset:0
  s_mov_b64 exec, s[30:31]
  s_waitcnt vmcnt(3)
  v_lshrrev_b32 v27, 16, v19
  v_and_b32 v43, 0xffff, v19
  v_cmp_le_u32 vcc, s28, v43
  v_cmp_le_u32 s[36:37], s27, v43
  v_mul_u32_u24 v27, 3, v27
  v_add_u32 v14, 4864, v43
  v_subrev_u32 v15, 15104, v43
  v_cndmask_b32 v43, v43, v14, vcc
  v_cndmask_b32 v43, v43, v15, s[36:37]
  v_addc_co_u32 v27, vcc, 0, v27, vcc
  v_addc_co_u32 v27, vcc, 0, v27, s[36:37]
  v_lshlrev_b32 v27, 2, v27
  v_cmp_gt_u32 vcc, s51, v1
  s_and_saveexec_b64 s[30:31], vcc
  ds_add_rtn_u32 v35, v27, v3 offset:0
  s_mov_b64 exec, s[30:31]
  s_waitcnt vmcnt(2)
  v_lshrrev_b32 v28, 16, v20
  v_and_b32 v44, 0xffff, v20
  v_cmp_le_u32 vcc, s28, v44
  v_cmp_le_u32 s[36:37], s27, v44
  v_mul_u32_u24 v28, 3, v28
  v_add_u32 v14, 4864, v44
  v_subrev_u32 v15, 15104, v44
  v_cndmask_b32 v44, v44, v14, vcc
  v_cndmask_b32 v44, v44, v15, s[36:37]
  v_addc_co_u32 v28, vcc, 0, v28, vcc
  v_addc_co_u32 v28, vcc, 0, v28, s[36:37]
  v_lshlrev_b32 v28, 2, v28
  v_cmp_gt_u32 vcc, s52, v1
  s_and_saveexec_b64 s[30:31], vcc
  ds_add_rtn_u32 v36, v28, v3 offset:0
  s_mov_b64 exec, s[30:31]
  s_waitcnt vmcnt(1)
  v_lshrrev_b32 v29, 16, v21
  v_and_b32 v45, 0xffff, v21
  v_cmp_le_u32 vcc, s28, v45
  v_cmp_le_u32 s[36:37], s27, v45
  v_mul_u32_u24 v29, 3, v29
  v_add_u32 v14, 4864, v45
  v_subrev_u32 v15, 15104, v45
  v_cndmask_b32 v45, v45, v14, vcc
  v_cndmask_b32 v45, v45, v15, s[36:37]
  v_addc_co_u32 v29, vcc, 0, v29, vcc
  v_addc_co_u32 v29, vcc, 0, v29, s[36:37]
  v_lshlrev_b32 v29, 2, v29
  v_cmp_gt_u32 vcc, s53, v1
  s_and_saveexec_b64 s[30:31], vcc
  ds_add_rtn_u32 v37, v29, v3 offset:0
  s_mov_b64 exec, s[30:31]
  s_waitcnt vmcnt(0)
  v_lshrrev_b32 v30, 16, v22
  v_and_b32 v46, 0xffff, v22
  v_cmp_le_u32 vcc, s28, v46
  v_cmp_le_u32 s[36:37], s27, v46
  v_mul_u32_u24 v30, 3, v30
  v_add_u32 v14, 4864, v46
  v_subrev_u32 v15, 15104, v46
  v_cndmask_b32 v46, v46, v14, vcc
  v_cndmask_b32 v46, v46, v15, s[36:37]
  v_addc_co_u32 v30, vcc, 0, v30, vcc
  v_addc_co_u32 v30, vcc, 0, v30, s[36:37]
  v_lshlrev_b32 v30, 2, v30
  v_cmp_gt_u32 vcc, s54, v1
  s_and_saveexec_b64 s[30:31], vcc
  ds_add_rtn_u32 v38, v30, v3 offset:0
  s_mov_b64 exec, s[30:31]
  s_cmp_le_u32 s48, 64
  s_cbranch_scc1 KPRX_2
  s_mov_b32 s25, 64
KPRM_1:
  v_add_u32 v13, s25, v1
  v_cmp_gt_u32 vcc, s48, v13
  s_and_saveexec_b64 s[30:31], vcc
  s_cbranch_execz KPRM_1_s
  v_add_u32 v13, s40, v13
  v_lshlrev_b32 v13, 2, v13
  buffer_load_dword v48, v13, s[12:15], 0 offen sc1
  s_waitcnt vmcnt(0)
  v_lshrrev_b32 v49, 16, v48
  v_and_b32 v50, 0xffff, v48
  v_cmp_le_u32 vcc, s28, v50
  v_cmp_le_u32 s[36:37], s27, v50
  v_mul_u32_u24 v49, 3, v49
  v_add_u32 v14, 4864, v50
  v_subrev_u32 v15, 15104, v50
  v_cndmask_b32 v50, v50, v14, vcc
  v_cndmask_b32 v50, v50, v15, s[36:37]
  v_addc_co_u32 v49, vcc, 0, v49, vcc
  v_addc_co_u32 v49, vcc, 0, v49, s[36:37]
  v_lshlrev_b32 v49, 2, v49
  ds_add_u32 v49, v3 offset:2560
KPRM_1_s:
  s_mov_b64 exec, s[30:31]
  s_add_u32 s25, s25, 64
  s_cmp_lt_u32 s25, s48
  s_cbranch_scc1 KPRM_1
KPRX_2:
  s_cmp_le_u32 s49, 64
  s_cbranch_scc1 KPRX_4
  s_mov_b32 s25, 64
KPRM_3:
  v_add_u32 v13, s25, v1
  v_cmp_gt_u32 vcc, s49, v13
  s_and_saveexec_b64 s[30:31], vcc
  s_cbranch_execz KPRM_3_s
  v_add_u32 v13, s41, v13
  v_lshlrev_b32 v13, 2, v13
  buffer_load_dword v48, v13, s[12:15], 0 offen sc1
  s_waitcnt vmcnt(0)
  v_lshrrev_b32 v49, 16, v48
  v_and_b32 v50, 0xffff, v48
  v_cmp_le_u32 vcc, s28, v50
  v_cmp_le_u32 s[36:37], s27, v50
  v_mul_u32_u24 v49, 3, v49
  v_add_u32 v14, 4864, v50
  v_subrev_u32 v15, 15104, v50
  v_cndmask_b32 v50, v50, v14, vcc
  v_cndmask_b32 v50, v50, v15, s[36:37]
  v_addc_co_u32 v49, vcc, 0, v49, vcc
  v_addc_co_u32 v49, vcc, 0, v49, s[36:37]
  v_lshlrev_b32 v49, 2, v49
  ds_add_u32 v49, v3 offset:2560
KPRM_3_s:
  s_mov_b64 exec, s[30:31]
  s_add_u32 s25, s25, 64
  s_cmp_lt_u32 s25, s49
  s_cbranch_scc1 KPRM_3
KPRX_4:
  s_cmp_le_u32 s50, 64
  s_cbranch_scc1 KPRX_6
  s_mov_b32 s25, 64
KPRM_5:
  v_add_u32 v13, s25, v1
  v_cmp_gt_u32 vcc, s50, v13
  s_and_saveexec_b64 s[30:31], vcc
  s_cbranch_execz KPRM_5_s
  v_add_u32 v13, s42, v13
  v_lshlrev_b32 v13, 2, v13
  buffer_load_dword v48, v13, s[12:15], 0 offen sc1
  s_waitcnt vmcnt(0)
  v_lshrrev_b32 v49, 16, v48
  v_and_b32 v50, 0xffff, v48
  v_cmp_le_u32 vcc, s28, v50
  v_cmp_le_u32 s[36:37], s27, v50
  v_mul_u32_u24 v49, 3, v49
  v_add_u32 v14, 4864, v50
  v_subrev_u32 v15, 15104, v50
  v_cndmask_b32 v50, v50, v14, vcc
  v_cndmask_b32 v50, v50, v15, s[36:37]
  v_addc_co_u32 v49, vcc, 0, v49, vcc
  v_addc_co_u32 v49, vcc, 0, v49, s[36:37]
  v_lshlrev_b32 v49, 2, v49
  ds_add_u32 v49, v3 offset:2560
KPRM_5_s:
  s_mov_b64 exec, s[30:31]
  s_add_u32 s25, s25, 64
  s_cmp_lt_u32 s25, s50
  s_cbranch_scc1 KPRM_5
KPRX_6:
  s_cmp_le_u32 s51, 64
  s_cbranch_scc1 KPRX_8
  s_mov_b32 s25, 64
KPRM_7:
  v_add_u32 v13, s25, v1
  v_cmp_gt_u32 vcc, s51, v13
  s_and_saveexec_b64 s[30:31], vcc
  s_cbranch_execz KPRM_7_s
  v_add_u32 v13, s43, v13
  v_lshlrev_b32 v13, 2, v13
  buffer_load_dword v48, v13, s[12:15], 0 offen sc1
  s_waitcnt vmcnt(0)
  v_lshrrev_b32 v49, 16, v48
  v_and_b32 v50, 0xffff, v48
  v_cmp_le_u32 vcc, s28, v50
  v_cmp_le_u32 s[36:37], s27, v50
  v_mul_u32_u24 v49, 3, v49
  v_add_u32 v14, 4864, v50
  v_subrev_u32 v15, 15104, v50
  v_cndmask_b32 v50, v50, v14, vcc
  v_cndmask_b32 v50, v50, v15, s[36:37]
  v_addc_co_u32 v49, vcc, 0, v49, vcc
  v_addc_co_u32 v49, vcc, 0, v49, s[36:37]
  v_lshlrev_b32 v49, 2, v49
  ds_add_u32 v49, v3 offset:2560
KPRM_7_s:
  s_mov_b64 exec, s[30:31]
  s_add_u32 s25, s25, 64
  s_cmp_lt_u32 s25, s51
  s_cbranch_scc1 KPRM_7
KPRX_8:
  s_cmp_le_u32 s52, 64
  s_cbranch_scc1 KPRX_10
  s_mov_b32 s25, 64
KPRM_9:
  v_add_u32 v13, s25, v1
  v_cmp_gt_u32 vcc, s52, v13
  s_and_saveexec_b64 s[30:31], vcc
  s_cbranch_execz KPRM_9_s
  v_add_u32 v13, s44, v13
  v_lshlrev_b32 v13, 2, v13
  buffer_load_dword v48, v13, s[12:15], 0 offen sc1
  s_waitcnt vmcnt(0)
  v_lshrrev_b32 v49, 16, v48
  v_and_b32 v50, 0xffff, v48
  v_cmp_le_u32 vcc, s28, v50
  v_cmp_le_u32 s[36:37], s27, v50
  v_mul_u32_u24 v49, 3, v49
  v_add_u32 v14, 4864, v50
  v_subrev_u32 v15, 15104, v50
  v_cndmask_b32 v50, v50, v14, vcc
  v_cndmask_b32 v50, v50, v15, s[36:37]
  v_addc_co_u32 v49, vcc, 0, v49, vcc
  v_addc_co_u32 v49, vcc, 0, v49, s[36:37]
  v_lshlrev_b32 v49, 2, v49
  ds_add_u32 v49, v3 offset:2560
KPRM_9_s:
  s_mov_b64 exec, s[30:31]
  s_add_u32 s25, s25, 64
  s_cmp_lt_u32 s25, s52
  s_cbranch_scc1 KPRM_9
KPRX_10:
  s_cmp_le_u32 s53, 64
  s_cbranch_scc1 KPRX_12
  s_mov_b32 s25, 64
KPRM_11:
  v_add_u32 v13, s25, v1
  v_cmp_gt_u32 vcc, s53, v13
  s_and_saveexec_b64 s[30:31], vcc
  s_cbranch_execz KPRM_11_s
  v_add_u32 v13, s45, v13
  v_lshlrev_b32 v13, 2, v13
  buffer_load_dword v48, v13, s[12:15], 0 offen sc1
  s_waitcnt vmcnt(0)
  v_lshrrev_b32 v49, 16, v48
  v_and_b32 v50, 0xffff, v48
  v_cmp_le_u32 vcc, s28, v50
  v_cmp_le_u32 s[36:37], s27, v50
  v_mul_u32_u24 v49, 3, v49
  v_add_u32 v14, 4864, v50
  v_subrev_u32 v15, 15104, v50
  v_cndmask_b32 v50, v50, v14, vcc
  v_cndmask_b32 v50, v50, v15, s[36:37]
  v_addc_co_u32 v49, vcc, 0, v49, vcc
  v_addc_co_u32 v49, vcc, 0, v49, s[36:37]
  v_lshlrev_b32 v49, 2, v49
  ds_add_u32 v49, v3 offset:2560
KPRM_11_s:
  s_mov_b64 exec, s[30:31]
  s_add_u32 s25, s25, 64
  s_cmp_lt_u32 s25, s53
  s_cbranch_scc1 KPRM_11
KPRX_12:
  s_cmp_le_u32 s54, 64
  s_cbranch_scc1 KPRX_14
  s_mov_b32 s25, 64
KPRM_13:
  v_add_u32 v13, s25, v1
  v_cmp_gt_u32 vcc, s54, v13
  s_and_saveexec_b64 s[30:31], vcc
  s_cbranch_execz KPRM_13_s
  v_add_u32 v13, s46, v13
  v_lshlrev_b32 v13, 2, v13
  buffer_load_dword v48, v13, s[12:15], 0 offen sc1
  s_waitcnt vmcnt(0)
  v_lshrrev_b32 v49, 16, v48
  v_and_b32 v50, 0xffff, v48
  v_cmp_le_u32 vcc, s28, v50
  v_cmp_le_u32 s[36:37], s27, v50
  v_mul_u32_u24 v49, 3, v49
  v_add_u32 v14, 4864, v50
  v_subrev_u32 v15, 15104, v50
  v_cndmask_b32 v50, v50, v14, vcc
  v_cndmask_b32 v50, v50, v15, s[36:37]
  v_addc_co_u32 v49, vcc, 0, v49, vcc
  v_addc_co_u32 v49, vcc, 0, v49, s[36:37]
  v_lshlrev_b32 v49, 2, v49
  ds_add_u32 v49, v3 offset:2560
KPRM_13_s:
  s_mov_b64 exec, s[30:31]
  s_add_u32 s25, s25, 64
  s_cmp_lt_u32 s25, s54
  s_cbranch_scc1 KPRM_13
KPRX_14:
  s_waitcnt lgkmcnt(0)
  s_barrier
  s_cmp_ge_u32 s22, 4
  s_cbranch_scc1 KP_N1
  v_mul_u32_u24 v4, 12, v0
  ds_read_b32 v48, v4 offset:0
  ds_read_b32 v49, v4 offset:4
  ds_read_b32 v50, v4 offset:8
  ds_read_b32 v51, v4 offset:2560
  ds_read_b32 v52, v4 offset:2564
  ds_read_b32 v53, v4 offset:2568
  v_cmp_gt_u32 vcc, 196, v0
  s_waitcnt lgkmcnt(0)
  v_add_u32 v48, v48, v51
  v_cndmask_b32 v48, 0, v48, vcc
  v_add_u32 v54, 1, v48
  v_and_b32 v54, -2, v54
  v_add_u32 v49, v49, v52
  v_cndmask_b32 v49, 0, v49, vcc
  v_add_u32 v55, 1, v49
  v_and_b32 v55, -2, v55
  v_add_u32 v50, v50, v53
  v_cndmask_b32 v50, 0, v50, vcc
  v_add_u32 v56, 1, v50
  v_and_b32 v56, -2, v56
  v_add3_u32 v57, v54, v55, v56
  v_mov_b32 v58, v57
  s_nop 1
  v_add_u32_dpp v58, v58, v58 row_shr:1 row_mask:0xf bank_mask:0xf bound_ctrl:0
  s_nop 1
  v_add_u32_dpp v58, v58, v58 row_shr:2 row_mask:0xf bank_mask:0xf bound_ctrl:0
  s_nop 1
  v_add_u32_dpp v58, v58, v58 row_shr:4 row_mask:0xf bank_mask:0xf bound_ctrl:0
  s_nop 1
  v_add_u32_dpp v58, v58, v58 row_shr:8 row_mask:0xf bank_mask:0xf bound_ctrl:0
  s_nop 1
  v_add_u32_dpp v58, v58, v58 row_bcast:15 row_mask:0xa bank_mask:0xf
  s_nop 1
  v_add_u32_dpp v58, v58, v58 row_bcast:31 row_mask:0xc bank_mask:0xf
  s_nop 1
  v_readlane_b32 s3, v58, 63
  s_lshl_b32 s25, s22, 2
  v_mov_b32 v59, s25
  v_mov_b32 v60, s3
  ds_write_b32 v59, v60 offset:10240
KP_N1:
  s_waitcnt lgkmcnt(0)
  s_barrier
  s_cmp_ge_u32 s22, 4
  s_cbranch_scc1 KP_P2
  v_mov_b32 v59, 0
  ds_read_b128 v[60:63], v59 offset:10240
  v_sub_u32 v58, v58, v57
  s_mul_i32 s3, s2, 590
  s_add_u32 s3, s3, s24
  s_add_u32 s3, s3, 1
  s_and_b32 s26, s3, -2
  s_waitcnt lgkmcnt(0)
  v_readfirstlane_b32 s56, v60
  v_readfirstlane_b32 s57, v61
  v_readfirstlane_b32 s58, v62
  s_cmp_ge_u32 s22, 1
  s_cselect_b32 s56, s56, 0
  s_cmp_ge_u32 s22, 2
  s_cselect_b32 s57, s57, 0
  s_cmp_ge_u32 s22, 3
  s_cselect_b32 s58, s58, 0
  s_add_u32 s26, s26, s56
  s_add_u32 s26, s26, s57
  s_add_u32 s26, s26, s58
  v_add_u32 v64, s26, v58
  v_add_u32 v65, v64, v54
  v_add_u32 v66, v65, v55
  v_add_u32 v67, v66, v56
  v_cmp_eq_u32 vcc, 0, v0
  s_and_saveexec_b64 s[30:31], vcc
  ds_write_b32 v59, v64 offset:10256
  s_mov_b64 exec, s[30:31]
  v_cmp_eq_u32 vcc, 195, v0
  s_and_saveexec_b64 s[30:31], vcc
  ds_write_b32 v59, v67 offset:10260
  s_mov_b64 exec, s[30:31]
  v_cmp_gt_u32 vcc, 196, v0
  s_and_saveexec_b64 s[30:31], vcc
  s_cbranch_execz KP_N2
  ds_write_b32 v4, v64 offset:7680
  ds_write_b32 v4, v65 offset:7684
  ds_write_b32 v4, v66 offset:7688
  s_mul_i32 s3, s2, 3136
  v_lshlrev_b32 v5, 4, v0
  v_add_u32 v5, s3, v5
  v_add_u32 v6, 67725824, v5
  global_store_dwordx4 v6, v[64:67], s[4:5]
  v_lshrrev_b32 v54, 1, v54
  v_lshrrev_b32 v55, 1, v55
  v_lshrrev_b32 v56, 1, v56
  v_or3_b32 v71, v54, v55, v56
  v_lshrrev_b32 v71, 10, v71
  v_mov_b32 v68, v64
  v_lshl_or_b32 v69, v55, 10, v54
  v_lshl_or_b32 v69, v56, 20, v69
  v_min_u32 v55, 7, v55
  v_min_u32 v56, 7, v56
  v_min_u32 v54, 15, v54
  v_and_b32 v72, 1, v55
  v_sub_u32 v73, 7, v56
  v_cmp_eq_u32 vcc, 1, v72
  s_nop 1
  v_cndmask_b32 v56, v56, v73, vcc
  v_lshl_or_b32 v56, v55, 3, v56
  v_and_b32 v72, 1, v56
  v_sub_u32 v73, 15, v54
  v_cmp_eq_u32 vcc, 1, v72
  s_nop 1
  v_cndmask_b32 v54, v54, v73, vcc
  v_lshl_or_b32 v54, v56, 4, v54
  v_lshlrev_b32 v70, 2, v54
  v_add_u32 v6, 69298688, v5
  global_store_dwordx4 v6, v[68:71], s[4:5]
KP_N2:
  s_mov_b64 exec, s[30:31]
KP_P2:
  s_waitcnt lgkmcnt(0)
  s_barrier
  v_mov_b32 v59, 0
  ds_read_b64 v[60:61], v59 offset:10256
  s_waitcnt lgkmcnt(0)
  v_readfirstlane_b32 s26, v60
  v_readfirstlane_b32 s29, v61
  s_sub_u32 s38, s29, s26
  s_lshl_b32 s38, s38, 1
  s_cmp_gt_u32 s38, 16384
  s_cbranch_scc1 KP_DIRECT
  s_lshl_b32 s39, s26, 1
  s_sub_u32 s39, 10496, s39
  v_cmp_gt_u32 vcc, s48, v1
  s_and_saveexec_b64 s[30:31], vcc
  ds_read_b32 v16, v24 offset:7680
  s_mov_b64 exec, s[30:31]
  v_cmp_gt_u32 vcc, s49, v1
  s_and_saveexec_b64 s[30:31], vcc
  ds_read_b32 v17, v25 offset:7680
  s_mov_b64 exec, s[30:31]
  v_cmp_gt_u32 vcc, s50, v1
  s_and_saveexec_b64 s[30:31], vcc
  ds_read_b32 v18, v26 offset:7680
  s_mov_b64 exec, s[30:31]
  v_cmp_gt_u32 vcc, s51, v1
  s_and_saveexec_b64 s[30:31], vcc
  ds_read_b32 v19, v27 offset:7680
  s_mov_b64 exec, s[30:31]
  v_cmp_gt_u32 vcc, s52, v1
  s_and_saveexec_b64 s[30:31], vcc
  ds_read_b32 v20, v28 offset:7680
  s_mov_b64 exec, s[30:31]
  v_cmp_gt_u32 vcc, s53, v1
  s_and_saveexec_b64 s[30:31], vcc
  ds_read_b32 v21, v29 offset:7680
  s_mov_b64 exec, s[30:31]
  v_cmp_gt_u32 vcc, s54, v1
  s_and_saveexec_b64 s[30:31], vcc
  ds_read_b32 v22, v30 offset:7680
  s_mov_b64 exec, s[30:31]
  s_cmp_ge_u32 s22, 4
  s_cbranch_scc1 KP_NP1
  v_cmp_gt_u32 vcc, 196, v0
  s_and_saveexec_b64 s[32:33], vcc
  s_cbranch_execz KP_NP0
  v_mov_b32 v72, 19968
  v_and_b32 v73, 1, v48
  v_cmp_eq_u32 vcc, 1, v73
  v_add_u32 v73, v64, v48
  v_lshlrev_b32 v73, 1, v73
  v_add_u32 v73, s39, v73
  s_and_saveexec_b64 s[30:31], vcc
  ds_write_b16 v73, v72
  s_mov_b64 exec, s[30:31]
  v_and_b32 v73, 1, v49
  v_cmp_eq_u32 vcc, 1, v73
  v_add_u32 v73, v65, v49
  v_lshlrev_b32 v73, 1, v73
  v_add_u32 v73, s39, v73
  s_and_saveexec_b64 s[30:31], vcc
  ds_write_b16 v73, v72
  s_mov_b64 exec, s[30:31]
  v_and_b32 v73, 1, v50
  v_cmp_eq_u32 vcc, 1, v73
  v_add_u32 v73, v66, v50
  v_lshlrev_b32 v73, 1, v73
  v_add_u32 v73, s39, v73
  s_and_saveexec_b64 s[30:31], vcc
  ds_write_b16 v73, v72
  s_mov_b64 exec, s[30:31]
KP_NP0:
  s_mov_b64 exec, s[32:33]
KP_NP1:
  s_waitcnt lgkmcnt(0)
  v_add_u32 v13, v16, v32
  v_lshlrev_b32 v13, 1, v13
  v_add_u32 v13, s39, v13
  v_cmp_gt_u32 vcc, s48, v1
  s_and_saveexec_b64 s[30:31], vcc
  ds_write_b16 v13, v40
  s_mov_b64 exec, s[30:31]
  v_add_u32 v13, v17, v33
  v_lshlrev_b32 v13, 1, v13
  v_add_u32 v13, s39, v13
  v_cmp_gt_u32 vcc, s49, v1
  s_and_saveexec_b64 s[30:31], vcc
  ds_write_b16 v13, v41
  s_mov_b64 exec, s[30:31]
  v_add_u32 v13, v18, v34
  v_lshlrev_b32 v13, 1, v13
  v_add_u32 v13, s39, v13
  v_cmp_gt_u32 vcc, s50, v1
  s_and_saveexec_b64 s[30:31], vcc
  ds_write_b16 v13, v42
  s_mov_b64 exec, s[30:31]
  v_add_u32 v13, v19, v35
  v_lshlrev_b32 v13, 1, v13
  v_add_u32 v13, s39, v13
  v_cmp_gt_u32 vcc, s51, v1
  s_and_saveexec_b64 s[30:31], vcc
  ds_write_b16 v13, v43
  s_mov_b64 exec, s[30:31]
  v_add_u32 v13, v20, v36
  v_lshlrev_b32 v13, 1, v13
  v_add_u32 v13, s39, v13
  v_cmp_gt_u32 vcc, s52, v1
  s_and_saveexec_b64 s[30:31], vcc
  ds_write_b16 v13, v44
  s_mov_b64 exec, s[30:31]
  v_add_u32 v13, v21, v37
  v_lshlrev_b32 v13, 1, v13
  v_add_u32 v13, s39, v13
  v_cmp_gt_u32 vcc, s53, v1
  s_and_saveexec_b64 s[30:31], vcc
  ds_write_b16 v13, v45
  s_mov_b64 exec, s[30:31]
  v_add_u32 v13, v22, v38
  v_lshlrev_b32 v13, 1, v13
  v_add_u32 v13, s39, v13
  v_cmp_gt_u32 vcc, s54, v1
  s_and_saveexec_b64 s[30:31], vcc
  ds_write_b16 v13, v46
  s_mov_b64 exec, s[30:31]
  s_cmp_le_u32 s48, 64
  s_cbranch_scc1 KPRX_16
  s_mov_b32 s25, 64
KPRM_15:
  v_add_u32 v13, s25, v1
  v_cmp_gt_u32 vcc, s48, v13
  s_and_saveexec_b64 s[30:31], vcc
  s_cbranch_execz KPRM_15_s
  v_add_u32 v13, s40, v13
  v_lshlrev_b32 v13, 2, v13
  buffer_load_dword v48, v13, s[12:15], 0 offen sc1
  s_waitcnt vmcnt(0)
  v_lshrrev_b32 v49, 16, v48
  v_and_b32 v50, 0xffff, v48
  v_cmp_le_u32 vcc, s28, v50
  v_cmp_le_u32 s[36:37], s27, v50
  v_mul_u32_u24 v49, 3, v49
  v_add_u32 v14, 4864, v50
  v_subrev_u32 v15, 15104, v50
  v_cndmask_b32 v50, v50, v14, vcc
  v_cndmask_b32 v50, v50, v15, s[36:37]
  v_addc_co_u32 v49, vcc, 0, v49, vcc
  v_addc_co_u32 v49, vcc, 0, v49, s[36:37]
  v_lshlrev_b32 v49, 2, v49
  ds_add_rtn_u32 v51, v49, v3 offset:5120
  ds_read_b32 v52, v49 offset:7680
  ds_read_b32 v53, v49 offset:0
  s_waitcnt lgkmcnt(0)
  v_add3_u32 v51, v51, v52, v53
  v_lshlrev_b32 v51, 1, v51
  v_add_u32 v51, s39, v51
  ds_write_b16 v51, v50
KPRM_15_s:
  s_mov_b64 exec, s[30:31]
  s_add_u32 s25, s25, 64
  s_cmp_lt_u32 s25, s48
  s_cbranch_scc1 KPRM_15
KPRX_16:
  s_cmp_le_u32 s49, 64
  s_cbranch_scc1 KPRX_18
  s_mov_b32 s25, 64
KPRM_17:
  v_add_u32 v13, s25, v1
  v_cmp_gt_u32 vcc, s49, v13
  s_and_saveexec_b64 s[30:31], vcc
  s_cbranch_execz KPRM_17_s
  v_add_u32 v13, s41, v13
  v_lshlrev_b32 v13, 2, v13
  buffer_load_dword v48, v13, s[12:15], 0 offen sc1
  s_waitcnt vmcnt(0)
  v_lshrrev_b32 v49, 16, v48
  v_and_b32 v50, 0xffff, v48
  v_cmp_le_u32 vcc, s28, v50
  v_cmp_le_u32 s[36:37], s27, v50
  v_mul_u32_u24 v49, 3, v49
  v_add_u32 v14, 4864, v50
  v_subrev_u32 v15, 15104, v50
  v_cndmask_b32 v50, v50, v14, vcc
  v_cndmask_b32 v50, v50, v15, s[36:37]
  v_addc_co_u32 v49, vcc, 0, v49, vcc
  v_addc_co_u32 v49, vcc, 0, v49, s[36:37]
  v_lshlrev_b32 v49, 2, v49
  ds_add_rtn_u32 v51, v49, v3 offset:5120
  ds_read_b32 v52, v49 offset:7680
  ds_read_b32 v53, v49 offset:0
  s_waitcnt lgkmcnt(0)
  v_add3_u32 v51, v51, v52, v53
  v_lshlrev_b32 v51, 1, v51
  v_add_u32 v51, s39, v51
  ds_write_b16 v51, v50
KPRM_17_s:
  s_mov_b64 exec, s[30:31]
  s_add_u32 s25, s25, 64
  s_cmp_lt_u32 s25, s49
  s_cbranch_scc1 KPRM_17
KPRX_18:
  s_cmp_le_u32 s50, 64
  s_cbranch_scc1 KPRX_20
  s_mov_b32 s25, 64
KPRM_19:
  v_add_u32 v13, s25, v1
  v_cmp_gt_u32 vcc, s50, v13
  s_and_saveexec_b64 s[30:31], vcc
  s_cbranch_execz KPRM_19_s
  v_add_u32 v13, s42, v13
  v_lshlrev_b32 v13, 2, v13
  buffer_load_dword v48, v13, s[12:15], 0 offen sc1
  s_waitcnt vmcnt(0)
  v_lshrrev_b32 v49, 16, v48
  v_and_b32 v50, 0xffff, v48
  v_cmp_le_u32 vcc, s28, v50
  v_cmp_le_u32 s[36:37], s27, v50
  v_mul_u32_u24 v49, 3, v49
  v_add_u32 v14, 4864, v50
  v_subrev_u32 v15, 15104, v50
  v_cndmask_b32 v50, v50, v14, vcc
  v_cndmask_b32 v50, v50, v15, s[36:37]
  v_addc_co_u32 v49, vcc, 0, v49, vcc
  v_addc_co_u32 v49, vcc, 0, v49, s[36:37]
  v_lshlrev_b32 v49, 2, v49
  ds_add_rtn_u32 v51, v49, v3 offset:5120
  ds_read_b32 v52, v49 offset:7680
  ds_read_b32 v53, v49 offset:0
  s_waitcnt lgkmcnt(0)
  v_add3_u32 v51, v51, v52, v53
  v_lshlrev_b32 v51, 1, v51
  v_add_u32 v51, s39, v51
  ds_write_b16 v51, v50
KPRM_19_s:
  s_mov_b64 exec, s[30:31]
  s_add_u32 s25, s25, 64
  s_cmp_lt_u32 s25, s50
  s_cbranch_scc1 KPRM_19
KPRX_20:
  s_cmp_le_u32 s51, 64
  s_cbranch_scc1 KPRX_22
  s_mov_b32 s25, 64
KPRM_21:
  v_add_u32 v13, s25, v1
  v_cmp_gt_u32 vcc, s51, v13
  s_and_saveexec_b64 s[30:31], vcc
  s_cbranch_execz KPRM_21_s
  v_add_u32 v13, s43, v13
  v_lshlrev_b32 v13, 2, v13
  buffer_load_dword v48, v13, s[12:15], 0 offen sc1
  s_waitcnt vmcnt(0)
  v_lshrrev_b32 v49, 16, v48
  v_and_b32 v50, 0xffff, v48
  v_cmp_le_u32 vcc, s28, v50
  v_cmp_le_u32 s[36:37], s27, v50
  v_mul_u32_u24 v49, 3, v49
  v_add_u32 v14, 4864, v50
  v_subrev_u32 v15, 15104, v50
  v_cndmask_b32 v50, v50, v14, vcc
  v_cndmask_b32 v50, v50, v15, s[36:37]
  v_addc_co_u32 v49, vcc, 0, v49, vcc
  v_addc_co_u32 v49, vcc, 0, v49, s[36:37]
  v_lshlrev_b32 v49, 2, v49
  ds_add_rtn_u32 v51, v49, v3 offset:5120
  ds_read_b32 v52, v49 offset:7680
  ds_read_b32 v53, v49 offset:0
  s_waitcnt lgkmcnt(0)
  v_add3_u32 v51, v51, v52, v53
  v_lshlrev_b32 v51, 1, v51
  v_add_u32 v51, s39, v51
  ds_write_b16 v51, v50
KPRM_21_s:
  s_mov_b64 exec, s[30:31]
  s_add_u32 s25, s25, 64
  s_cmp_lt_u32 s25, s51
  s_cbranch_scc1 KPRM_21
KPRX_22:
  s_cmp_le_u32 s52, 64
  s_cbranch_scc1 KPRX_24
  s_mov_b32 s25, 64
KPRM_23:
  v_add_u32 v13, s25, v1
  v_cmp_gt_u32 vcc, s52, v13
  s_and_saveexec_b64 s[30:31], vcc
  s_cbranch_execz KPRM_23_s
  v_add_u32 v13, s44, v13
  v_lshlrev_b32 v13, 2, v13
  buffer_load_dword v48, v13, s[12:15], 0 offen sc1
  s_waitcnt vmcnt(0)
  v_lshrrev_b32 v49, 16, v48
  v_and_b32 v50, 0xffff, v48
  v_cmp_le_u32 vcc, s28, v50
  v_cmp_le_u32 s[36:37], s27, v50
  v_mul_u32_u24 v49, 3, v49
  v_add_u32 v14, 4864, v50
  v_subrev_u32 v15, 15104, v50
  v_cndmask_b32 v50, v50, v14, vcc
  v_cndmask_b32 v50, v50, v15, s[36:37]
  v_addc_co_u32 v49, vcc, 0, v49, vcc
  v_addc_co_u32 v49, vcc, 0, v49, s[36:37]
  v_lshlrev_b32 v49, 2, v49
  ds_add_rtn_u32 v51, v49, v3 offset:5120
  ds_read_b32 v52, v49 offset:7680
  ds_read_b32 v53, v49 offset:0
  s_waitcnt lgkmcnt(0)
  v_add3_u32 v51, v51, v52, v53
  v_lshlrev_b32 v51, 1, v51
  v_add_u32 v51, s39, v51
  ds_write_b16 v51, v50
KPRM_23_s:
  s_mov_b64 exec, s[30:31]
  s_add_u32 s25, s25, 64
  s_cmp_lt_u32 s25, s52
  s_cbranch_scc1 KPRM_23
KPRX_24:
  s_cmp_le_u32 s53, 64
  s_cbranch_scc1 KPRX_26
  s_mov_b32 s25, 64
KPRM_25:
  v_add_u32 v13, s25, v1
  v_cmp_gt_u32 vcc, s53, v13
  s_and_saveexec_b64 s[30:31], vcc
  s_cbranch_execz KPRM_25_s
  v_add_u32 v13, s45, v13
  v_lshlrev_b32 v13, 2, v13
  buffer_load_dword v48, v13, s[12:15], 0 offen sc1
  s_waitcnt vmcnt(0)
  v_lshrrev_b32 v49, 16, v48
  v_and_b32 v50, 0xffff, v48
  v_cmp_le_u32 vcc, s28, v50
  v_cmp_le_u32 s[36:37], s27, v50
  v_mul_u32_u24 v49, 3, v49
  v_add_u32 v14, 4864, v50
  v_subrev_u32 v15, 15104, v50
  v_cndmask_b32 v50, v50, v14, vcc
  v_cndmask_b32 v50, v50, v15, s[36:37]
  v_addc_co_u32 v49, vcc, 0, v49, vcc
  v_addc_co_u32 v49, vcc, 0, v49, s[36:37]
  v_lshlrev_b32 v49, 2, v49
  ds_add_rtn_u32 v51, v49, v3 offset:5120
  ds_read_b32 v52, v49 offset:7680
  ds_read_b32 v53, v49 offset:0
  s_waitcnt lgkmcnt(0)
  v_add3_u32 v51, v51, v52, v53
  v_lshlrev_b32 v51, 1, v51
  v_add_u32 v51, s39, v51
  ds_write_b16 v51, v50
KPRM_25_s:
  s_mov_b64 exec, s[30:31]
  s_add_u32 s25, s25, 64
  s_cmp_lt_u32 s25, s53
  s_cbranch_scc1 KPRM_25
KPRX_26:
  s_cmp_le_u32 s54, 64
  s_cbranch_scc1 KPRX_28
  s_mov_b32 s25, 64
KPRM_27:
  v_add_u32 v13, s25, v1
  v_cmp_gt_u32 vcc, s54, v13
  s_and_saveexec_b64 s[30:31], vcc
  s_cbranch_execz KPRM_27_s
  v_add_u32 v13, s46, v13
  v_lshlrev_b32 v13, 2, v13
  buffer_load_dword v48, v13, s[12:15], 0 offen sc1
  s_waitcnt vmcnt(0)
  v_lshrrev_b32 v49, 16, v48
  v_and_b32 v50, 0xffff, v48
  v_cmp_le_u32 vcc, s28, v50
  v_cmp_le_u32 s[36:37], s27, v50
  v_mul_u32_u24 v49, 3, v49
  v_add_u32 v14, 4864, v50
  v_subrev_u32 v15, 15104, v50
  v_cndmask_b32 v50, v50, v14, vcc
  v_cndmask_b32 v50, v50, v15, s[36:37]
  v_addc_co_u32 v49, vcc, 0, v49, vcc
  v_addc_co_u32 v49, vcc, 0, v49, s[36:37]
  v_lshlrev_b32 v49, 2, v49
  ds_add_rtn_u32 v51, v49, v3 offset:5120
  ds_read_b32 v52, v49 offset:7680
  ds_read_b32 v53, v49 offset:0
  s_waitcnt lgkmcnt(0)
  v_add3_u32 v51, v51, v52, v53
  v_lshlrev_b32 v51, 1, v51
  v_add_u32 v51, s39, v51
  ds_write_b16 v51, v50
KPRM_27_s:
  s_mov_b64 exec, s[30:31]
  s_add_u32 s25, s25, 64
  s_cmp_lt_u32 s25, s54
  s_cbranch_scc1 KPRM_27
KPRX_28:
  s_waitcnt lgkmcnt(0)
  s_barrier
  v_lshlrev_b32 v4, 4, v0
  v_cmp_gt_u32 vcc, s38, v4
  s_and_saveexec_b64 s[30:31], vcc
  s_cbranch_execz KP_END
  ds_read_b128 v[8:11], v4 offset:10496
  s_lshl_b32 s18, s29, 1
  s_lshl_b32 s3, s26, 1
  s_waitcnt lgkmcnt(0)
  buffer_store_dwordx4 v[8:11], v4, s[16:19], s3 offen
  s_endpgm
KP_DIRECT:
  s_cmp_ge_u32 s22, 4
  s_cbranch_scc1 KP_NQ1
  v_cmp_gt_u32 vcc, 196, v0
  s_and_saveexec_b64 s[32:33], vcc
  s_cbranch_execz KP_NQ0
  v_mov_b32 v72, 19968
  v_mov_b32 v74, 0x7ffffff0
  v_and_b32 v73, 1, v48
  v_cmp_eq_u32 vcc, 1, v73
  v_add_u32 v73, v64, v48
  v_lshlrev_b32 v73, 1, v73
  v_cndmask_b32 v73, v74, v73, vcc
  buffer_store_short v72, v73, s[16:19], 0 offen
  v_and_b32 v73, 1, v49
  v_cmp_eq_u32 vcc, 1, v73
  v_add_u32 v73, v65, v49
  v_lshlrev_b32 v73, 1, v73
  v_cndmask_b32 v73, v74, v73, vcc
  buffer_store_short v72, v73, s[16:19], 0 offen
  v_and_b32 v73, 1, v50
  v_cmp_eq_u32 vcc, 1, v73
  v_add_u32 v73, v66, v50
  v_lshlrev_b32 v73, 1, v73
  v_cndmask_b32 v73, v74, v73, vcc
  buffer_store_short v72, v73, s[16:19], 0 offen
KP_NQ0:
  s_mov_b64 exec, s[32:33]
KP_NQ1:
  v_cmp_gt_u32 vcc, s48, v1
  s_and_saveexec_b64 s[30:31], vcc
  ds_read_b32 v16, v24 offset:7680
  s_mov_b64 exec, s[30:31]
  v_cmp_gt_u32 vcc, s49, v1
  s_and_saveexec_b64 s[30:31], vcc
  ds_read_b32 v17, v25 offset:7680
  s_mov_b64 exec, s[30:31]
  v_cmp_gt_u32 vcc, s50, v1
  s_and_saveexec_b64 s[30:31], vcc
  ds_read_b32 v18, v26 offset:7680
  s_mov_b64 exec, s[30:31]
  v_cmp_gt_u32 vcc, s51, v1
  s_and_saveexec_b64 s[30:31], vcc
  ds_read_b32 v19, v27 offset:7680
  s_mov_b64 exec, s[30:31]
  v_cmp_gt_u32 vcc, s52, v1
  s_and_saveexec_b64 s[30:31], vcc
  ds_read_b32 v20, v28 offset:7680
  s_mov_b64 exec, s[30:31]
  v_cmp_gt_u32 vcc, s53, v1
  s_and_saveexec_b64 s[30:31], vcc
  ds_read_b32 v21, v29 offset:7680
  s_mov_b64 exec, s[30:31]
  v_cmp_gt_u32 vcc, s54, v1
  s_and_saveexec_b64 s[30:31], vcc
  ds_read_b32 v22, v30 offset:7680
  s_mov_b64 exec, s[30:31]
  s_waitcnt lgkmcnt(0)
  v_mov_b32 v94, 0x7ffffff0
  v_add_u32 v13, v16, v32
  v_lshlrev_b32 v13, 1, v13
  v_cmp_gt_u32 vcc, s48, v1
  s_nop 1
  v_cndmask_b32 v13, v94, v13, vcc
  buffer_store_short v40, v13, s[16:19], 0 offen
  v_add_u32 v13, v17, v33
  v_lshlrev_b32 v13, 1, v13
  v_cmp_gt_u32 vcc, s49, v1
  s_nop 1
  v_cndmask_b32 v13, v94, v13, vcc
  buffer_store_short v41, v13, s[16:19], 0 offen
  v_add_u32 v13, v18, v34
  v_lshlrev_b32 v13, 1, v13
  v_cmp_gt_u32 vcc, s50, v1
  s_nop 1
  v_cndmask_b32 v13, v94, v13, vcc
  buffer_store_short v42, v13, s[16:19], 0 offen
  v_add_u32 v13, v19, v35
  v_lshlrev_b32 v13, 1, v13
  v_cmp_gt_u32 vcc, s51, v1
  s_nop 1
  v_cndmask_b32 v13, v94, v13, vcc
  buffer_store_short v43, v13, s[16:19], 0 offen
  v_add_u32 v13, v20, v36
  v_lshlrev_b32 v13, 1, v13
  v_cmp_gt_u32 vcc, s52, v1
  s_nop 1
  v_cndmask_b32 v13, v94, v13, vcc
  buffer_store_short v44, v13, s[16:19], 0 offen
  v_add_u32 v13, v21, v37
  v_lshlrev_b32 v13, 1, v13
  v_cmp_gt_u32 vcc, s53, v1
  s_nop 1
  v_cndmask_b32 v13, v94, v13, vcc
  buffer_store_short v45, v13, s[16:19], 0 offen
  v_add_u32 v13, v22, v38
  v_lshlrev_b32 v13, 1, v13
  v_cmp_gt_u32 vcc, s54, v1
  s_nop 1
  v_cndmask_b32 v13, v94, v13, vcc
  buffer_store_short v46, v13, s[16:19], 0 offen
  s_cmp_le_u32 s48, 64
  s_cbranch_scc1 KPRX_30
  s_mov_b32 s25, 64
KPRM_29:
  v_add_u32 v13, s25, v1
  v_cmp_gt_u32 vcc, s48, v13
  s_and_saveexec_b64 s[30:31], vcc
  s_cbranch_execz KPRM_29_s
  v_add_u32 v13, s40, v13
  v_lshlrev_b32 v13, 2, v13
  buffer_load_dword v48, v13, s[12:15], 0 offen sc1
  s_waitcnt vmcnt(0)
  v_lshrrev_b32 v49, 16, v48
  v_and_b32 v50, 0xffff, v48
  v_cmp_le_u32 vcc, s28, v50
  v_cmp_le_u32 s[36:37], s27, v50
  v_mul_u32_u24 v49, 3, v49
  v_add_u32 v14, 4864, v50
  v_subrev_u32 v15, 15104, v50
  v_cndmask_b32 v50, v50, v14, vcc
  v_cndmask_b32 v50, v50, v15, s[36:37]
  v_addc_co_u32 v49, vcc, 0, v49, vcc
  v_addc_co_u32 v49, vcc, 0, v49, s[36:37]
  v_lshlrev_b32 v49, 2, v49
  ds_add_rtn_u32 v51, v49, v3 offset:5120
  ds_read_b32 v52, v49 offset:7680
  ds_read_b32 v53, v49 offset:0
  s_waitcnt lgkmcnt(0)
  v_add3_u32 v51, v51, v52, v53
  v_lshlrev_b32 v51, 1, v51
  buffer_store_short v50, v51, s[16:19], 0 offen
KPRM_29_s:
  s_mov_b64 exec, s[30:31]
  s_add_u32 s25, s25, 64
  s_cmp_lt_u32 s25, s48
  s_cbranch_scc1 KPRM_29
KPRX_30:
  s_cmp_le_u32 s49, 64
  s_cbranch_scc1 KPRX_32
  s_mov_b32 s25, 64
KPRM_31:
  v_add_u32 v13, s25, v1
  v_cmp_gt_u32 vcc, s49, v13
  s_and_saveexec_b64 s[30:31], vcc
  s_cbranch_execz KPRM_31_s
  v_add_u32 v13, s41, v13
  v_lshlrev_b32 v13, 2, v13
  buffer_load_dword v48, v13, s[12:15], 0 offen sc1
  s_waitcnt vmcnt(0)
  v_lshrrev_b32 v49, 16, v48
  v_and_b32 v50, 0xffff, v48
  v_cmp_le_u32 vcc, s28, v50
  v_cmp_le_u32 s[36:37], s27, v50
  v_mul_u32_u24 v49, 3, v49
  v_add_u32 v14, 4864, v50
  v_subrev_u32 v15, 15104, v50
  v_cndmask_b32 v50, v50, v14, vcc
  v_cndmask_b32 v50, v50, v15, s[36:37]
  v_addc_co_u32 v49, vcc, 0, v49, vcc
  v_addc_co_u32 v49, vcc, 0, v49, s[36:37]
  v_lshlrev_b32 v49, 2, v49
  ds_add_rtn_u32 v51, v49, v3 offset:5120
  ds_read_b32 v52, v49 offset:7680
  ds_read_b32 v53, v49 offset:0
  s_waitcnt lgkmcnt(0)
  v_add3_u32 v51, v51, v52, v53
  v_lshlrev_b32 v51, 1, v51
  buffer_store_short v50, v51, s[16:19], 0 offen
KPRM_31_s:
  s_mov_b64 exec, s[30:31]
  s_add_u32 s25, s25, 64
  s_cmp_lt_u32 s25, s49
  s_cbranch_scc1 KPRM_31
KPRX_32:
  s_cmp_le_u32 s50, 64
  s_cbranch_scc1 KPRX_34
  s_mov_b32 s25, 64
KPRM_33:
  v_add_u32 v13, s25, v1
  v_cmp_gt_u32 vcc, s50, v13
  s_and_saveexec_b64 s[30:31], vcc
  s_cbranch_execz KPRM_33_s
  v_add_u32 v13, s42, v13
  v_lshlrev_b32 v13, 2, v13
  buffer_load_dword v48, v13, s[12:15], 0 offen sc1
  s_waitcnt vmcnt(0)
  v_lshrrev_b32 v49, 16, v48
  v_and_b32 v50, 0xffff, v48
  v_cmp_le_u32 vcc, s28, v50
  v_cmp_le_u32 s[36:37], s27, v50
  v_mul_u32_u24 v49, 3, v49
  v_add_u32 v14, 4864, v50
  v_subrev_u32 v15, 15104, v50
  v_cndmask_b32 v50, v50, v14, vcc
  v_cndmask_b32 v50, v50, v15, s[36:37]
  v_addc_co_u32 v49, vcc, 0, v49, vcc
  v_addc_co_u32 v49, vcc, 0, v49, s[36:37]
  v_lshlrev_b32 v49, 2, v49
  ds_add_rtn_u32 v51, v49, v3 offset:5120
  ds_read_b32 v52, v49 offset:7680
  ds_read_b32 v53, v49 offset:0
  s_waitcnt lgkmcnt(0)
  v_add3_u32 v51, v51, v52, v53
  v_lshlrev_b32 v51, 1, v51
  buffer_store_short v50, v51, s[16:19], 0 offen
KPRM_33_s:
  s_mov_b64 exec, s[30:31]
  s_add_u32 s25, s25, 64
  s_cmp_lt_u32 s25, s50
  s_cbranch_scc1 KPRM_33
KPRX_34:
  s_cmp_le_u32 s51, 64
  s_cbranch_scc1 KPRX_36
  s_mov_b32 s25, 64
KPRM_35:
  v_add_u32 v13, s25, v1
  v_cmp_gt_u32 vcc, s51, v13
  s_and_saveexec_b64 s[30:31], vcc
  s_cbranch_execz KPRM_35_s
  v_add_u32 v13, s43, v13
  v_lshlrev_b32 v13, 2, v13
  buffer_load_dword v48, v13, s[12:15], 0 offen sc1
  s_waitcnt vmcnt(0)
  v_lshrrev_b32 v49, 16, v48
  v_and_b32 v50, 0xffff, v48
  v_cmp_le_u32 vcc, s28, v50
  v_cmp_le_u32 s[36:37], s27, v50
  v_mul_u32_u24 v49, 3, v49
  v_add_u32 v14, 4864, v50
  v_subrev_u32 v15, 15104, v50
  v_cndmask_b32 v50, v50, v14, vcc
  v_cndmask_b32 v50, v50, v15, s[36:37]
  v_addc_co_u32 v49, vcc, 0, v49, vcc
  v_addc_co_u32 v49, vcc, 0, v49, s[36:37]
  v_lshlrev_b32 v49, 2, v49
  ds_add_rtn_u32 v51, v49, v3 offset:5120
  ds_read_b32 v52, v49 offset:7680
  ds_read_b32 v53, v49 offset:0
  s_waitcnt lgkmcnt(0)
  v_add3_u32 v51, v51, v52, v53
  v_lshlrev_b32 v51, 1, v51
  buffer_store_short v50, v51, s[16:19], 0 offen
KPRM_35_s:
  s_mov_b64 exec, s[30:31]
  s_add_u32 s25, s25, 64
  s_cmp_lt_u32 s25, s51
  s_cbranch_scc1 KPRM_35
KPRX_36:
  s_cmp_le_u32 s52, 64
  s_cbranch_scc1 KPRX_38
  s_mov_b32 s25, 64
KPRM_37:
  v_add_u32 v13, s25, v1
  v_cmp_gt_u32 vcc, s52, v13
  s_and_saveexec_b64 s[30:31], vcc
  s_cbranch_execz KPRM_37_s
  v_add_u32 v13, s44, v13
  v_lshlrev_b32 v13, 2, v13
  buffer_load_dword v48, v13, s[12:15], 0 offen sc1
  s_waitcnt vmcnt(0)
  v_lshrrev_b32 v49, 16, v48
  v_and_b32 v50, 0xffff, v48
  v_cmp_le_u32 vcc, s28, v50
  v_cmp_le_u32 s[36:37], s27, v50
  v_mul_u32_u24 v49, 3, v49
  v_add_u32 v14, 4864, v50
  v_subrev_u32 v15, 15104, v50
  v_cndmask_b32 v50, v50, v14, vcc
  v_cndmask_b32 v50, v50, v15, s[36:37]
  v_addc_co_u32 v49, vcc, 0, v49, vcc
  v_addc_co_u32 v49, vcc, 0, v49, s[36:37]
  v_lshlrev_b32 v49, 2, v49
  ds_add_rtn_u32 v51, v49, v3 offset:5120
  ds_read_b32 v52, v49 offset:7680
  ds_read_b32 v53, v49 offset:0
  s_waitcnt lgkmcnt(0)
  v_add3_u32 v51, v51, v52, v53
  v_lshlrev_b32 v51, 1, v51
  buffer_store_short v50, v51, s[16:19], 0 offen
KPRM_37_s:
  s_mov_b64 exec, s[30:31]
  s_add_u32 s25, s25, 64
  s_cmp_lt_u32 s25, s52
  s_cbranch_scc1 KPRM_37
KPRX_38:
  s_cmp_le_u32 s53, 64
  s_cbranch_scc1 KPRX_40
  s_mov_b32 s25, 64
KPRM_39:
  v_add_u32 v13, s25, v1
  v_cmp_gt_u32 vcc, s53, v13
  s_and_saveexec_b64 s[30:31], vcc
  s_cbranch_execz KPRM_39_s
  v_add_u32 v13, s45, v13
  v_lshlrev_b32 v13, 2, v13
  buffer_load_dword v48, v13, s[12:15], 0 offen sc1
  s_waitcnt vmcnt(0)
  v_lshrrev_b32 v49, 16, v48
  v_and_b32 v50, 0xffff, v48
  v_cmp_le_u32 vcc, s28, v50
  v_cmp_le_u32 s[36:37], s27, v50
  v_mul_u32_u24 v49, 3, v49
  v_add_u32 v14, 4864, v50
  v_subrev_u32 v15, 15104, v50
  v_cndmask_b32 v50, v50, v14, vcc
  v_cndmask_b32 v50, v50, v15, s[36:37]
  v_addc_co_u32 v49, vcc, 0, v49, vcc
  v_addc_co_u32 v49, vcc, 0, v49, s[36:37]
  v_lshlrev_b32 v49, 2, v49
  ds_add_rtn_u32 v51, v49, v3 offset:5120
  ds_read_b32 v52, v49 offset:7680
  ds_read_b32 v53, v49 offset:0
  s_waitcnt lgkmcnt(0)
  v_add3_u32 v51, v51, v52, v53
  v_lshlrev_b32 v51, 1, v51
  buffer_store_short v50, v51, s[16:19], 0 offen
KPRM_39_s:
  s_mov_b64 exec, s[30:31]
  s_add_u32 s25, s25, 64
  s_cmp_lt_u32 s25, s53
  s_cbranch_scc1 KPRM_39
KPRX_40:
  s_cmp_le_u32 s54, 64
  s_cbranch_scc1 KPRX_42
  s_mov_b32 s25, 64
KPRM_41:
  v_add_u32 v13, s25, v1
  v_cmp_gt_u32 vcc, s54, v13
  s_and_saveexec_b64 s[30:31], vcc
  s_cbranch_execz KPRM_41_s
  v_add_u32 v13, s46, v13
  v_lshlrev_b32 v13, 2, v13
  buffer_load_dword v48, v13, s[12:15], 0 offen sc1
  s_waitcnt vmcnt(0)
  v_lshrrev_b32 v49, 16, v48
  v_and_b32 v50, 0xffff, v48
  v_cmp_le_u32 vcc, s28, v50
  v_cmp_le_u32 s[36:37], s27, v50
  v_mul_u32_u24 v49, 3, v49
  v_add_u32 v14, 4864, v50
  v_subrev_u32 v15, 15104, v50
  v_cndmask_b32 v50, v50, v14, vcc
  v_cndmask_b32 v50, v50, v15, s[36:37]
  v_addc_co_u32 v49, vcc, 0, v49, vcc
  v_addc_co_u32 v49, vcc, 0, v49, s[36:37]
  v_lshlrev_b32 v49, 2, v49
  ds_add_rtn_u32 v51, v49, v3 offset:5120
  ds_read_b32 v52, v49 offset:7680
  ds_read_b32 v53, v49 offset:0
  s_waitcnt lgkmcnt(0)
  v_add3_u32 v51, v51, v52, v53
  v_lshlrev_b32 v51, 1, v51
  buffer_store_short v50, v51, s[16:19], 0 offen
KPRM_41_s:
  s_mov_b64 exec, s[30:31]
  s_add_u32 s25, s25, 64
  s_cmp_lt_u32 s25, s54
  s_cbranch_scc1 KPRM_41
KPRX_42:
  s_endpgm
KP_X:
  s_load_dwordx2 s[8:9], s[0:1], 0
  s_load_dwordx2 s[12:13], s[0:1], 24
  s_cmp_ge_u32 s22, 16
  s_cbranch_scc1 KP_END
  s_sub_u32 s3, s2, 131
  s_mul_i32 s3, s3, 16
  s_add_u32 s3, s3, s22
  s_add_u32 s40, s3, 0
  s_waitcnt lgkmcnt(0)
KP_XL:
  s_cmp_ge_u32 s40, 1563
  s_cbranch_scc1 KP_END
  s_lshl_b32 s20, s40, 4
  v_and_b32 v2, 15, v1
  v_add_u32 v2, s20, v2
  v_lshrrev_b32 v3, 4, v1
  v_lshlrev_b32 v4, 8, v2
  v_lshl_add_u32 v4, v3, 4, v4
  v_lshlrev_b32 v5, 1, v2
  s_waitcnt lgkmcnt(0)
  s_mov_b32 s10, 6400000
  s_mov_b32 s11, 0x20000
  s_mov_b32 s14, 50000
  s_mov_b32 s15, 0x20000
  buffer_load_ushort v6, v5, s[12:15], 0 offen
  buffer_load_dwordx4 v[8:11], v4, s[8:11], 0 offen offset:0
  buffer_load_dwordx4 v[12:15], v4, s[8:11], 0 offen offset:64
  buffer_load_dwordx4 v[16:19], v4, s[8:11], 0 offen offset:128
  buffer_load_dwordx4 v[20:23], v4, s[8:11], 0 offen offset:192
  s_add_u32 s32, s4, 6488064
  s_addc_u32 s33, s5, 0
  s_mov_b32 s34, 6488064
  s_mov_b32 s35, 0x20000
  s_mov_b32 s21, 202752
  v_mul_lo_u32 v72, v1, s21
  s_lshl_b32 s3, s20, 3
  v_add_u32 v72, s3, v72
  buffer_load_dword v73, v72, s[32:35], 0 offen
  s_add_u32 s16, s4, 12976128
  s_addc_u32 s17, s5, 0
  s_mov_b32 s18, 6488064
  s_mov_b32 s19, 0x20000
  s_add_u32 s24, s4, 0
  s_addc_u32 s25, s5, 0
  s_mov_b32 s26, 6488064
  s_mov_b32 s27, 0x20000
  s_mov_b32 s21, 202752
  v_and_b32 v7, 1, v1
  v_lshl_add_u32 v7, v3, 1, v7
  v_mul_lo_u32 v7, v7, s21
  v_and_b32 v5, -2, v2
  v_lshl_add_u32 v7, v5, 3, v7
  s_mov_b32 s28, 0xffff0000
  s_mov_b32 s30, 0xaaaaaaaa
  s_mov_b32 s31, 0xaaaaaaaa
  s_waitcnt vmcnt(5)
  v_lshlrev_b32 v6, 16, v6
  s_waitcnt vmcnt(4)
  s_mov_b32 s3, 0
  v_lshlrev_b32 v24, 16, v8
  v_and_b32 v25, s28, v8
  v_mul_f32 v24, v24, v6
  v_mul_f32 v25, v25, v6
  v_cvt_pk_bf16_f32 v32, v24, v25
  v_lshlrev_b32 v26, 16, v9
  v_and_b32 v27, s28, v9
  v_mul_f32 v26, v26, v6
  v_mul_f32 v27, v27, v6
  v_cvt_pk_bf16_f32 v33, v26, v27
  v_lshlrev_b32 v28, 16, v10
  v_and_b32 v29, s28, v10
  v_mul_f32 v28, v28, v6
  v_mul_f32 v29, v29, v6
  v_cvt_pk_bf16_f32 v34, v28, v29
  v_lshlrev_b32 v30, 16, v11
  v_and_b32 v31, s28, v11
  v_mul_f32 v30, v30, v6
  v_mul_f32 v31, v31, v6
  v_cvt_pk_bf16_f32 v35, v30, v31
  v_cndmask_b32 v36, v34, v32, s[30:31]
  v_cndmask_b32 v37, v35, v33, s[30:31]
  s_nop 0
  v_mov_b32_dpp v38, v36 quad_perm:[1,0,3,2] row_mask:0xf bank_mask:0xf
  v_mov_b32_dpp v39, v37 quad_perm:[1,0,3,2] row_mask:0xf bank_mask:0xf
  v_cndmask_b32 v40, v32, v38, s[30:31]
  v_cndmask_b32 v41, v33, v39, s[30:31]
  v_cndmask_b32 v42, v38, v34, s[30:31]
  v_cndmask_b32 v43, v39, v35, s[30:31]
  buffer_store_dwordx4 v[40:43], v7, s[24:27], s3 offen
  v_cndmask_b32 v36, v10, v8, s[30:31]
  v_cndmask_b32 v37, v11, v9, s[30:31]
  s_nop 0
  v_mov_b32_dpp v38, v36 quad_perm:[1,0,3,2] row_mask:0xf bank_mask:0xf
  v_mov_b32_dpp v39, v37 quad_perm:[1,0,3,2] row_mask:0xf bank_mask:0xf
  v_cndmask_b32 v44, v8, v38, s[30:31]
  v_cndmask_b32 v45, v9, v39, s[30:31]
  v_cndmask_b32 v46, v38, v10, s[30:31]
  v_cndmask_b32 v47, v39, v11, s[30:31]
  buffer_store_dwordx4 v[44:47], v7, s[16:19], s3 offen
  s_waitcnt vmcnt(5)
  s_mov_b32 s3, 1622016
  v_lshlrev_b32 v24, 16, v12
  v_and_b32 v25, s28, v12
  v_mul_f32 v24, v24, v6
  v_mul_f32 v25, v25, v6
  v_cvt_pk_bf16_f32 v32, v24, v25
  v_lshlrev_b32 v26, 16, v13
  v_and_b32 v27, s28, v13
  v_mul_f32 v26, v26, v6
  v_mul_f32 v27, v27, v6
  v_cvt_pk_bf16_f32 v33, v26, v27
  v_lshlrev_b32 v28, 16, v14
  v_and_b32 v29, s28, v14
  v_mul_f32 v28, v28, v6
  v_mul_f32 v29, v29, v6
  v_cvt_pk_bf16_f32 v34, v28, v29
  v_lshlrev_b32 v30, 16, v15
  v_and_b32 v31, s28, v15
  v_mul_f32 v30, v30, v6
  v_mul_f32 v31, v31, v6
  v_cvt_pk_bf16_f32 v35, v30, v31
  v_cndmask_b32 v36, v34, v32, s[30:31]
  v_cndmask_b32 v37, v35, v33, s[30:31]
  s_nop 0
  v_mov_b32_dpp v38, v36 quad_perm:[1,0,3,2] row_mask:0xf bank_mask:0xf
  v_mov_b32_dpp v39, v37 quad_perm:[1,0,3,2] row_mask:0xf bank_mask:0xf
  v_cndmask_b32 v48, v32, v38, s[30:31]
  v_cndmask_b32 v49, v33, v39, s[30:31]
  v_cndmask_b32 v50, v38, v34, s[30:31]
  v_cndmask_b32 v51, v39, v35, s[30:31]
  buffer_store_dwordx4 v[48:51], v7, s[24:27], s3 offen
  v_cndmask_b32 v36, v14, v12, s[30:31]
  v_cndmask_b32 v37, v15, v13, s[30:31]
  s_nop 0
  v_mov_b32_dpp v38, v36 quad_perm:[1,0,3,2] row_mask:0xf bank_mask:0xf
  v_mov_b32_dpp v39, v37 quad_perm:[1,0,3,2] row_mask:0xf bank_mask:0xf
  v_cndmask_b32 v52, v12, v38, s[30:31]
  v_cndmask_b32 v53, v13, v39, s[30:31]
  v_cndmask_b32 v54, v38, v14, s[30:31]
  v_cndmask_b32 v55, v39, v15, s[30:31]
  buffer_store_dwordx4 v[52:55], v7, s[16:19], s3 offen
  s_waitcnt vmcnt(6)
  s_mov_b32 s3, 3244032
  v_lshlrev_b32 v24, 16, v16
  v_and_b32 v25, s28, v16
  v_mul_f32 v24, v24, v6
  v_mul_f32 v25, v25, v6
  v_cvt_pk_bf16_f32 v32, v24, v25
  v_lshlrev_b32 v26, 16, v17
  v_and_b32 v27, s28, v17
  v_mul_f32 v26, v26, v6
  v_mul_f32 v27, v27, v6
  v_cvt_pk_bf16_f32 v33, v26, v27
  v_lshlrev_b32 v28, 16, v18
  v_and_b32 v29, s28, v18
  v_mul_f32 v28, v28, v6
  v_mul_f32 v29, v29, v6
  v_cvt_pk_bf16_f32 v34, v28, v29
  v_lshlrev_b32 v30, 16, v19
  v_and_b32 v31, s28, v19
  v_mul_f32 v30, v30, v6
  v_mul_f32 v31, v31, v6
  v_cvt_pk_bf16_f32 v35, v30, v31
  v_cndmask_b32 v36, v34, v32, s[30:31]
  v_cndmask_b32 v37, v35, v33, s[30:31]
  s_nop 0
  v_mov_b32_dpp v38, v36 quad_perm:[1,0,3,2] row_mask:0xf bank_mask:0xf
  v_mov_b32_dpp v39, v37 quad_perm:[1,0,3,2] row_mask:0xf bank_mask:0xf
  v_cndmask_b32 v56, v32, v38, s[30:31]
  v_cndmask_b32 v57, v33, v39, s[30:31]
  v_cndmask_b32 v58, v38, v34, s[30:31]
  v_cndmask_b32 v59, v39, v35, s[30:31]
  buffer_store_dwordx4 v[56:59], v7, s[24:27], s3 offen
  v_cndmask_b32 v36, v18, v16, s[30:31]
  v_cndmask_b32 v37, v19, v17, s[30:31]
  s_nop 0
  v_mov_b32_dpp v38, v36 quad_perm:[1,0,3,2] row_mask:0xf bank_mask:0xf
  v_mov_b32_dpp v39, v37 quad_perm:[1,0,3,2] row_mask:0xf bank_mask:0xf
  v_cndmask_b32 v60, v16, v38, s[30:31]
  v_cndmask_b32 v61, v17, v39, s[30:31]
  v_cndmask_b32 v62, v38, v18, s[30:31]
  v_cndmask_b32 v63, v39, v19, s[30:31]
  buffer_store_dwordx4 v[60:63], v7, s[16:19], s3 offen
  s_waitcnt vmcnt(7)
  s_mov_b32 s3, 4866048
  v_lshlrev_b32 v24, 16, v20
  v_and_b32 v25, s28, v20
  v_mul_f32 v24, v24, v6
  v_mul_f32 v25, v25, v6
  v_cvt_pk_bf16_f32 v32, v24, v25
  v_lshlrev_b32 v26, 16, v21
  v_and_b32 v27, s28, v21
  v_mul_f32 v26, v26, v6
  v_mul_f32 v27, v27, v6
  v_cvt_pk_bf16_f32 v33, v26, v27
  v_lshlrev_b32 v28, 16, v22
  v_and_b32 v29, s28, v22
  v_mul_f32 v28, v28, v6
  v_mul_f32 v29, v29, v6
  v_cvt_pk_bf16_f32 v34, v28, v29
  v_lshlrev_b32 v30, 16, v23
  v_and_b32 v31, s28, v23
  v_mul_f32 v30, v30, v6
  v_mul_f32 v31, v31, v6
  v_cvt_pk_bf16_f32 v35, v30, v31
  v_cndmask_b32 v36, v34, v32, s[30:31]
  v_cndmask_b32 v37, v35, v33, s[30:31]
  s_nop 0
  v_mov_b32_dpp v38, v36 quad_perm:[1,0,3,2] row_mask:0xf bank_mask:0xf
  v_mov_b32_dpp v39, v37 quad_perm:[1,0,3,2] row_mask:0xf bank_mask:0xf
  v_cndmask_b32 v64, v32, v38, s[30:31]
  v_cndmask_b32 v65, v33, v39, s[30:31]
  v_cndmask_b32 v66, v38, v34, s[30:31]
  v_cndmask_b32 v67, v39, v35, s[30:31]
  buffer_store_dwordx4 v[64:67], v7, s[24:27], s3 offen
  v_cndmask_b32 v36, v22, v20, s[30:31]
  v_cndmask_b32 v37, v23, v21, s[30:31]
  s_nop 0
  v_mov_b32_dpp v38, v36 quad_perm:[1,0,3,2] row_mask:0xf bank_mask:0xf
  v_mov_b32_dpp v39, v37 quad_perm:[1,0,3,2] row_mask:0xf bank_mask:0xf
  v_cndmask_b32 v68, v20, v38, s[30:31]
  v_cndmask_b32 v69, v21, v39, s[30:31]
  v_cndmask_b32 v70, v38, v22, s[30:31]
  v_cndmask_b32 v71, v39, v23, s[30:31]
  buffer_store_dwordx4 v[68:71], v7, s[16:19], s3 offen
  s_endpgm
KP_SW:
  s_load_dwordx2 s[8:9], s[0:1], 64
  v_mov_b32 v8, 0
  v_mov_b32 v9, 0
  v_mov_b32 v10, 0
  v_mov_b32 v11, 0
  v_lshlrev_b32 v2, 4, v0
  v_add_u32 v2, 68250112, v2
  s_waitcnt lgkmcnt(0)
  global_store_dwordx4 v2, v[8:11], s[4:5]
  s_cmp_lg_u32 s22, 0
  s_cbranch_scc1 KP_SW2
  v_lshlrev_b32 v3, 2, v1
  global_load_dword v4, v3, s[8:9]
  s_waitcnt vmcnt(0)
  v_lshlrev_b32 v5, 16, v4
  v_and_b32 v6, 0xffff0000, v4
  v_add_f32 v7, v5, v6
  s_nop 1
  v_add_f32_dpp v7, v7, v7 quad_perm:[1,0,3,2] row_mask:0xf bank_mask:0xf
  s_nop 1
  v_add_f32_dpp v7, v7, v7 quad_perm:[2,3,0,1] row_mask:0xf bank_mask:0xf
  s_nop 1
  v_add_f32_dpp v7, v7, v7 row_half_mirror row_mask:0xf bank_mask:0xf
  s_nop 1
  v_add_f32_dpp v7, v7, v7 row_mirror row_mask:0xf bank_mask:0xf
  v_mov_b32 v12, v7
  s_nop 1
  v_permlane16_swap_b32 v7, v12
  v_add_f32 v7, v7, v12
  v_mov_b32 v12, v7
  s_nop 1
  v_permlane32_swap_b32 v7, v12
  v_add_f32 v7, v7, v12
  v_mul_f32 v7, 0x3c000000, v7
  v_sub_f32 v5, v5, v7
  v_sub_f32 v6, v6, v7
  v_mul_f32 v5, 0x3fb8aa3b, v5
  v_mul_f32 v6, 0x3fb8aa3b, v6
  v_cvt_pk_bf16_f32 v12, v5, v6
  v_lshlrev_b32 v13, 16, v12
  v_and_b32 v14, 0xffff0000, v12
  v_sub_f32 v5, v5, v13
  v_sub_f32 v6, v6, v14
  v_cvt_pk_bf16_f32 v13, v5, v6
  ds_write_b32 v3, v12 offset:256
  ds_write_b32 v3, v13 offset:512
  v_mov_b32 v12, 0x3f803f80
  v_mov_b32 v13, 0
  ds_write_b32 v3, v12
  ds_write_b32 v3, v13 offset:768
KP_SW2:
  s_waitcnt lgkmcnt(0)
  s_barrier
  s_cmp_ge_u32 s22, 8
  s_cbranch_scc1 KP_END
  v_and_b32 v2, 3, v1
  v_lshlrev_b32 v2, 8, v2
  v_lshrrev_b32 v3, 5, v1
  v_lshl_add_u32 v2, v3, 4, v2
  s_lshl_b32 s3, s22, 5
  v_add_u32 v2, s3, v2
  ds_read_b128 v[8:11], v2
  v_bfe_u32 v3, v1, 4, 1
  v_bfe_u32 v4, v1, 2, 1
  v_cmp_eq_u32 vcc, v3, v4
  s_waitcnt lgkmcnt(0)
  s_nop 0
  v_cndmask_b32 v8, 0, v8, vcc
  v_cndmask_b32 v9, 0, v9, vcc
  v_cndmask_b32 v10, 0, v10, vcc
  v_cndmask_b32 v11, 0, v11, vcc
  s_lshl_b32 s3, s22, 10
  s_add_u32 s3, s3, 64946176
  v_lshlrev_b32 v2, 4, v1
  v_add_u32 v2, s3, v2
  global_store_dwordx4 v2, v[8:11], s[4:5]
  s_endpgm
KP_WM:
  s_load_dwordx4 s[8:11], s[0:1], 32
  s_waitcnt lgkmcnt(0)
  s_mov_b32 s12, s8
  s_mov_b32 s13, s9
  s_mov_b32 s14, 32768
  s_mov_b32 s15, 0x20000
  s_mov_b32 s16, s10
  s_mov_b32 s17, s11
  s_mov_b32 s18, 32768
  s_mov_b32 s19, 0x20000
  v_lshlrev_b32 v90, 4, v0
  v_add_u32 v91, 16384, v90
  v_lshrrev_b32 v92, 4, v0
  v_and_b32 v93, 15, v92
  v_and_b32 v94, 15, v0
  v_xor_b32 v93, v93, v94
  v_lshlrev_b32 v93, 4, v93
  v_lshl_add_u32 v92, v92, 8, v93
  buffer_load_dwordx4 v[8:11], v90, s[12:15], 0 offen
  buffer_load_dwordx4 v[12:15], v91, s[12:15], 0 offen
  buffer_load_dwordx4 v[16:19], v90, s[16:19], 0 offen
  buffer_load_dwordx4 v[20:23], v91, s[16:19], 0 offen
  s_lshr_b32 s20, s22, 2
  s_lshl_b32 s20, s20, 13
  s_and_b32 s21, s22, 3
  s_lshl_b32 s21, s21, 13
  v_and_b32 v2, 0x13, v1
  v_bfe_u32 v3, v1, 2, 1
  v_lshl_or_b32 v2, v3, 3, v2
  v_bfe_u32 v3, v1, 3, 1
  v_lshl_or_b32 v2, v3, 2, v2
  v_and_b32 v3, 15, v2
  v_lshrrev_b32 v4, 5, v1
  v_xor_b32 v57, v3, v4
  v_lshlrev_b32 v56, 8, v2
  v_add_u32 v56, s20, v56
  v_and_b32 v2, 0x13, v1
  v_bfe_u32 v3, v1, 2, 1
  v_lshl_or_b32 v2, v3, 3, v2
  v_bfe_u32 v3, v1, 3, 1
  v_lshl_or_b32 v2, v3, 2, v2
  v_and_b32 v3, 15, v2
  v_lshrrev_b32 v4, 5, v1
  v_xor_b32 v59, v3, v4
  v_lshlrev_b32 v58, 8, v2
  v_add_u32 v58, s21, v58
  s_waitcnt vmcnt(2)
  ds_write_b128 v92, v[8:11]
  ds_write_b128 v92, v[12:15] offset:16384
  s_waitcnt vmcnt(0)
  ds_write_b128 v92, v[16:19] offset:32768
  ds_write_b128 v92, v[20:23] offset:49152
  s_waitcnt lgkmcnt(0)
  s_barrier
  v_xor_b32 v7, 0, v57
  v_lshl_add_u32 v7, v7, 4, v56
  ds_read_b128 v[8:11], v7 offset:0
  v_xor_b32 v7, 0, v59
  v_lshl_add_u32 v7, v7, 4, v58
  ds_read_b128 v[84:87], v7 offset:32768
  v_xor_b32 v7, 2, v57
  v_lshl_add_u32 v7, v7, 4, v56
  ds_read_b128 v[12:15], v7 offset:0
  v_xor_b32 v7, 2, v59
  v_lshl_add_u32 v7, v7, 4, v58
  ds_read_b128 v[88:91], v7 offset:32768
  v_xor_b32 v7, 4, v57
  v_lshl_add_u32 v7, v7, 4, v56
  ds_read_b128 v[16:19], v7 offset:0
  v_xor_b32 v7, 4, v59
  v_lshl_add_u32 v7, v7, 4, v58
  ds_read_b128 v[92:95], v7 offset:32768
  v_xor_b32 v7, 6, v57
  v_lshl_add_u32 v7, v7, 4, v56
  ds_read_b128 v[20:23], v7 offset:0
  v_xor_b32 v7, 6, v59
  v_lshl_add_u32 v7, v7, 4, v58
  ds_read_b128 v[96:99], v7 offset:32768
  s_waitcnt lgkmcnt(0)
  v_xor_b32 v7, 8, v57
  v_lshl_add_u32 v7, v7, 4, v56
  ds_read_b128 v[24:27], v7 offset:0
  v_xor_b32 v7, 8, v59
  v_lshl_add_u32 v7, v7, 4, v58
  ds_read_b128 v[100:103], v7 offset:32768
  v_xor_b32 v7, 10, v57
  v_lshl_add_u32 v7, v7, 4, v56
  ds_read_b128 v[28:31], v7 offset:0
  v_xor_b32 v7, 10, v59
  v_lshl_add_u32 v7, v7, 4, v58
  ds_read_b128 v[104:107], v7 offset:32768
  v_xor_b32 v7, 12, v57
  v_lshl_add_u32 v7, v7, 4, v56
  ds_read_b128 v[32:35], v7 offset:0
  v_xor_b32 v7, 12, v59
  v_lshl_add_u32 v7, v7, 4, v58
  ds_read_b128 v[108:111], v7 offset:32768
  v_xor_b32 v7, 14, v57
  v_lshl_add_u32 v7, v7, 4, v56
  ds_read_b128 v[36:39], v7 offset:0
  v_xor_b32 v7, 14, v59
  v_lshl_add_u32 v7, v7, 4, v58
  ds_read_b128 v[112:115], v7 offset:32768
  s_waitcnt lgkmcnt(0)
  s_barrier
  v_mfma_f32_32x32x16_bf16 v[64:79], v[8:11], v[84:87], 0
  v_mfma_f32_32x32x16_bf16 v[40:55], v[84:87], v[8:11], 0
  v_mfma_f32_32x32x16_bf16 v[64:79], v[12:15], v[88:91], v[64:79]
  v_mfma_f32_32x32x16_bf16 v[40:55], v[88:91], v[12:15], v[40:55]
  v_mfma_f32_32x32x16_bf16 v[64:79], v[16:19], v[92:95], v[64:79]
  v_mfma_f32_32x32x16_bf16 v[40:55], v[92:95], v[16:19], v[40:55]
  v_mfma_f32_32x32x16_bf16 v[64:79], v[20:23], v[96:99], v[64:79]
  v_mfma_f32_32x32x16_bf16 v[40:55], v[96:99], v[20:23], v[40:55]
  v_mfma_f32_32x32x16_bf16 v[64:79], v[24:27], v[100:103], v[64:79]
  v_mfma_f32_32x32x16_bf16 v[40:55], v[100:103], v[24:27], v[40:55]
  v_mfma_f32_32x32x16_bf16 v[64:79], v[28:31], v[104:107], v[64:79]
  v_mfma_f32_32x32x16_bf16 v[40:55], v[104:107], v[28:31], v[40:55]
  v_mfma_f32_32x32x16_bf16 v[64:79], v[32:35], v[108:111], v[64:79]
  v_mfma_f32_32x32x16_bf16 v[40:55], v[108:111], v[32:35], v[40:55]
  v_mfma_f32_32x32x16_bf16 v[64:79], v[36:39], v[112:115], v[64:79]
  v_mfma_f32_32x32x16_bf16 v[40:55], v[112:115], v[36:39], v[40:55]
  s_nop 10
  v_add_f32 v8, v64, v65
  v_add_f32 v8, v8, v66
  v_add_f32 v8, v8, v67
  v_add_f32 v8, v8, v68
  v_add_f32 v8, v8, v69
  v_add_f32 v8, v8, v70
  v_add_f32 v8, v8, v71
  v_add_f32 v8, v8, v72
  v_add_f32 v8, v8, v73
  v_add_f32 v8, v8, v74
  v_add_f32 v8, v8, v75
  v_add_f32 v8, v8, v76
  v_add_f32 v8, v8, v77
  v_add_f32 v8, v8, v78
  v_add_f32 v8, v8, v79
  v_mov_b32 v12, v8
  s_nop 1
  v_permlane32_swap_b32 v8, v12
  v_add_f32 v8, v8, v12
  v_and_b32 v13, 31, v1
  v_lshlrev_b32 v13, 2, v13
  s_lshl_b32 s3, s22, 7
  v_add_u32 v14, s3, v13
  ds_write_b32 v14, v8 offset:32768
  v_add_f32 v9, v40, v41
  v_add_f32 v9, v9, v42
  v_add_f32 v9, v9, v43
  v_add_f32 v9, v9, v44
  v_add_f32 v9, v9, v45
  v_add_f32 v9, v9, v46
  v_add_f32 v9, v9, v47
  v_add_f32 v9, v9, v48
  v_add_f32 v9, v9, v49
  v_add_f32 v9, v9, v50
  v_add_f32 v9, v9, v51
  v_add_f32 v9, v9, v52
  v_add_f32 v9, v9, v53
  v_add_f32 v9, v9, v54
  v_add_f32 v9, v9, v55
  v_mov_b32 v12, v9
  s_nop 1
  v_permlane32_swap_b32 v9, v12
  v_add_f32 v9, v9, v12
  v_bfe_u32 v14, v1, 2, 1
  v_lshlrev_b32 v14, 4, v14
  v_bfe_u32 v15, v1, 3, 2
  v_lshl_add_u32 v14, v15, 2, v14
  v_and_b32 v15, 3, v1
  v_add_u32 v14, v14, v15
  v_lshlrev_b32 v14, 2, v14
  v_add_u32 v14, s3, v14
  ds_write_b32 v14, v9 offset:34816
  s_waitcnt lgkmcnt(0)
  s_barrier
  s_and_b32 s3, s22, 3
  s_lshl_b32 s3, s3, 7
  v_add_u32 v14, s3, v13
  ds_read_b32 v16, v14 offset:32768
  ds_read_b32 v17, v14 offset:33280
  ds_read_b32 v18, v14 offset:33792
  ds_read_b32 v19, v14 offset:34304
  v_lshlrev_b32 v15, 5, v1
  ds_read_b128 v[20:23], v15 offset:32768
  ds_read_b128 v[24:27], v15 offset:32784
  s_lshr_b32 s3, s22, 2
  s_lshl_b32 s3, s3, 9
  v_lshrrev_b32 v15, 5, v1
  v_lshlrev_b32 v15, 6, v15
  v_add_u32 v15, s3, v15
  ds_read_b128 v[84:87], v15 offset:34816
  ds_read_b128 v[88:91], v15 offset:34832
  ds_read_b128 v[92:95], v15 offset:34848
  ds_read_b128 v[96:99], v15 offset:34864
  ds_read_b128 v[100:103], v15 offset:34944
  ds_read_b128 v[104:107], v15 offset:34960
  ds_read_b128 v[108:111], v15 offset:34976
  ds_read_b128 v[112:115], v15 offset:34992
  s_waitcnt lgkmcnt(0)
  v_add_f32 v40, v84, v100
  v_add_f32 v41, v85, v101
  v_add_f32 v42, v86, v102
  v_add_f32 v43, v87, v103
  v_add_f32 v44, v88, v104
  v_add_f32 v45, v89, v105
  v_add_f32 v46, v90, v106
  v_add_f32 v47, v91, v107
  v_add_f32 v48, v92, v108
  v_add_f32 v49, v93, v109
  v_add_f32 v50, v94, v110
  v_add_f32 v51, v95, v111
  v_add_f32 v52, v96, v112
  v_add_f32 v53, v97, v113
  v_add_f32 v54, v98, v114
  v_add_f32 v55, v99, v115
  ds_read_b128 v[84:87], v15 offset:35072
  ds_read_b128 v[88:91], v15 offset:35088
  ds_read_b128 v[92:95], v15 offset:35104
  ds_read_b128 v[96:99], v15 offset:35120
  ds_read_b128 v[100:103], v15 offset:35200
  ds_read_b128 v[104:107], v15 offset:35216
  ds_read_b128 v[108:111], v15 offset:35232
  ds_read_b128 v[112:115], v15 offset:35248
  s_waitcnt lgkmcnt(0)
  v_add_f32 v84, v84, v100
  v_add_f32 v40, v40, v84
  v_add_f32 v85, v85, v101
  v_add_f32 v41, v41, v85
  v_add_f32 v86, v86, v102
  v_add_f32 v42, v42, v86
  v_add_f32 v87, v87, v103
  v_add_f32 v43, v43, v87
  v_add_f32 v88, v88, v104
  v_add_f32 v44, v44, v88
  v_add_f32 v89, v89, v105
  v_add_f32 v45, v45, v89
  v_add_f32 v90, v90, v106
  v_add_f32 v46, v46, v90
  v_add_f32 v91, v91, v107
  v_add_f32 v47, v47, v91
  v_add_f32 v92, v92, v108
  v_add_f32 v48, v48, v92
  v_add_f32 v93, v93, v109
  v_add_f32 v49, v49, v93
  v_add_f32 v94, v94, v110
  v_add_f32 v50, v50, v94
  v_add_f32 v95, v95, v111
  v_add_f32 v51, v51, v95
  v_add_f32 v96, v96, v112
  v_add_f32 v52, v52, v96
  v_add_f32 v97, v97, v113
  v_add_f32 v53, v53, v97
  v_add_f32 v98, v98, v114
  v_add_f32 v54, v54, v98
  v_add_f32 v99, v99, v115
  v_add_f32 v55, v55, v99
  s_waitcnt lgkmcnt(0)
  s_mov_b32 s3, 0x3c000000
  v_add_f32 v8, v16, v17
  v_add_f32 v9, v18, v19
  v_add_f32 v8, v8, v9
  v_mul_f32 v8, s3, v8
  v_add_f32 v12, v20, v21
  v_add_f32 v12, v12, v22
  v_add_f32 v12, v12, v23
  v_add_f32 v12, v12, v24
  v_add_f32 v12, v12, v25
  v_add_f32 v12, v12, v26
  v_add_f32 v12, v12, v27
  s_nop 1
  v_add_f32_dpp v12, v12, v12 quad_perm:[1,0,3,2] row_mask:0xf bank_mask:0xf
  s_nop 1
  v_add_f32_dpp v12, v12, v12 quad_perm:[2,3,0,1] row_mask:0xf bank_mask:0xf
  s_nop 1
  v_add_f32_dpp v12, v12, v12 row_half_mirror row_mask:0xf bank_mask:0xf
  s_nop 1
  v_add_f32_dpp v12, v12, v12 row_mirror row_mask:0xf bank_mask:0xf
  v_mov_b32 v15, v12
  s_nop 1
  v_permlane16_swap_b32 v12, v15
  v_add_f32 v12, v12, v15
  v_mov_b32 v15, v12
  s_nop 1
  v_permlane32_swap_b32 v12, v15
  v_add_f32 v12, v12, v15
  v_mul_f32 v12, s3, v12
  v_mul_f32 v12, s3, v12
  v_sub_f32 v8, v8, v12
  v_fma_f32 v40, s3, v40, v8
  v_fma_f32 v41, s3, v41, v8
  v_fma_f32 v42, s3, v42, v8
  v_fma_f32 v43, s3, v43, v8
  v_fma_f32 v44, s3, v44, v8
  v_fma_f32 v45, s3, v45, v8
  v_fma_f32 v46, s3, v46, v8
  v_fma_f32 v47, s3, v47, v8
  v_fma_f32 v48, s3, v48, v8
  v_fma_f32 v49, s3, v49, v8
  v_fma_f32 v50, s3, v50, v8
  v_fma_f32 v51, s3, v51, v8
  v_fma_f32 v52, s3, v52, v8
  v_fma_f32 v53, s3, v53, v8
  v_fma_f32 v54, s3, v54, v8
  v_fma_f32 v55, s3, v55, v8
  s_mov_b32 s3, 0x3e0293ee
  v_sub_f32 v64, v64, v40
  v_mul_f32 v64, s3, v64
  v_sub_f32 v65, v65, v41
  v_mul_f32 v65, s3, v65
  v_sub_f32 v66, v66, v42
  v_mul_f32 v66, s3, v66
  v_sub_f32 v67, v67, v43
  v_mul_f32 v67, s3, v67
  v_sub_f32 v68, v68, v44
  v_mul_f32 v68, s3, v68
  v_sub_f32 v69, v69, v45
  v_mul_f32 v69, s3, v69
  v_sub_f32 v70, v70, v46
  v_mul_f32 v70, s3, v70
  v_sub_f32 v71, v71, v47
  v_mul_f32 v71, s3, v71
  v_sub_f32 v72, v72, v48
  v_mul_f32 v72, s3, v72
  v_sub_f32 v73, v73, v49
  v_mul_f32 v73, s3, v73
  v_sub_f32 v74, v74, v50
  v_mul_f32 v74, s3, v74
  v_sub_f32 v75, v75, v51
  v_mul_f32 v75, s3, v75
  v_sub_f32 v76, v76, v52
  v_mul_f32 v76, s3, v76
  v_sub_f32 v77, v77, v53
  v_mul_f32 v77, s3, v77
  v_sub_f32 v78, v78, v54
  v_mul_f32 v78, s3, v78
  v_sub_f32 v79, v79, v55
  v_mul_f32 v79, s3, v79
  s_and_b32 s3, s22, 3
  s_lshl_b32 s3, s3, 13
  s_lshr_b32 s20, s22, 2
  s_lshl_b32 s20, s20, 11
  s_add_u32 s3, s3, s20
  s_add_u32 s3, s3, 64880640
  v_lshlrev_b32 v13, 4, v1
  v_add_u32 v13, s3, v13
  v_cvt_pk_bf16_f32 v32, v64, v65
  v_cvt_pk_bf16_f32 v33, v66, v67
  v_cvt_pk_bf16_f32 v34, v68, v69
  v_cvt_pk_bf16_f32 v35, v70, v71
  global_store_dwordx4 v13, v[32:35], s[4:5] offset:0
  v_cvt_pk_bf16_f32 v36, v72, v73
  v_cvt_pk_bf16_f32 v37, v74, v75
  v_cvt_pk_bf16_f32 v38, v76, v77
  v_cvt_pk_bf16_f32 v39, v78, v79
  global_store_dwordx4 v13, v[36:39], s[4:5] offset:1024
  s_endpgm
KP_WU:
  s_load_dwordx4 s[8:11], s[0:1], 48
  s_waitcnt lgkmcnt(0)
  s_mov_b32 s12, s8
  s_mov_b32 s13, s9
  s_mov_b32 s14, 32768
  s_mov_b32 s15, 0x20000
  s_mov_b32 s16, s10
  s_mov_b32 s17, s11
  s_mov_b32 s18, 32768
  s_mov_b32 s19, 0x20000
  v_lshlrev_b32 v90, 4, v0
  v_add_u32 v91, 16384, v90
  v_lshrrev_b32 v92, 4, v0
  v_and_b32 v93, 15, v92
  v_and_b32 v94, 15, v0
  v_xor_b32 v93, v93, v94
  v_lshlrev_b32 v93, 4, v93
  v_lshl_add_u32 v92, v92, 8, v93
  buffer_load_dwordx4 v[8:11], v90, s[12:15], 0 offen
  buffer_load_dwordx4 v[12:15], v91, s[12:15], 0 offen
  buffer_load_dwordx4 v[16:19], v90, s[16:19], 0 offen
  buffer_load_dwordx4 v[20:23], v91, s[16:19], 0 offen
  s_lshr_b32 s20, s22, 2
  s_lshl_b32 s20, s20, 13
  v_and_b32 v2, 0x13, v1
  v_bfe_u32 v3, v1, 2, 1
  v_lshl_or_b32 v2, v3, 3, v2
  v_bfe_u32 v3, v1, 3, 1
  v_lshl_or_b32 v2, v3, 2, v2
  v_and_b32 v3, 15, v2
  v_lshrrev_b32 v4, 5, v1
  v_xor_b32 v57, v3, v4
  v_lshlrev_b32 v56, 8, v2
  v_add_u32 v56, s20, v56
  v_lshrrev_b32 v5, 5, v1
  v_lshlrev_b32 v5, 3, v5
  v_bfe_u32 v6, v1, 2, 2
  v_add_u32 v5, v5, v6
  v_lshlrev_b32 v5, 8, v5
  v_bfe_u32 v6, v1, 4, 1
  v_lshlrev_b32 v6, 4, v6
  v_and_b32 v7, 1, v1
  v_lshl_add_u32 v6, v7, 3, v6
  v_bfe_u32 v7, v1, 1, 1
  v_lshl_add_u32 v6, v7, 2, v6
  v_lshl_add_u32 v5, v6, 1, v5
  s_and_b32 s21, s22, 3
  s_lshl_b32 s21, s21, 6
  v_add_u32 v5, s21, v5
  s_waitcnt vmcnt(2)
  ds_write_b128 v92, v[8:11]
  ds_write_b128 v92, v[12:15] offset:16384
  s_waitcnt vmcnt(0)
  ds_write_b128 v90, v[16:19] offset:32768
  ds_write_b128 v91, v[20:23] offset:32768
  s_waitcnt lgkmcnt(0)
  s_barrier
  v_xor_b32 v7, 0, v57
  v_lshl_add_u32 v7, v7, 4, v56
  ds_read_b128 v[8:11], v7 offset:0
  ds_read_b64_tr_b16 v[84:85], v5 offset:32768
  ds_read_b64_tr_b16 v[86:87], v5 offset:33792
  v_xor_b32 v7, 2, v57
  v_lshl_add_u32 v7, v7, 4, v56
  ds_read_b128 v[12:15], v7 offset:0
  ds_read_b64_tr_b16 v[88:89], v5 offset:36864
  ds_read_b64_tr_b16 v[90:91], v5 offset:37888
  v_xor_b32 v7, 4, v57
  v_lshl_add_u32 v7, v7, 4, v56
  ds_read_b128 v[16:19], v7 offset:0
  ds_read_b64_tr_b16 v[92:93], v5 offset:40960
  ds_read_b64_tr_b16 v[94:95], v5 offset:41984
  v_xor_b32 v7, 6, v57
  v_lshl_add_u32 v7, v7, 4, v56
  ds_read_b128 v[20:23], v7 offset:0
  ds_read_b64_tr_b16 v[96:97], v5 offset:45056
  ds_read_b64_tr_b16 v[98:99], v5 offset:46080
  s_waitcnt lgkmcnt(0)
  v_xor_b32 v7, 8, v57
  v_lshl_add_u32 v7, v7, 4, v56
  ds_read_b128 v[24:27], v7 offset:0
  ds_read_b64_tr_b16 v[100:101], v5 offset:49152
  ds_read_b64_tr_b16 v[102:103], v5 offset:50176
  v_xor_b32 v7, 10, v57
  v_lshl_add_u32 v7, v7, 4, v56
  ds_read_b128 v[28:31], v7 offset:0
  ds_read_b64_tr_b16 v[104:105], v5 offset:53248
  ds_read_b64_tr_b16 v[106:107], v5 offset:54272
  v_xor_b32 v7, 12, v57
  v_lshl_add_u32 v7, v7, 4, v56
  ds_read_b128 v[32:35], v7 offset:0
  ds_read_b64_tr_b16 v[108:109], v5 offset:57344
  ds_read_b64_tr_b16 v[110:111], v5 offset:58368
  v_xor_b32 v7, 14, v57
  v_lshl_add_u32 v7, v7, 4, v56
  ds_read_b128 v[36:39], v7 offset:0
  ds_read_b64_tr_b16 v[112:113], v5 offset:61440
  ds_read_b64_tr_b16 v[114:115], v5 offset:62464
  s_waitcnt lgkmcnt(0)
  s_barrier
  v_mfma_f32_32x32x16_bf16 v[64:79], v[8:11], v[84:87], 0
  v_mfma_f32_32x32x16_bf16 v[64:79], v[12:15], v[88:91], v[64:79]
  v_mfma_f32_32x32x16_bf16 v[64:79], v[16:19], v[92:95], v[64:79]
  v_mfma_f32_32x32x16_bf16 v[64:79], v[20:23], v[96:99], v[64:79]
  v_mfma_f32_32x32x16_bf16 v[64:79], v[24:27], v[100:103], v[64:79]
  v_mfma_f32_32x32x16_bf16 v[64:79], v[28:31], v[104:107], v[64:79]
  v_mfma_f32_32x32x16_bf16 v[64:79], v[32:35], v[108:111], v[64:79]
  v_mfma_f32_32x32x16_bf16 v[64:79], v[36:39], v[112:115], v[64:79]
  s_nop 11
  v_add_f32 v8, v64, v65
  v_add_f32 v8, v8, v66
  v_add_f32 v8, v8, v67
  v_add_f32 v8, v8, v68
  v_add_f32 v8, v8, v69
  v_add_f32 v8, v8, v70
  v_add_f32 v8, v8, v71
  v_add_f32 v8, v8, v72
  v_add_f32 v8, v8, v73
  v_add_f32 v8, v8, v74
  v_add_f32 v8, v8, v75
  v_add_f32 v8, v8, v76
  v_add_f32 v8, v8, v77
  v_add_f32 v8, v8, v78
  v_add_f32 v8, v8, v79
  v_mov_b32 v12, v8
  s_nop 1
  v_permlane32_swap_b32 v8, v12
  v_add_f32 v8, v8, v12
  v_and_b32 v13, 31, v1
  v_lshlrev_b32 v13, 2, v13
  s_lshl_b32 s3, s22, 7
  v_add_u32 v14, s3, v13
  ds_write_b32 v14, v8 offset:32768
  s_waitcnt lgkmcnt(0)
  s_barrier
  s_and_b32 s3, s22, 3
  s_lshl_b32 s3, s3, 7
  v_add_u32 v14, s3, v13
  ds_read_b32 v16, v14 offset:32768
  ds_read_b32 v17, v14 offset:33280
  ds_read_b32 v18, v14 offset:33792
  ds_read_b32 v19, v14 offset:34304
  s_waitcnt lgkmcnt(0)
  s_mov_b32 s3, 0x3c000000
  v_add_f32 v8, v16, v17
  v_add_f32 v9, v18, v19
  v_add_f32 v8, v8, v9
  v_mul_f32 v8, s3, v8
  s_mov_b32 s3, 0x3f800000
  v_sub_f32 v64, v64, v8
  v_sub_f32 v65, v65, v8
  v_sub_f32 v66, v66, v8
  v_sub_f32 v67, v67, v8
  v_sub_f32 v68, v68, v8
  v_sub_f32 v69, v69, v8
  v_sub_f32 v70, v70, v8
  v_sub_f32 v71, v71, v8
  v_sub_f32 v72, v72, v8
  v_sub_f32 v73, v73, v8
  v_sub_f32 v74, v74, v8
  v_sub_f32 v75, v75, v8
  v_sub_f32 v76, v76, v8
  v_sub_f32 v77, v77, v8
  v_sub_f32 v78, v78, v8
  v_sub_f32 v79, v79, v8
  s_and_b32 s3, s22, 3
  s_lshl_b32 s3, s3, 13
  s_lshr_b32 s20, s22, 2
  s_lshl_b32 s20, s20, 11
  s_add_u32 s3, s3, s20
  s_add_u32 s3, s3, 64913408
  v_lshlrev_b32 v13, 4, v1
  v_add_u32 v13, s3, v13
  v_cvt_pk_bf16_f32 v32, v64, v65
  v_cvt_pk_bf16_f32 v33, v66, v67
  v_cvt_pk_bf16_f32 v34, v68, v69
  v_cvt_pk_bf16_f32 v35, v70, v71
  global_store_dwordx4 v13, v[32:35], s[4:5] offset:0
  v_cvt_pk_bf16_f32 v36, v72, v73
  v_cvt_pk_bf16_f32 v37, v74, v75
  v_cvt_pk_bf16_f32 v38, v76, v77
  v_cvt_pk_bf16_f32 v39, v78, v79
  global_store_dwordx4 v13, v[36:39], s[4:5] offset:1024
  s_endpgm
KP_END:
  s_endpgm
.section .rodata,"a"
.p2align 6
.amdhsa_kernel prep_kernel
  .amdhsa_next_free_vgpr 128
  .amdhsa_next_free_sgpr 88
  .amdhsa_accum_offset 128
  .amdhsa_group_segment_fixed_size 0
  .amdhsa_kernarg_size 96
  .amdhsa_user_sgpr_count 2
  .amdhsa_user_sgpr_kernarg_segment_ptr 1
  .amdhsa_system_sgpr_workgroup_id_x 1
  .amdhsa_float_denorm_mode_32 3
.end_amdhsa_kernel
.text
.globl hops_kernel
.p2align 8
.type hops_kernel,@function
hops_kernel:
  s_cmp_ge_u32 s2, 256
  s_cbranch_scc1 K3_END
  s_load_dwordx2 s[4:5], s[0:1], 88
  s_load_dwordx2 s[6:7], s[0:1], 24
  s_memtime s[60:61]
  s_and_b32 s20, s2, 7
  s_lshl_b32 s20, s20, 2
  s_lshr_b32 s3, s2, 3
  s_and_b32 s3, s3, 3
  s_add_u32 s20, s20, s3
  s_lshr_b32 s21, s2, 5
  v_lshrrev_b32 v56, 6, v0
  v_and_b32 v1, 63, v0
  s_getreg_b32 s44, hwreg(HW_REG_XCC_ID, 0, 4)
  v_readfirstlane_b32 s22, v56
  s_mul_i32 s41, s21, 3136
  s_waitcnt lgkmcnt(0)
  s_lshl_b32 s3, s20, 6
  s_add_u32 s45, s3, 68258304
  s_lshl_b32 s3, s21, 2
  s_add_u32 s3, s3, s45
  s_add_u32 s44, s44, 1
  v_mov_b32 v2, s3
  v_mov_b32 v3, s44
  v_cmp_eq_u32 vcc, 0, v0
  s_and_saveexec_b64 s[30:31], vcc
  s_cbranch_execz K3_X1
  global_store_dword v2, v3, s[4:5] sc1
K3_X1:
  s_mov_b64 exec, s[30:31]
  s_add_u32 s8, s4, 67725824
  s_addc_u32 s9, s5, 0
  s_mov_b32 s10, 401408
  s_mov_b32 s11, 0x20000
  s_mov_b32 s16, s6
  s_mov_b32 s17, s7
  s_mov_b32 s18, 50000
  s_mov_b32 s19, 0x20000
  v_mov_b32 v2, s41
  v_lshlrev_b32 v2, 4, v2
  buffer_load_dword v4, v2, s[8:11], 0 offen
  v_add_u32 v3, 50172, v2
  buffer_load_dword v5, v3, s[8:11], 0 offen
  v_add_u32 v2, s41, v0
  v_lshlrev_b32 v2, 4, v2
  v_add_u32 v3, 16384, v2
  v_add_u32 v6, 32768, v2
  v_add_u32 v7, 49152, v2
  s_add_u32 s12, s4, 69298688
  s_addc_u32 s13, s5, 0
  s_mov_b32 s14, 401408
  s_mov_b32 s15, 0x20000
  buffer_load_dwordx4 v[12:15], v2, s[12:15], 0 offen
  buffer_load_dwordx4 v[16:19], v3, s[12:15], 0 offen
  buffer_load_dwordx4 v[20:23], v6, s[12:15], 0 offen
  buffer_load_dwordx4 v[24:27], v7, s[12:15], 0 offen
  s_mov_b32 s42, 3136
  s_cmp_eq_u32 s21, 7
  s_cselect_b32 s42, 3048, s42
  v_lshlrev_b32 v56, 1, v0
  v_add_u32 v57, 2048, v56
  v_add_u32 v58, s41, v56
  v_lshlrev_b32 v68, 3, v58
  v_lshlrev_b32 v58, 1, v58
  v_cmp_gt_u32 vcc, s42, v56
  v_mov_b32 v59, 0x7ffffff0
  s_nop 0
  v_cndmask_b32 v68, v59, v68, vcc
  v_cndmask_b32 v58, v59, v58, vcc
  buffer_load_dword v64, v58, s[16:19], 0 offen
  v_add_u32 v58, s41, v57
  v_lshlrev_b32 v69, 3, v58
  v_lshlrev_b32 v58, 1, v58
  v_cmp_gt_u32 vcc, s42, v57
  v_mov_b32 v59, 0x7ffffff0
  s_nop 0
  v_cndmask_b32 v69, v59, v69, vcc
  v_cndmask_b32 v58, v59, v58, vcc
  buffer_load_dword v66, v58, s[16:19], 0 offen
  v_lshlrev_b32 v6, 2, v0
  v_mov_b32 v7, 0
  v_add_u32 v6, 156160, v6
  ds_write_b32 v6, v7
  v_mov_b32 v8, 160388
  ds_write_b32 v8, v7
  v_mov_b32 v7, 1308642816
  v_mov_b32 v8, 160384
  ds_write_b32 v8, v7
  v_lshlrev_b32 v10, 4, v1
  s_waitcnt lgkmcnt(0)
  s_barrier
  s_waitcnt vmcnt(6)
  v_readfirstlane_b32 s46, v4
  v_readfirstlane_b32 s47, v5
  s_add_u32 s12, s4, 66677248
  s_addc_u32 s13, s5, 0
  s_mov_b32 s15, 0x20000
  s_sub_u32 s48, s47, s46
  s_lshl_b32 s48, s48, 1
  s_lshl_b32 s14, s47, 1
  s_cmp_gt_u32 s48, 131072
  s_cselect_b32 s49, 1, 0
  s_cselect_b32 s14, 0, s14
  s_lshl_b32 s50, s46, 1
  s_lshl_b32 s56, s22, 10
  s_add_u32 s50, s50, s56
  v_mov_b32 v44, 0
  v_mov_b32 v45, 1
  s_mov_b32 s51, 156160
  v_cmp_gt_u32 s[52:53], 64, v0
  s_waitcnt vmcnt(5)
  v_or_b32 v44, v44, v15
  v_subrev_u32 v49, s46, v12
  v_lshlrev_b32 v49, 12, v49
  v_add_u32 v50, 0, v0
  v_or_b32 v36, v49, v50
  v_mov_b32 v40, v13
  v_add_u32 v28, s51, v14
  ds_add_rtn_u32 v32, v28, v45
  s_waitcnt vmcnt(4)
  v_or_b32 v44, v44, v19
  v_subrev_u32 v49, s46, v16
  v_lshlrev_b32 v49, 12, v49
  v_add_u32 v50, 1024, v0
  v_or_b32 v37, v49, v50
  v_mov_b32 v41, v17
  v_add_u32 v29, s51, v18
  ds_add_rtn_u32 v33, v29, v45
  s_waitcnt vmcnt(3)
  v_or_b32 v44, v44, v23
  v_subrev_u32 v49, s46, v20
  v_lshlrev_b32 v49, 12, v49
  v_add_u32 v50, 2048, v0
  v_or_b32 v38, v49, v50
  v_mov_b32 v42, v21
  v_add_u32 v30, s51, v22
  ds_add_rtn_u32 v34, v30, v45
  s_waitcnt vmcnt(2)
  v_cndmask_b32 v27, 0, v27, s[52:53]
  v_or_b32 v44, v44, v27
  v_subrev_u32 v49, s46, v24
  v_lshlrev_b32 v49, 12, v49
  v_add_u32 v50, 3072, v0
  v_or_b32 v39, v49, v50
  v_mov_b32 v43, v25
  v_add_u32 v31, s51, v26
  s_mov_b64 s[30:31], exec
  s_mov_b64 exec, s[52:53]
  s_cbranch_execz K3_H3
  ds_add_rtn_u32 v35, v31, v45
K3_H3:
  s_mov_b64 exec, s[30:31]
  s_add_u32 m0, s56, 0
  s_add_u32 s3, s50, 0
  buffer_load_dwordx4 v10, s[12:15], s3 offen lds
  s_add_u32 m0, s56, 16384
  s_add_u32 s3, s50, 16384
  buffer_load_dwordx4 v10, s[12:15], s3 offen lds
  s_add_u32 m0, s56, 32768
  s_add_u32 s3, s50, 32768
  buffer_load_dwordx4 v10, s[12:15], s3 offen lds
  v_cmp_ne_u32 vcc, 0, v44
  s_cmp_lg_u64 vcc, 0
  s_cselect_b32 s3, 1, 0
  s_or_b32 s49, s49, s3
  s_waitcnt lgkmcnt(0)
  s_barrier
  s_add_u32 m0, s56, 49152
  s_add_u32 s3, s50, 49152
  buffer_load_dwordx4 v10, s[12:15], s3 offen lds
  s_add_u32 m0, s56, 65536
  s_add_u32 s3, s50, 65536
  buffer_load_dwordx4 v10, s[12:15], s3 offen lds
  s_add_u32 m0, s56, 81920
  s_add_u32 s3, s50, 81920
  buffer_load_dwordx4 v10, s[12:15], s3 offen lds
  v_lshlrev_b32 v6, 2, v0
  v_add_u32 v6, 156160, v6
  ds_read_b32 v7, v6
  s_waitcnt lgkmcnt(0)
  v_mov_b32 v8, v7
  s_nop 1
  v_add_u32_dpp v8, v8, v8 row_shr:1 row_mask:0xf bank_mask:0xf bound_ctrl:0
  s_nop 1
  v_add_u32_dpp v8, v8, v8 row_shr:2 row_mask:0xf bank_mask:0xf bound_ctrl:0
  s_nop 1
  v_add_u32_dpp v8, v8, v8 row_shr:4 row_mask:0xf bank_mask:0xf bound_ctrl:0
  s_nop 1
  v_add_u32_dpp v8, v8, v8 row_shr:8 row_mask:0xf bank_mask:0xf bound_ctrl:0
  s_nop 1
  v_add_u32_dpp v8, v8, v8 row_bcast:15 row_mask:0xa bank_mask:0xf
  s_nop 1
  v_add_u32_dpp v8, v8, v8 row_bcast:31 row_mask:0xc bank_mask:0xf
  s_nop 1
  v_readlane_b32 s3, v8, 63
  s_lshl_b32 s28, s22, 2
  s_add_u32 s28, s28, 160256
  v_mov_b32 v9, s28
  v_mov_b32 v46, s3
  ds_write_b32 v9, v46
  s_waitcnt lgkmcnt(0)
  s_barrier
  s_add_u32 m0, s56, 98304
  s_add_u32 s3, s50, 98304
  buffer_load_dwordx4 v10, s[12:15], s3 offen lds
  s_add_u32 m0, s56, 114688
  s_add_u32 s3, s50, 114688
  buffer_load_dwordx4 v10, s[12:15], s3 offen lds
  v_lshlrev_b32 v9, 2, v1
  v_add_u32 v9, 160256, v9
  v_cmp_gt_u32 vcc, 16, v1
  v_mov_b32 v46, 0
  s_and_saveexec_b64 s[30:31], vcc
  ds_read_b32 v46, v9
  s_mov_b64 exec, s[30:31]
  s_waitcnt lgkmcnt(0)
  v_cmp_gt_u32 vcc, s22, v1
  s_nop 1
  v_cndmask_b32 v46, 0, v46, vcc
  s_nop 1
  v_add_u32_dpp v46, v46, v46 row_shr:1 row_mask:0xf bank_mask:0xf bound_ctrl:0
  s_nop 1
  v_add_u32_dpp v46, v46, v46 row_shr:2 row_mask:0xf bank_mask:0xf bound_ctrl:0
  s_nop 1
  v_add_u32_dpp v46, v46, v46 row_shr:4 row_mask:0xf bank_mask:0xf bound_ctrl:0
  s_nop 1
  v_add_u32_dpp v46, v46, v46 row_shr:8 row_mask:0xf bank_mask:0xf bound_ctrl:0
  s_nop 1
  v_add_u32_dpp v46, v46, v46 row_bcast:15 row_mask:0xa bank_mask:0xf
  s_nop 1
  v_add_u32_dpp v46, v46, v46 row_bcast:31 row_mask:0xc bank_mask:0xf
  s_nop 1
  v_readlane_b32 s3, v46, 63
  v_sub_u32 v8, v8, v7
  s_nop 0
  v_add_u32 v8, s3, v8
  ds_write_b32 v6, v8
  s_waitcnt lgkmcnt(0)
  s_barrier
  ds_read_b32 v12, v28
  ds_read_b32 v13, v29
  ds_read_b32 v14, v30
  s_mov_b64 s[30:31], exec
  s_mov_b64 exec, s[52:53]
  s_cbranch_execz K3_H4a
  ds_read_b32 v15, v31
K3_H4a:
  s_mov_b64 exec, s[30:31]
  s_waitcnt lgkmcnt(0)
  v_add_u32 v46, v12, v32
  v_lshlrev_b32 v47, 2, v46
  v_add_u32 v47, 131072, v47
  ds_write_b32 v47, v36
  ds_write_b32 v47, v40 offset:12544
  v_add_u32 v46, v13, v33
  v_lshlrev_b32 v47, 2, v46
  v_add_u32 v47, 131072, v47
  ds_write_b32 v47, v37
  ds_write_b32 v47, v41 offset:12544
  v_add_u32 v46, v14, v34
  v_lshlrev_b32 v47, 2, v46
  v_add_u32 v47, 131072, v47
  ds_write_b32 v47, v38
  ds_write_b32 v47, v42 offset:12544
  s_mov_b64 s[30:31], exec
  s_mov_b64 exec, s[52:53]
  s_cbranch_execz K3_H4
  v_add_u32 v46, v15, v35
  v_lshlrev_b32 v47, 2, v46
  v_add_u32 v47, 131072, v47
  ds_write_b32 v47, v39
  ds_write_b32 v47, v43 offset:12544
K3_H4:
  s_mov_b64 exec, s[30:31]
  s_cmp_eq_u32 s49, 0
  s_cbranch_scc1 K3_NOSF
  v_mov_b32 v46, 160388
  v_mov_b32 v47, 1
  ds_write_b32 v46, v47
K3_NOSF:
  s_waitcnt vmcnt(0) lgkmcnt(0)
  s_barrier
  s_mov_b32 s3, 0
  s_cmp_eq_u32 s22, 0
  s_cselect_b32 s3, 0x4901034, s3
  s_cmp_eq_u32 s22, 1
  s_cselect_b32 s3, 0xbe31403, s3
  s_cmp_eq_u32 s22, 2
  s_cselect_b32 s3, 0x81a0003, s3
  s_cmp_eq_u32 s22, 3
  s_cselect_b32 s3, 0x7513403, s3
  s_cmp_eq_u32 s22, 4
  s_cselect_b32 s3, 0x89e2403, s3
  s_cmp_eq_u32 s22, 5
  s_cselect_b32 s3, 0x6d63003, s3
  s_cmp_eq_u32 s22, 6
  s_cselect_b32 s3, 0xba51c03, s3
  s_cmp_eq_u32 s22, 7
  s_cselect_b32 s3, 0xad42803, s3
  s_cmp_eq_u32 s22, 8
  s_cselect_b32 s3, 0x9dc6003, s3
  s_cmp_eq_u32 s22, 9
  s_cselect_b32 s3, 0xb592c03, s3
  s_cmp_eq_u32 s22, 10
  s_cselect_b32 s3, 0xa8f3803, s3
  s_cmp_eq_u32 s22, 11
  s_cselect_b32 s3, 0xa642003, s3
  s_cmp_eq_u32 s22, 12
  s_cselect_b32 s3, 0x9974c03, s3
  s_cmp_eq_u32 s22, 13
  s_cselect_b32 s3, 0xa1f5403, s3
  s_cmp_eq_u32 s22, 14
  s_cselect_b32 s3, 0xc060803, s3
  s_cmp_eq_u32 s22, 15
  s_cselect_b32 s3, 0xb210403, s3
  s_and_b32 s39, s3, 15
  s_sub_u32 s38, 4, s39
  s_bfe_u32 s28, s3, 0x60004
  s_bfe_u32 s29, s3, 0x6000a
  s_bfe_u32 s30, s3, 0x60010
  s_bfe_u32 s31, s3, 0x60016
  s_lshl_b32 s3, s28, 8
  s_add_u32 s3, s3, 131072
  v_lshl_add_u32 v46, v1, 2, s3
  ds_read_b32 v32, v46
  ds_read_b32 v36, v46 offset:12544
  s_lshl_b32 s3, s29, 8
  s_add_u32 s3, s3, 131072
  v_lshl_add_u32 v46, v1, 2, s3
  ds_read_b32 v33, v46
  ds_read_b32 v37, v46 offset:12544
  s_lshl_b32 s3, s30, 8
  s_add_u32 s3, s3, 131072
  v_lshl_add_u32 v46, v1, 2, s3
  ds_read_b32 v34, v46
  ds_read_b32 v38, v46 offset:12544
  s_lshl_b32 s3, s31, 8
  s_add_u32 s3, s3, 131072
  v_lshl_add_u32 v46, v1, 2, s3
  ds_read_b32 v35, v46
  ds_read_b32 v39, v46 offset:12544
  s_waitcnt lgkmcnt(0)
  s_cmp_le_u32 s38, 0
  s_cbranch_scc1 IV_1
  v_mov_b32 v36, 0
  v_mov_b32 v32, 0xfff
IV_1:
  s_cmp_le_u32 s38, 1
  s_cbranch_scc1 IV_2
  v_mov_b32 v37, 0
  v_mov_b32 v33, 0xfff
IV_2:
  s_cmp_le_u32 s38, 2
  s_cbranch_scc1 IV_3
  v_mov_b32 v38, 0
  v_mov_b32 v34, 0xfff
IV_3:
  v_and_b32 v40, 0x3ff, v36
  v_bfe_u32 v44, v36, 10, 10
  v_bfe_u32 v48, v36, 20, 10
  v_and_b32 v41, 0x3ff, v37
  v_bfe_u32 v45, v37, 10, 10
  v_bfe_u32 v49, v37, 20, 10
  v_and_b32 v42, 0x3ff, v38
  v_bfe_u32 v46, v38, 10, 10
  v_bfe_u32 v50, v38, 20, 10
  v_and_b32 v43, 0x3ff, v39
  v_bfe_u32 v47, v39, 10, 10
  v_bfe_u32 v51, v39, 20, 10
  v_lshl_or_b32 v12, v44, 16, v40
  v_lshl_or_b32 v13, v45, 16, v41
  v_lshl_or_b32 v14, v46, 16, v42
  v_lshl_or_b32 v15, v47, 16, v43
  v_lshl_or_b32 v16, v49, 16, v48
  v_lshl_or_b32 v17, v51, 16, v50
  s_cmp_le_u32 s38, 0
  s_cselect_b32 s52, 0x00010001, 0
  s_cmp_le_u32 s38, 1
  s_cselect_b32 s53, 0x00010001, 0
  s_cmp_le_u32 s38, 2
  s_cselect_b32 s54, 0x00010001, 0
  s_mov_b32 s55, 0x00010001
  s_pack_ll_b32_b16 s56, s52, s53
  s_pack_ll_b32_b16 s57, s54, s55
  v_pk_max_u16 v12, v12, s52
  v_pk_max_u16 v13, v13, s53
  v_pk_max_u16 v14, v14, s54
  v_pk_max_u16 v15, v15, s55
  v_pk_max_u16 v16, v16, s56
  v_pk_max_u16 v17, v17, s57
  v_mov_b32_dpp v18, v12 row_shr:1 row_mask:0xf bank_mask:0xf bound_ctrl:0
  v_mov_b32_dpp v19, v13 row_shr:1 row_mask:0xf bank_mask:0xf bound_ctrl:0
  v_mov_b32_dpp v20, v14 row_shr:1 row_mask:0xf bank_mask:0xf bound_ctrl:0
  v_mov_b32_dpp v21, v15 row_shr:1 row_mask:0xf bank_mask:0xf bound_ctrl:0
  v_mov_b32_dpp v22, v16 row_shr:1 row_mask:0xf bank_mask:0xf bound_ctrl:0
  v_mov_b32_dpp v23, v17 row_shr:1 row_mask:0xf bank_mask:0xf bound_ctrl:0
  v_pk_max_u16 v12, v12, v18
  v_pk_max_u16 v13, v13, v19
  v_pk_max_u16 v14, v14, v20
  v_pk_max_u16 v15, v15, v21
  v_pk_max_u16 v16, v16, v22
  v_pk_max_u16 v17, v17, v23
  v_mov_b32_dpp v18, v12 row_shr:2 row_mask:0xf bank_mask:0xf bound_ctrl:0
  v_mov_b32_dpp v19, v13 row_shr:2 row_mask:0xf bank_mask:0xf bound_ctrl:0
  v_mov_b32_dpp v20, v14 row_shr:2 row_mask:0xf bank_mask:0xf bound_ctrl:0
  v_mov_b32_dpp v21, v15 row_shr:2 row_mask:0xf bank_mask:0xf bound_ctrl:0
  v_mov_b32_dpp v22, v16 row_shr:2 row_mask:0xf bank_mask:0xf bound_ctrl:0
  v_mov_b32_dpp v23, v17 row_shr:2 row_mask:0xf bank_mask:0xf bound_ctrl:0
  v_pk_max_u16 v12, v12, v18
  v_pk_max_u16 v13, v13, v19
  v_pk_max_u16 v14, v14, v20
  v_pk_max_u16 v15, v15, v21
  v_pk_max_u16 v16, v16, v22
  v_pk_max_u16 v17, v17, v23
  v_mov_b32_dpp v18, v12 row_shr:4 row_mask:0xf bank_mask:0xf bound_ctrl:0
  v_mov_b32_dpp v19, v13 row_shr:4 row_mask:0xf bank_mask:0xf bound_ctrl:0
  v_mov_b32_dpp v20, v14 row_shr:4 row_mask:0xf bank_mask:0xf bound_ctrl:0
  v_mov_b32_dpp v21, v15 row_shr:4 row_mask:0xf bank_mask:0xf bound_ctrl:0
  v_mov_b32_dpp v22, v16 row_shr:4 row_mask:0xf bank_mask:0xf bound_ctrl:0
  v_mov_b32_dpp v23, v17 row_shr:4 row_mask:0xf bank_mask:0xf bound_ctrl:0
  v_pk_max_u16 v12, v12, v18
  v_pk_max_u16 v13, v13, v19
  v_pk_max_u16 v14, v14, v20
  v_pk_max_u16 v15, v15, v21
  v_pk_max_u16 v16, v16, v22
  v_pk_max_u16 v17, v17, v23
  v_mov_b32_dpp v18, v12 row_shr:8 row_mask:0xf bank_mask:0xf bound_ctrl:0
  v_mov_b32_dpp v19, v13 row_shr:8 row_mask:0xf bank_mask:0xf bound_ctrl:0
  v_mov_b32_dpp v20, v14 row_shr:8 row_mask:0xf bank_mask:0xf bound_ctrl:0
  v_mov_b32_dpp v21, v15 row_shr:8 row_mask:0xf bank_mask:0xf bound_ctrl:0
  v_mov_b32_dpp v22, v16 row_shr:8 row_mask:0xf bank_mask:0xf bound_ctrl:0
  v_mov_b32_dpp v23, v17 row_shr:8 row_mask:0xf bank_mask:0xf bound_ctrl:0
  v_pk_max_u16 v12, v12, v18
  v_pk_max_u16 v13, v13, v19
  v_pk_max_u16 v14, v14, v20
  v_pk_max_u16 v15, v15, v21
  v_pk_max_u16 v16, v16, v22
  v_pk_max_u16 v17, v17, v23
  v_mov_b32 v18, 0
  v_mov_b32 v19, 0
  v_mov_b32 v20, 0
  v_mov_b32 v21, 0
  v_mov_b32 v22, 0
  v_mov_b32 v23, 0
  v_mov_b32_dpp v18, v12 row_bcast:15 row_mask:0xa bank_mask:0xf
  v_mov_b32_dpp v19, v13 row_bcast:15 row_mask:0xa bank_mask:0xf
  v_mov_b32_dpp v20, v14 row_bcast:15 row_mask:0xa bank_mask:0xf
  v_mov_b32_dpp v21, v15 row_bcast:15 row_mask:0xa bank_mask:0xf
  v_mov_b32_dpp v22, v16 row_bcast:15 row_mask:0xa bank_mask:0xf
  v_mov_b32_dpp v23, v17 row_bcast:15 row_mask:0xa bank_mask:0xf
  v_pk_max_u16 v12, v12, v18
  v_pk_max_u16 v13, v13, v19
  v_pk_max_u16 v14, v14, v20
  v_pk_max_u16 v15, v15, v21
  v_pk_max_u16 v16, v16, v22
  v_pk_max_u16 v17, v17, v23
  v_mov_b32 v18, 0
  v_mov_b32 v19, 0
  v_mov_b32 v20, 0
  v_mov_b32 v21, 0
  v_mov_b32 v22, 0
  v_mov_b32 v23, 0
  v_mov_b32_dpp v18, v12 row_bcast:31 row_mask:0xc bank_mask:0xf
  v_mov_b32_dpp v19, v13 row_bcast:31 row_mask:0xc bank_mask:0xf
  v_mov_b32_dpp v20, v14 row_bcast:31 row_mask:0xc bank_mask:0xf
  v_mov_b32_dpp v21, v15 row_bcast:31 row_mask:0xc bank_mask:0xf
  v_mov_b32_dpp v22, v16 row_bcast:31 row_mask:0xc bank_mask:0xf
  v_mov_b32_dpp v23, v17 row_bcast:31 row_mask:0xc bank_mask:0xf
  v_pk_max_u16 v12, v12, v18
  v_pk_max_u16 v13, v13, v19
  v_pk_max_u16 v14, v14, v20
  v_pk_max_u16 v15, v15, v21
  v_pk_max_u16 v16, v16, v22
  v_pk_max_u16 v17, v17, v23
  v_readlane_b32 s52, v12, 63
  v_readlane_b32 s53, v13, 63
  v_readlane_b32 s54, v14, 63
  v_readlane_b32 s55, v15, 63
  v_readlane_b32 s56, v16, 63
  v_readlane_b32 s57, v17, 63
  s_or_b32 s3, s52, s53
  s_or_b32 s3, s3, s54
  s_or_b32 s3, s3, s55
  s_or_b32 s3, s3, s56
  s_or_b32 s3, s3, s57
  s_and_b32 s3, s3, 0xffe0ffe0
  s_cselect_b32 s3, 1, 0
  s_or_b32 s49, s49, s3
  s_pack_ll_b32_b16 s64, s52, s54
  s_pack_ll_b32_b16 s65, s53, s55
  s_lshl_b32 s65, s65, 8
  s_or_b32 s64, s64, s65
  s_mul_i32 s64, s64, 0x01010101
  s_lshr_b32 s32, s64, 24
  s_add_u32 s64, s64, 0x1f1f1f1f
  s_mov_b32 s35, 0
  s_bitset1_b32 s35, s64
  s_lshr_b32 s65, s64, 8
  s_bitset1_b32 s35, s65
  s_lshr_b32 s65, s64, 16
  s_bitset1_b32 s35, s65
  s_lshr_b32 s65, s64, 24
  s_bitset1_b32 s35, s65
  s_cmp_gt_u32 s32, 18
  s_cselect_b32 s3, 1, 0
  s_or_b32 s49, s49, s3
  s_pack_hh_b32_b16 s64, s52, s54
  s_pack_hh_b32_b16 s65, s53, s55
  s_lshl_b32 s65, s65, 8
  s_or_b32 s64, s64, s65
  s_mul_i32 s64, s64, 0x01010101
  s_lshr_b32 s33, s64, 24
  s_add_u32 s64, s64, 0x1f1f1f1f
  s_mov_b32 s36, 0
  s_bitset1_b32 s36, s64
  s_lshr_b32 s65, s64, 8
  s_bitset1_b32 s36, s65
  s_lshr_b32 s65, s64, 16
  s_bitset1_b32 s36, s65
  s_lshr_b32 s65, s64, 24
  s_bitset1_b32 s36, s65
  s_cmp_gt_u32 s33, 18
  s_cselect_b32 s3, 1, 0
  s_or_b32 s49, s49, s3
  s_pack_ll_b32_b16 s64, s56, s57
  s_pack_hh_b32_b16 s65, s56, s57
  s_lshl_b32 s65, s65, 8
  s_or_b32 s64, s64, s65
  s_mul_i32 s64, s64, 0x01010101
  s_lshr_b32 s34, s64, 24
  s_add_u32 s64, s64, 0x1f1f1f1f
  s_mov_b32 s37, 0
  s_bitset1_b32 s37, s64
  s_lshr_b32 s65, s64, 8
  s_bitset1_b32 s37, s65
  s_lshr_b32 s65, s64, 16
  s_bitset1_b32 s37, s65
  s_lshr_b32 s65, s64, 24
  s_bitset1_b32 s37, s65
  s_cmp_gt_u32 s34, 20
  s_cselect_b32 s3, 1, 0
  s_or_b32 s49, s49, s3
  s_lshl_b32 s56, s22, 10
  s_cmp_eq_u32 s49, 0
  s_cbranch_scc1 K3_NOSF2
  v_mov_b32 v52, 160388
  v_mov_b32 v53, 1
  ds_write_b32 v52, v53
K3_NOSF2:
  v_and_b32 v2, 0xfff, v32
  v_add_u32 v6, s41, v2
  v_lshlrev_b32 v6, 1, v6
  v_cmp_eq_u32 vcc, 0xfff, v2
  v_mov_b32 v52, 0x7ffffff0
  s_nop 0
  v_cndmask_b32 v6, v6, v52, vcc
  buffer_load_ushort v6, v6, s[16:19], 0 offen
  v_and_b32 v3, 0xfff, v33
  v_add_u32 v7, s41, v3
  v_lshlrev_b32 v7, 1, v7
  v_cmp_eq_u32 vcc, 0xfff, v3
  v_mov_b32 v52, 0x7ffffff0
  s_nop 0
  v_cndmask_b32 v7, v7, v52, vcc
  buffer_load_ushort v7, v7, s[16:19], 0 offen
  v_and_b32 v4, 0xfff, v34
  v_add_u32 v8, s41, v4
  v_lshlrev_b32 v8, 1, v8
  v_cmp_eq_u32 vcc, 0xfff, v4
  v_mov_b32 v52, 0x7ffffff0
  s_nop 0
  v_cndmask_b32 v8, v8, v52, vcc
  buffer_load_ushort v8, v8, s[16:19], 0 offen
  v_and_b32 v5, 0xfff, v35
  v_add_u32 v9, s41, v5
  v_lshlrev_b32 v9, 1, v9
  v_cmp_eq_u32 vcc, 0xfff, v5
  v_mov_b32 v52, 0x7ffffff0
  s_nop 0
  v_cndmask_b32 v9, v9, v52, vcc
  buffer_load_ushort v9, v9, s[16:19], 0 offen
  v_lshrrev_b32 v28, 12, v32
  v_lshlrev_b32 v28, 1, v28
  v_lshrrev_b32 v29, 12, v33
  v_lshlrev_b32 v29, 1, v29
  v_lshrrev_b32 v30, 12, v34
  v_lshlrev_b32 v30, 1, v30
  v_lshrrev_b32 v31, 12, v35
  v_lshlrev_b32 v31, 1, v31
  v_mov_b32 v60, 160384
  v_mov_b32 v61, 0x4e004e00
  v_mov_b32 v16, v28
  v_lshl_add_u32 v28, v40, 2, v28
  v_mov_b32 v12, v28
  v_mov_b32 v17, v29
  v_lshl_add_u32 v29, v41, 2, v29
  v_mov_b32 v13, v29
  v_mov_b32 v18, v30
  v_lshl_add_u32 v30, v42, 2, v30
  v_mov_b32 v14, v30
  v_mov_b32 v19, v31
  v_lshl_add_u32 v31, v43, 2, v31
  v_mov_b32 v15, v31
  s_cmp_le_u32 s38, 0
  s_cbranch_scc1 IS_4
  v_mov_b32 v16, v17
  v_mov_b32 v12, v13
  v_mov_b32 v17, v18
  v_mov_b32 v13, v14
  v_mov_b32 v18, v19
  v_mov_b32 v14, v15
IS_4:
  s_cmp_le_u32 s38, 1
  s_cbranch_scc1 IS_5
  v_mov_b32 v16, v17
  v_mov_b32 v12, v13
  v_mov_b32 v17, v18
  v_mov_b32 v13, v14
  v_mov_b32 v18, v19
  v_mov_b32 v14, v15
IS_5:
  s_cmp_le_u32 s38, 2
  s_cbranch_scc1 IS_6
  v_mov_b32 v16, v17
  v_mov_b32 v12, v13
  v_mov_b32 v17, v18
  v_mov_b32 v13, v14
  v_mov_b32 v18, v19
  v_mov_b32 v14, v15
IS_6:
  v_mov_b32 v20, v16
  v_mov_b32 v22, v12
  v_cmp_lt_u32 vcc, v20, v22
  s_bitcmp1_b32 s35, 0
  v_add_u32 v21, 4, v20
  v_cndmask_b32 v23, v60, v20, vcc
  ds_read_b32 v72, v23
  s_cbranch_scc1 BU_0_0
BB_0_0:
  v_cmp_lt_u32 vcc, v21, v22
  s_bitcmp1_b32 s35, 1
  v_add_u32 v20, 4, v21
  v_cndmask_b32 v23, v60, v21, vcc
  ds_read_b32 v73, v23
  s_cbranch_scc1 BU_0_1
BB_0_1:
  v_cmp_lt_u32 vcc, v20, v22
  s_bitcmp1_b32 s35, 2
  v_add_u32 v21, 4, v20
  v_cndmask_b32 v23, v60, v20, vcc
  ds_read_b32 v74, v23
  s_cbranch_scc1 BU_0_2
BB_0_2:
  v_cmp_lt_u32 vcc, v21, v22
  s_bitcmp1_b32 s35, 3
  v_add_u32 v20, 4, v21
  v_cndmask_b32 v23, v60, v21, vcc
  ds_read_b32 v75, v23
  s_cbranch_scc1 BU_0_3
BB_0_3:
  v_cmp_lt_u32 vcc, v20, v22
  s_bitcmp1_b32 s35, 4
  v_add_u32 v21, 4, v20
  v_cndmask_b32 v23, v60, v20, vcc
  ds_read_b32 v76, v23
  s_cbranch_scc1 BU_0_4
BB_0_4:
  v_cmp_lt_u32 vcc, v21, v22
  s_bitcmp1_b32 s35, 5
  v_add_u32 v20, 4, v21
  v_cndmask_b32 v23, v60, v21, vcc
  ds_read_b32 v77, v23
  s_cbranch_scc1 BU_0_5
BB_0_5:
  v_cmp_lt_u32 vcc, v20, v22
  s_bitcmp1_b32 s35, 6
  v_add_u32 v21, 4, v20
  v_cndmask_b32 v23, v60, v20, vcc
  ds_read_b32 v78, v23
  s_cbranch_scc1 BU_0_6
BB_0_6:
  v_cmp_lt_u32 vcc, v21, v22
  s_bitcmp1_b32 s35, 7
  v_add_u32 v20, 4, v21
  v_cndmask_b32 v23, v60, v21, vcc
  ds_read_b32 v79, v23
  s_cbranch_scc1 BU_0_7
BB_0_7:
  s_waitcnt lgkmcnt(4)
  v_cmp_lt_u32 vcc, v20, v22
  s_bitcmp1_b32 s35, 8
  v_add_u32 v21, 4, v20
  v_cndmask_b32 v23, v60, v20, vcc
  ds_read_b32 v80, v23
  s_cbranch_scc1 BU_0_8
BB_0_8:
  v_cmp_lt_u32 vcc, v21, v22
  s_bitcmp1_b32 s35, 9
  v_add_u32 v20, 4, v21
  v_cndmask_b32 v23, v60, v21, vcc
  ds_read_b32 v81, v23
  s_cbranch_scc1 BU_0_9
BB_0_9:
  v_cmp_lt_u32 vcc, v20, v22
  s_bitcmp1_b32 s35, 10
  v_add_u32 v21, 4, v20
  v_cndmask_b32 v23, v60, v20, vcc
  ds_read_b32 v82, v23
  s_cbranch_scc1 BU_0_10
BB_0_10:
  v_cmp_lt_u32 vcc, v21, v22
  s_bitcmp1_b32 s35, 11
  v_add_u32 v20, 4, v21
  v_cndmask_b32 v23, v60, v21, vcc
  ds_read_b32 v83, v23
  s_cbranch_scc1 BU_0_11
BB_0_11:
  v_cmp_lt_u32 vcc, v20, v22
  s_bitcmp1_b32 s35, 12
  v_add_u32 v21, 4, v20
  v_cndmask_b32 v23, v60, v20, vcc
  ds_read_b32 v84, v23
  s_cbranch_scc1 BU_0_12
BB_0_12:
  v_cmp_lt_u32 vcc, v21, v22
  s_bitcmp1_b32 s35, 13
  v_add_u32 v20, 4, v21
  v_cndmask_b32 v23, v60, v21, vcc
  ds_read_b32 v85, v23
  s_cbranch_scc1 BU_0_13
BB_0_13:
  v_cmp_lt_u32 vcc, v20, v22
  s_bitcmp1_b32 s35, 14
  v_add_u32 v21, 4, v20
  v_cndmask_b32 v23, v60, v20, vcc
  ds_read_b32 v86, v23
  s_cbranch_scc1 BU_0_14
BB_0_14:
  v_cmp_lt_u32 vcc, v21, v22
  s_bitcmp1_b32 s35, 15
  v_add_u32 v20, 4, v21
  v_cndmask_b32 v23, v60, v21, vcc
  ds_read_b32 v87, v23
  s_cbranch_scc1 BU_0_15
BB_0_15:
  s_waitcnt lgkmcnt(4)
  v_cmp_lt_u32 vcc, v20, v22
  s_bitcmp1_b32 s35, 16
  v_add_u32 v21, 4, v20
  v_cndmask_b32 v23, v60, v20, vcc
  ds_read_b32 v88, v23
  s_cbranch_scc1 BU_0_16
BB_0_16:
  v_cmp_lt_u32 vcc, v21, v22
  s_bitcmp1_b32 s35, 17
  v_add_u32 v20, 4, v21
  v_cndmask_b32 v23, v60, v21, vcc
  ds_read_b32 v89, v23
  s_cbranch_scc1 BU_0_17
BB_0_17:
  s_branch BF_0_18
BF_0_1:
  v_mov_b32 v73, v61
BF_0_2:
  v_mov_b32 v74, v61
BF_0_3:
  v_mov_b32 v75, v61
BF_0_4:
  v_mov_b32 v76, v61
BF_0_5:
  v_mov_b32 v77, v61
BF_0_6:
  v_mov_b32 v78, v61
BF_0_7:
  v_mov_b32 v79, v61
BF_0_8:
  v_mov_b32 v80, v61
BF_0_9:
  v_mov_b32 v81, v61
BF_0_10:
  v_mov_b32 v82, v61
BF_0_11:
  v_mov_b32 v83, v61
BF_0_12:
  v_mov_b32 v84, v61
BF_0_13:
  v_mov_b32 v85, v61
BF_0_14:
  v_mov_b32 v86, v61
BF_0_15:
  v_mov_b32 v87, v61
BF_0_16:
  v_mov_b32 v88, v61
BF_0_17:
  v_mov_b32 v89, v61
BF_0_18:
  v_mov_b32 v16, v28
  v_lshl_add_u32 v28, v44, 2, v28
  v_mov_b32 v12, v28
  v_mov_b32 v17, v29
  v_lshl_add_u32 v29, v45, 2, v29
  v_mov_b32 v13, v29
  v_mov_b32 v18, v30
  v_lshl_add_u32 v30, v46, 2, v30
  v_mov_b32 v14, v30
  v_mov_b32 v19, v31
  v_lshl_add_u32 v31, v47, 2, v31
  v_mov_b32 v15, v31
  s_cmp_le_u32 s38, 0
  s_cbranch_scc1 IS_7
  v_mov_b32 v16, v17
  v_mov_b32 v12, v13
  v_mov_b32 v17, v18
  v_mov_b32 v13, v14
  v_mov_b32 v18, v19
  v_mov_b32 v14, v15
IS_7:
  s_cmp_le_u32 s38, 1
  s_cbranch_scc1 IS_8
  v_mov_b32 v16, v17
  v_mov_b32 v12, v13
  v_mov_b32 v17, v18
  v_mov_b32 v13, v14
  v_mov_b32 v18, v19
  v_mov_b32 v14, v15
IS_8:
  s_cmp_le_u32 s38, 2
  s_cbranch_scc1 IS_9
  v_mov_b32 v16, v17
  v_mov_b32 v12, v13
  v_mov_b32 v17, v18
  v_mov_b32 v13, v14
  v_mov_b32 v18, v19
  v_mov_b32 v14, v15
IS_9:
  v_mov_b32 v20, v16
  v_mov_b32 v22, v12
  v_cmp_lt_u32 vcc, v20, v22
  s_bitcmp1_b32 s36, 0
  v_add_u32 v21, 4, v20
  v_cndmask_b32 v23, v60, v20, vcc
  ds_read_b32 v90, v23
  s_cbranch_scc1 BU_1_0
BB_1_0:
  v_cmp_lt_u32 vcc, v21, v22
  s_bitcmp1_b32 s36, 1
  v_add_u32 v20, 4, v21
  v_cndmask_b32 v23, v60, v21, vcc
  ds_read_b32 v91, v23
  s_cbranch_scc1 BU_1_1
BB_1_1:
  v_cmp_lt_u32 vcc, v20, v22
  s_bitcmp1_b32 s36, 2
  v_add_u32 v21, 4, v20
  v_cndmask_b32 v23, v60, v20, vcc
  ds_read_b32 v92, v23
  s_cbranch_scc1 BU_1_2
BB_1_2:
  v_cmp_lt_u32 vcc, v21, v22
  s_bitcmp1_b32 s36, 3
  v_add_u32 v20, 4, v21
  v_cndmask_b32 v23, v60, v21, vcc
  ds_read_b32 v93, v23
  s_cbranch_scc1 BU_1_3
BB_1_3:
  v_cmp_lt_u32 vcc, v20, v22
  s_bitcmp1_b32 s36, 4
  v_add_u32 v21, 4, v20
  v_cndmask_b32 v23, v60, v20, vcc
  ds_read_b32 v94, v23
  s_cbranch_scc1 BU_1_4
BB_1_4:
  v_cmp_lt_u32 vcc, v21, v22
  s_bitcmp1_b32 s36, 5
  v_add_u32 v20, 4, v21
  v_cndmask_b32 v23, v60, v21, vcc
  ds_read_b32 v95, v23
  s_cbranch_scc1 BU_1_5
BB_1_5:
  v_cmp_lt_u32 vcc, v20, v22
  s_bitcmp1_b32 s36, 6
  v_add_u32 v21, 4, v20
  v_cndmask_b32 v23, v60, v20, vcc
  ds_read_b32 v96, v23
  s_cbranch_scc1 BU_1_6
BB_1_6:
  v_cmp_lt_u32 vcc, v21, v22
  s_bitcmp1_b32 s36, 7
  v_add_u32 v20, 4, v21
  v_cndmask_b32 v23, v60, v21, vcc
  ds_read_b32 v97, v23
  s_cbranch_scc1 BU_1_7
BB_1_7:
  s_waitcnt lgkmcnt(4)
  v_cmp_lt_u32 vcc, v20, v22
  s_bitcmp1_b32 s36, 8
  v_add_u32 v21, 4, v20
  v_cndmask_b32 v23, v60, v20, vcc
  ds_read_b32 v98, v23
  s_cbranch_scc1 BU_1_8
BB_1_8:
  v_cmp_lt_u32 vcc, v21, v22
  s_bitcmp1_b32 s36, 9
  v_add_u32 v20, 4, v21
  v_cndmask_b32 v23, v60, v21, vcc
  ds_read_b32 v99, v23
  s_cbranch_scc1 BU_1_9
BB_1_9:
  v_cmp_lt_u32 vcc, v20, v22
  s_bitcmp1_b32 s36, 10
  v_add_u32 v21, 4, v20
  v_cndmask_b32 v23, v60, v20, vcc
  ds_read_b32 v100, v23
  s_cbranch_scc1 BU_1_10
BB_1_10:
  v_cmp_lt_u32 vcc, v21, v22
  s_bitcmp1_b32 s36, 11
  v_add_u32 v20, 4, v21
  v_cndmask_b32 v23, v60, v21, vcc
  ds_read_b32 v101, v23
  s_cbranch_scc1 BU_1_11
BB_1_11:
  v_cmp_lt_u32 vcc, v20, v22
  s_bitcmp1_b32 s36, 12
  v_add_u32 v21, 4, v20
  v_cndmask_b32 v23, v60, v20, vcc
  ds_read_b32 v102, v23
  s_cbranch_scc1 BU_1_12
BB_1_12:
  v_cmp_lt_u32 vcc, v21, v22
  s_bitcmp1_b32 s36, 13
  v_add_u32 v20, 4, v21
  v_cndmask_b32 v23, v60, v21, vcc
  ds_read_b32 v103, v23
  s_cbranch_scc1 BU_1_13
BB_1_13:
  v_cmp_lt_u32 vcc, v20, v22
  s_bitcmp1_b32 s36, 14
  v_add_u32 v21, 4, v20
  v_cndmask_b32 v23, v60, v20, vcc
  ds_read_b32 v104, v23
  s_cbranch_scc1 BU_1_14
BB_1_14:
  v_cmp_lt_u32 vcc, v21, v22
  s_bitcmp1_b32 s36, 15
  v_add_u32 v20, 4, v21
  v_cndmask_b32 v23, v60, v21, vcc
  ds_read_b32 v105, v23
  s_cbranch_scc1 BU_1_15
BB_1_15:
  s_waitcnt lgkmcnt(4)
  v_cmp_lt_u32 vcc, v20, v22
  s_bitcmp1_b32 s36, 16
  v_add_u32 v21, 4, v20
  v_cndmask_b32 v23, v60, v20, vcc
  ds_read_b32 v106, v23
  s_cbranch_scc1 BU_1_16
BB_1_16:
  v_cmp_lt_u32 vcc, v21, v22
  s_bitcmp1_b32 s36, 17
  v_add_u32 v20, 4, v21
  v_cndmask_b32 v23, v60, v21, vcc
  ds_read_b32 v107, v23
  s_cbranch_scc1 BU_1_17
BB_1_17:
  s_branch BF_1_18
BF_1_1:
  v_mov_b32 v91, v61
BF_1_2:
  v_mov_b32 v92, v61
BF_1_3:
  v_mov_b32 v93, v61
BF_1_4:
  v_mov_b32 v94, v61
BF_1_5:
  v_mov_b32 v95, v61
BF_1_6:
  v_mov_b32 v96, v61
BF_1_7:
  v_mov_b32 v97, v61
BF_1_8:
  v_mov_b32 v98, v61
BF_1_9:
  v_mov_b32 v99, v61
BF_1_10:
  v_mov_b32 v100, v61
BF_1_11:
  v_mov_b32 v101, v61
BF_1_12:
  v_mov_b32 v102, v61
BF_1_13:
  v_mov_b32 v103, v61
BF_1_14:
  v_mov_b32 v104, v61
BF_1_15:
  v_mov_b32 v105, v61
BF_1_16:
  v_mov_b32 v106, v61
BF_1_17:
  v_mov_b32 v107, v61
BF_1_18:
  v_mov_b32 v16, v28
  v_lshl_add_u32 v28, v48, 2, v28
  v_mov_b32 v12, v28
  v_mov_b32 v17, v29
  v_lshl_add_u32 v29, v49, 2, v29
  v_mov_b32 v13, v29
  v_mov_b32 v18, v30
  v_lshl_add_u32 v30, v50, 2, v30
  v_mov_b32 v14, v30
  v_mov_b32 v19, v31
  v_lshl_add_u32 v31, v51, 2, v31
  v_mov_b32 v15, v31
  s_cmp_le_u32 s38, 0
  s_cbranch_scc1 IS_10
  v_mov_b32 v16, v17
  v_mov_b32 v12, v13
  v_mov_b32 v17, v18
  v_mov_b32 v13, v14
  v_mov_b32 v18, v19
  v_mov_b32 v14, v15
IS_10:
  s_cmp_le_u32 s38, 1
  s_cbranch_scc1 IS_11
  v_mov_b32 v16, v17
  v_mov_b32 v12, v13
  v_mov_b32 v17, v18
  v_mov_b32 v13, v14
  v_mov_b32 v18, v19
  v_mov_b32 v14, v15
IS_11:
  s_cmp_le_u32 s38, 2
  s_cbranch_scc1 IS_12
  v_mov_b32 v16, v17
  v_mov_b32 v12, v13
  v_mov_b32 v17, v18
  v_mov_b32 v13, v14
  v_mov_b32 v18, v19
  v_mov_b32 v14, v15
IS_12:
  v_mov_b32 v20, v16
  v_mov_b32 v22, v12
  v_cmp_lt_u32 vcc, v20, v22
  s_bitcmp1_b32 s37, 0
  v_add_u32 v21, 4, v20
  v_cndmask_b32 v23, v60, v20, vcc
  ds_read_b32 v108, v23
  s_cbranch_scc1 BU_2_0
BB_2_0:
  v_cmp_lt_u32 vcc, v21, v22
  s_bitcmp1_b32 s37, 1
  v_add_u32 v20, 4, v21
  v_cndmask_b32 v23, v60, v21, vcc
  ds_read_b32 v109, v23
  s_cbranch_scc1 BU_2_1
BB_2_1:
  v_cmp_lt_u32 vcc, v20, v22
  s_bitcmp1_b32 s37, 2
  v_add_u32 v21, 4, v20
  v_cndmask_b32 v23, v60, v20, vcc
  ds_read_b32 v110, v23
  s_cbranch_scc1 BU_2_2
BB_2_2:
  v_cmp_lt_u32 vcc, v21, v22
  s_bitcmp1_b32 s37, 3
  v_add_u32 v20, 4, v21
  v_cndmask_b32 v23, v60, v21, vcc
  ds_read_b32 v111, v23
  s_cbranch_scc1 BU_2_3
BB_2_3:
  v_cmp_lt_u32 vcc, v20, v22
  s_bitcmp1_b32 s37, 4
  v_add_u32 v21, 4, v20
  v_cndmask_b32 v23, v60, v20, vcc
  ds_read_b32 v112, v23
  s_cbranch_scc1 BU_2_4
BB_2_4:
  v_cmp_lt_u32 vcc, v21, v22
  s_bitcmp1_b32 s37, 5
  v_add_u32 v20, 4, v21
  v_cndmask_b32 v23, v60, v21, vcc
  ds_read_b32 v113, v23
  s_cbranch_scc1 BU_2_5
BB_2_5:
  v_cmp_lt_u32 vcc, v20, v22
  s_bitcmp1_b32 s37, 6
  v_add_u32 v21, 4, v20
  v_cndmask_b32 v23, v60, v20, vcc
  ds_read_b32 v114, v23
  s_cbranch_scc1 BU_2_6
BB_2_6:
  v_cmp_lt_u32 vcc, v21, v22
  s_bitcmp1_b32 s37, 7
  v_add_u32 v20, 4, v21
  v_cndmask_b32 v23, v60, v21, vcc
  ds_read_b32 v115, v23
  s_cbranch_scc1 BU_2_7
BB_2_7:
  s_waitcnt lgkmcnt(4)
  v_cmp_lt_u32 vcc, v20, v22
  s_bitcmp1_b32 s37, 8
  v_add_u32 v21, 4, v20
  v_cndmask_b32 v23, v60, v20, vcc
  ds_read_b32 v116, v23
  s_cbranch_scc1 BU_2_8
BB_2_8:
  v_cmp_lt_u32 vcc, v21, v22
  s_bitcmp1_b32 s37, 9
  v_add_u32 v20, 4, v21
  v_cndmask_b32 v23, v60, v21, vcc
  ds_read_b32 v117, v23
  s_cbranch_scc1 BU_2_9
BB_2_9:
  v_cmp_lt_u32 vcc, v20, v22
  s_bitcmp1_b32 s37, 10
  v_add_u32 v21, 4, v20
  v_cndmask_b32 v23, v60, v20, vcc
  ds_read_b32 v118, v23
  s_cbranch_scc1 BU_2_10
BB_2_10:
  v_cmp_lt_u32 vcc, v21, v22
  s_bitcmp1_b32 s37, 11
  v_add_u32 v20, 4, v21
  v_cndmask_b32 v23, v60, v21, vcc
  ds_read_b32 v119, v23
  s_cbranch_scc1 BU_2_11
BB_2_11:
  v_cmp_lt_u32 vcc, v20, v22
  s_bitcmp1_b32 s37, 12
  v_add_u32 v21, 4, v20
  v_cndmask_b32 v23, v60, v20, vcc
  ds_read_b32 v120, v23
  s_cbranch_scc1 BU_2_12
BB_2_12:
  v_cmp_lt_u32 vcc, v21, v22
  s_bitcmp1_b32 s37, 13
  v_add_u32 v20, 4, v21
  v_cndmask_b32 v23, v60, v21, vcc
  ds_read_b32 v121, v23
  s_cbranch_scc1 BU_2_13
BB_2_13:
  v_cmp_lt_u32 vcc, v20, v22
  s_bitcmp1_b32 s37, 14
  v_add_u32 v21, 4, v20
  v_cndmask_b32 v23, v60, v20, vcc
  ds_read_b32 v122, v23
  s_cbranch_scc1 BU_2_14
BB_2_14:
  v_cmp_lt_u32 vcc, v21, v22
  s_bitcmp1_b32 s37, 15
  v_add_u32 v20, 4, v21
  v_cndmask_b32 v23, v60, v21, vcc
  ds_read_b32 v123, v23
  s_cbranch_scc1 BU_2_15
BB_2_15:
  s_waitcnt lgkmcnt(4)
  v_cmp_lt_u32 vcc, v20, v22
  s_bitcmp1_b32 s37, 16
  v_add_u32 v21, 4, v20
  v_cndmask_b32 v23, v60, v20, vcc
  ds_read_b32 v124, v23
  s_cbranch_scc1 BU_2_16
BB_2_16:
  v_cmp_lt_u32 vcc, v21, v22
  s_bitcmp1_b32 s37, 17
  v_add_u32 v20, 4, v21
  v_cndmask_b32 v23, v60, v21, vcc
  ds_read_b32 v125, v23
  s_cbranch_scc1 BU_2_17
BB_2_17:
  v_cmp_lt_u32 vcc, v20, v22
  s_bitcmp1_b32 s37, 18
  v_add_u32 v21, 4, v20
  v_cndmask_b32 v23, v60, v20, vcc
  ds_read_b32 v126, v23
  s_cbranch_scc1 BU_2_18
BB_2_18:
  v_cmp_lt_u32 vcc, v21, v22
  s_bitcmp1_b32 s37, 19
  v_add_u32 v20, 4, v21
  v_cndmask_b32 v23, v60, v21, vcc
  ds_read_b32 v127, v23
  s_cbranch_scc1 BU_2_19
BB_2_19:
  s_branch BF_2_20
BF_2_1:
  v_mov_b32 v109, v61
BF_2_2:
  v_mov_b32 v110, v61
BF_2_3:
  v_mov_b32 v111, v61
BF_2_4:
  v_mov_b32 v112, v61
BF_2_5:
  v_mov_b32 v113, v61
BF_2_6:
  v_mov_b32 v114, v61
BF_2_7:
  v_mov_b32 v115, v61
BF_2_8:
  v_mov_b32 v116, v61
BF_2_9:
  v_mov_b32 v117, v61
BF_2_10:
  v_mov_b32 v118, v61
BF_2_11:
  v_mov_b32 v119, v61
BF_2_12:
  v_mov_b32 v120, v61
BF_2_13:
  v_mov_b32 v121, v61
BF_2_14:
  v_mov_b32 v122, v61
BF_2_15:
  v_mov_b32 v123, v61
BF_2_16:
  v_mov_b32 v124, v61
BF_2_17:
  v_mov_b32 v125, v61
BF_2_18:
  v_mov_b32 v126, v61
BF_2_19:
  v_mov_b32 v127, v61
BF_2_20:
  s_waitcnt lgkmcnt(0)
  s_barrier
  v_mov_b32 v52, 160388
  ds_read_b32 v53, v52
  s_waitcnt lgkmcnt(0)
  v_readfirstlane_b32 s49, v53
  s_cmp_eq_u32 s49, 0
  s_cbranch_scc1 K3_SETUP2
  s_waitcnt vmcnt(0)
K3_SLOWSETUP:
  s_add_u32 s3, s22, 0
  s_lshl_b32 s3, s3, 6
  v_add_u32 v2, s3, v1
  v_cmp_gt_u32 vcc, 3136, v2
  v_mov_b32 v46, 0xfff
  s_nop 0
  v_cndmask_b32 v2, v46, v2, vcc
  s_add_u32 s3, s22, 16
  s_lshl_b32 s3, s3, 6
  v_add_u32 v3, s3, v1
  v_cmp_gt_u32 vcc, 3136, v3
  v_mov_b32 v46, 0xfff
  s_nop 0
  v_cndmask_b32 v3, v46, v3, vcc
  s_add_u32 s3, s22, 32
  s_lshl_b32 s3, s3, 6
  v_add_u32 v4, s3, v1
  v_cmp_gt_u32 vcc, 3136, v4
  v_mov_b32 v46, 0xfff
  s_nop 0
  v_cndmask_b32 v4, v46, v4, vcc
  s_add_u32 s3, s22, 48
  s_lshl_b32 s3, s3, 6
  v_add_u32 v5, s3, v1
  v_cmp_gt_u32 vcc, 3136, v5
  v_mov_b32 v46, 0xfff
  s_nop 0
  v_cndmask_b32 v5, v46, v5, vcc
  v_add_u32 v6, s41, v2
  v_lshlrev_b32 v6, 1, v6
  v_cmp_eq_u32 vcc, 0xfff, v2
  v_mov_b32 v52, 0x7ffffff0
  s_nop 0
  v_cndmask_b32 v6, v6, v52, vcc
  buffer_load_ushort v6, v6, s[16:19], 0 offen
  v_add_u32 v7, s41, v3
  v_lshlrev_b32 v7, 1, v7
  v_cmp_eq_u32 vcc, 0xfff, v3
  v_mov_b32 v52, 0x7ffffff0
  s_nop 0
  v_cndmask_b32 v7, v7, v52, vcc
  buffer_load_ushort v7, v7, s[16:19], 0 offen
  v_add_u32 v8, s41, v4
  v_lshlrev_b32 v8, 1, v8
  v_cmp_eq_u32 vcc, 0xfff, v4
  v_mov_b32 v52, 0x7ffffff0
  s_nop 0
  v_cndmask_b32 v8, v8, v52, vcc
  buffer_load_ushort v8, v8, s[16:19], 0 offen
  v_add_u32 v9, s41, v5
  v_lshlrev_b32 v9, 1, v9
  v_cmp_eq_u32 vcc, 0xfff, v5
  v_mov_b32 v52, 0x7ffffff0
  s_nop 0
  v_cndmask_b32 v9, v9, v52, vcc
  buffer_load_ushort v9, v9, s[16:19], 0 offen
K3_SETUP2:
  v_cmp_eq_u32 vcc, 0xfff, v2
  v_lshlrev_b32 v2, 3, v2
  v_add_u32 v2, 79872, v2
  v_mov_b32 v57, 104960
  v_cndmask_b32 v2, v2, v57, vcc
  v_cmp_eq_u32 vcc, 0xfff, v3
  v_lshlrev_b32 v3, 3, v3
  v_add_u32 v3, 79872, v3
  v_mov_b32 v57, 104960
  v_cndmask_b32 v3, v3, v57, vcc
  v_cmp_eq_u32 vcc, 0xfff, v4
  v_lshlrev_b32 v4, 3, v4
  v_add_u32 v4, 79872, v4
  v_mov_b32 v57, 104960
  v_cndmask_b32 v4, v4, v57, vcc
  v_cmp_eq_u32 vcc, 0xfff, v5
  v_lshlrev_b32 v5, 3, v5
  v_add_u32 v5, 79872, v5
  v_mov_b32 v57, 104960
  v_cndmask_b32 v5, v5, v57, vcc
  v_and_b32 v70, 7, v1
  v_lshlrev_b32 v70, 2, v70
  v_add_u32 v70, s45, v70
  global_load_dword v71, v70, s[4:5] sc1
  s_mov_b32 s50, 2
  s_waitcnt vmcnt(1)
  v_lshlrev_b32 v6, 16, v6
  v_lshlrev_b32 v7, 16, v7
  v_lshlrev_b32 v8, 16, v8
  v_lshlrev_b32 v9, 16, v9
  v_and_b32 v65, 0xffff0000, v64
  v_lshlrev_b32 v64, 16, v64
  v_and_b32 v67, 0xffff0000, v66
  v_lshlrev_b32 v66, 16, v66
  v_lshrrev_b32 v56, 4, v1
  v_bfe_u32 v57, v1, 2, 2
  v_and_b32 v58, 1, v1
  v_lshlrev_b32 v58, 4, v58
  v_mov_b32 v59, 0x3f80
  v_lshlrev_b32 v59, v58, v59
  v_cmp_eq_u32 vcc, v56, v57
  s_nop 1
  v_cndmask_b32 v59, 0, v59, vcc
  v_bfe_u32 v58, v1, 1, 1
  v_cmp_eq_u32 vcc, 0, v58
  v_mov_b32 v60, 0
  s_nop 0
  v_cndmask_b32 v28, 0, v59, vcc
  v_cndmask_b32 v29, v59, v60, vcc
  v_mov_b32 v30, v28
  v_mov_b32 v31, v29
  v_lshlrev_b32 v11, 4, v0
  v_add_u32 v11, 79872, v11
  v_lshlrev_b32 v62, 7, v0
  s_lshl_b32 s3, s41, 3
  v_add_u32 v62, s3, v62
  v_cmp_gt_u32 vcc, 196, v0
  v_mov_b32 v61, 0x7ffffff0
  s_nop 0
  v_cndmask_b32 v62, v61, v62, vcc
  s_lshl_b32 s3, s20, 8
  s_add_u32 s66, s3, 68250112
  s_lshl_b32 s3, s21, 5
  s_add_u32 s67, s66, s3
  s_mov_b32 s11, 0x20000
  s_mov_b32 s15, 0x20000
  s_mov_b32 s27, 0x20000
  s_mov_b32 s10, 202752
  s_mov_b32 s14, 200000
  s_mov_b32 s26, 200000
  s_mov_b32 s23, 0
  s_lshl_b32 s56, s22, 10
  s_mov_b32 s51, 0xffff0000
  v_mov_b32 v56, 159744
  v_mov_b32 v58, 0
  v_mov_b32 v59, 0
  ds_write_b64 v56, v[58:59]
  s_waitcnt lgkmcnt(0)
K3_HOP:
  s_and_b32 s69, s23, 1
  s_lshl_b32 s3, s69, 5
  s_add_u32 s3, s3, s20
  s_mul_i32 s3, s3, 202752
  s_add_u32 s8, s4, s3
  s_addc_u32 s9, s5, 0
  s_xor_b32 s69, s69, 1
  s_lshl_b32 s3, s69, 5
  s_add_u32 s3, s3, s20
  s_mul_i32 s3, s3, 202752
  s_add_u32 s12, s4, s3
  s_addc_u32 s13, s5, 0
  s_add_u32 s3, s23, 1
  s_lshl_b32 s3, s3, 5
  s_add_u32 s3, s3, s20
  s_mul_i32 s3, s3, 202752
  s_add_u32 s3, s3, 12976128
  s_add_u32 s24, s4, s3
  s_addc_u32 s25, s5, 0
  s_cmp_lg_u32 s49, 0
  s_cbranch_scc1 K3_SLOWHOP
  s_lshl_b32 s3, s22, 10
  s_add_u32 m0, s3, 0
  s_add_u32 s3, s3, 0
  buffer_load_dwordx4 v10, s[8:11], s3 offen sc1 lds
  s_lshl_b32 s3, s22, 10
  s_add_u32 m0, s3, 16384
  s_add_u32 s3, s3, 16384
  buffer_load_dwordx4 v10, s[8:11], s3 offen sc1 lds
  s_cmp_ge_u32 s22, 8
  s_cbranch_scc1 DS_13
  s_lshl_b32 s3, s22, 10
  s_add_u32 m0, s3, 32768
  s_add_u32 s3, s3, 32768
  buffer_load_dwordx4 v10, s[8:11], s3 offen sc1 lds
DS_13:
  v_mov_b32 v12, 0
  v_mov_b32 v13, 0
  v_mov_b32 v14, 0
  v_mov_b32 v15, 0
  v_mov_b32 v16, 0
  v_mov_b32 v17, 0
  v_mov_b32 v18, 0
  v_mov_b32 v19, 0
  v_mov_b32 v20, 0
  v_mov_b32 v21, 0
  v_mov_b32 v22, 0
  v_mov_b32 v23, 0
  v_mov_b32 v24, 0
  v_mov_b32 v25, 0
  v_mov_b32 v26, 0
  v_mov_b32 v27, 0
  s_waitcnt vmcnt(0)
  s_barrier
  s_mov_b32 s54, s35
  s_setprio 3
  v_lshlrev_b32_sdwa v56, 3, v72 dst_sel:DWORD dst_unused:UNUSED_PAD src0_sel:DWORD src1_sel:WORD_0
  v_lshlrev_b32_sdwa v57, 3, v72 dst_sel:DWORD dst_unused:UNUSED_PAD src0_sel:DWORD src1_sel:WORD_1
  v_lshlrev_b32_sdwa v58, 3, v73 dst_sel:DWORD dst_unused:UNUSED_PAD src0_sel:DWORD src1_sel:WORD_0
  v_lshlrev_b32_sdwa v59, 3, v73 dst_sel:DWORD dst_unused:UNUSED_PAD src0_sel:DWORD src1_sel:WORD_1
  ds_read_b64 v[32:33], v56
  ds_read_b64 v[34:35], v57
  ds_read_b64 v[36:37], v58
  ds_read_b64 v[38:39], v59
  s_cmp_ge_u32 s22, 14
  s_cbranch_scc1 DR_14
  s_add_u32 m0, s56, 145408
  s_add_u32 s3, s56, 106496
  buffer_load_dwordx4 v10, s[8:11], s3 offen sc1 lds
DR_14:
  s_cmp_eq_u32 s38, 1
  s_cbranch_scc1 E_0_1_0
  s_cmp_eq_u32 s38, 2
  s_cbranch_scc1 E_0_2_0
  s_cmp_eq_u32 s38, 3
  s_cbranch_scc1 E_0_3_0
E_0_0_0:
  v_lshlrev_b32_sdwa v56, 3, v74 dst_sel:DWORD dst_unused:UNUSED_PAD src0_sel:DWORD src1_sel:WORD_0
  v_lshlrev_b32_sdwa v57, 3, v74 dst_sel:DWORD dst_unused:UNUSED_PAD src0_sel:DWORD src1_sel:WORD_1
  v_lshlrev_b32_sdwa v58, 3, v75 dst_sel:DWORD dst_unused:UNUSED_PAD src0_sel:DWORD src1_sel:WORD_0
  v_lshlrev_b32_sdwa v59, 3, v75 dst_sel:DWORD dst_unused:UNUSED_PAD src0_sel:DWORD src1_sel:WORD_1
  ds_read_b64 v[40:41], v56
  ds_read_b64 v[42:43], v57
  ds_read_b64 v[44:45], v58
  ds_read_b64 v[46:47], v59
  s_add_u32 m0, s56, 79872
  s_add_u32 s3, s56, 40960
  buffer_load_dwordx4 v10, s[8:11], s3 offen sc1 lds
  s_waitcnt lgkmcnt(4)
  v_mfma_f32_16x16x32_bf16 v[12:15], v[28:31], v[32:35], v[12:15]
  s_bitcmp1_b32 s54, 0
  s_cbranch_scc1 E_0_1_1
E_0_0_1:
  v_mfma_f32_16x16x32_bf16 v[12:15], v[28:31], v[36:39], v[12:15]
  s_bitcmp1_b32 s54, 1
  s_cbranch_scc1 E_0_1_2
E_0_0_2:
  v_lshlrev_b32_sdwa v56, 3, v76 dst_sel:DWORD dst_unused:UNUSED_PAD src0_sel:DWORD src1_sel:WORD_0
  v_lshlrev_b32_sdwa v57, 3, v76 dst_sel:DWORD dst_unused:UNUSED_PAD src0_sel:DWORD src1_sel:WORD_1
  v_lshlrev_b32_sdwa v58, 3, v77 dst_sel:DWORD dst_unused:UNUSED_PAD src0_sel:DWORD src1_sel:WORD_0
  v_lshlrev_b32_sdwa v59, 3, v77 dst_sel:DWORD dst_unused:UNUSED_PAD src0_sel:DWORD src1_sel:WORD_1
  ds_read_b64 v[32:33], v56
  ds_read_b64 v[34:35], v57
  ds_read_b64 v[36:37], v58
  ds_read_b64 v[38:39], v59
  s_add_u32 m0, s56, 96256
  s_add_u32 s3, s56, 57344
  buffer_load_dwordx4 v10, s[8:11], s3 offen sc1 lds
  s_waitcnt lgkmcnt(4)
  v_mfma_f32_16x16x32_bf16 v[12:15], v[28:31], v[40:43], v[12:15]
  s_bitcmp1_b32 s54, 2
  s_cbranch_scc1 E_0_1_3
E_0_0_3:
  v_mfma_f32_16x16x32_bf16 v[12:15], v[28:31], v[44:47], v[12:15]
  s_bitcmp1_b32 s54, 3
  s_cbranch_scc1 E_0_1_4
E_0_0_4:
  s_setprio 2
  v_lshlrev_b32_sdwa v56, 3, v78 dst_sel:DWORD dst_unused:UNUSED_PAD src0_sel:DWORD src1_sel:WORD_0
  v_lshlrev_b32_sdwa v57, 3, v78 dst_sel:DWORD dst_unused:UNUSED_PAD src0_sel:DWORD src1_sel:WORD_1
  v_lshlrev_b32_sdwa v58, 3, v79 dst_sel:DWORD dst_unused:UNUSED_PAD src0_sel:DWORD src1_sel:WORD_0
  v_lshlrev_b32_sdwa v59, 3, v79 dst_sel:DWORD dst_unused:UNUSED_PAD src0_sel:DWORD src1_sel:WORD_1
  ds_read_b64 v[40:41], v56
  ds_read_b64 v[42:43], v57
  ds_read_b64 v[44:45], v58
  ds_read_b64 v[46:47], v59
  s_add_u32 m0, s56, 112640
  s_add_u32 s3, s56, 73728
  buffer_load_dwordx4 v10, s[8:11], s3 offen sc1 lds
  s_waitcnt lgkmcnt(4)
  v_mfma_f32_16x16x32_bf16 v[12:15], v[28:31], v[32:35], v[12:15]
  s_bitcmp1_b32 s54, 4
  s_cbranch_scc1 E_0_1_5
E_0_0_5:
  v_mfma_f32_16x16x32_bf16 v[12:15], v[28:31], v[36:39], v[12:15]
  s_bitcmp1_b32 s54, 5
  s_cbranch_scc1 E_0_1_6
E_0_0_6:
  v_lshlrev_b32_sdwa v56, 3, v80 dst_sel:DWORD dst_unused:UNUSED_PAD src0_sel:DWORD src1_sel:WORD_0
  v_lshlrev_b32_sdwa v57, 3, v80 dst_sel:DWORD dst_unused:UNUSED_PAD src0_sel:DWORD src1_sel:WORD_1
  v_lshlrev_b32_sdwa v58, 3, v81 dst_sel:DWORD dst_unused:UNUSED_PAD src0_sel:DWORD src1_sel:WORD_0
  v_lshlrev_b32_sdwa v59, 3, v81 dst_sel:DWORD dst_unused:UNUSED_PAD src0_sel:DWORD src1_sel:WORD_1
  ds_read_b64 v[32:33], v56
  ds_read_b64 v[34:35], v57
  ds_read_b64 v[36:37], v58
  ds_read_b64 v[38:39], v59
  s_add_u32 m0, s56, 129024
  s_add_u32 s3, s56, 90112
  buffer_load_dwordx4 v10, s[8:11], s3 offen sc1 lds
  s_waitcnt lgkmcnt(4)
  v_mfma_f32_16x16x32_bf16 v[12:15], v[28:31], v[40:43], v[12:15]
  s_bitcmp1_b32 s54, 6
  s_cbranch_scc1 E_0_1_7
E_0_0_7:
  v_mfma_f32_16x16x32_bf16 v[12:15], v[28:31], v[44:47], v[12:15]
  s_bitcmp1_b32 s54, 7
  s_cbranch_scc1 E_0_1_8
E_0_0_8:
  s_setprio 1
  v_lshlrev_b32_sdwa v56, 3, v82 dst_sel:DWORD dst_unused:UNUSED_PAD src0_sel:DWORD src1_sel:WORD_0
  v_lshlrev_b32_sdwa v57, 3, v82 dst_sel:DWORD dst_unused:UNUSED_PAD src0_sel:DWORD src1_sel:WORD_1
  v_lshlrev_b32_sdwa v58, 3, v83 dst_sel:DWORD dst_unused:UNUSED_PAD src0_sel:DWORD src1_sel:WORD_0
  v_lshlrev_b32_sdwa v59, 3, v83 dst_sel:DWORD dst_unused:UNUSED_PAD src0_sel:DWORD src1_sel:WORD_1
  ds_read_b64 v[40:41], v56
  ds_read_b64 v[42:43], v57
  ds_read_b64 v[44:45], v58
  ds_read_b64 v[46:47], v59
  s_waitcnt lgkmcnt(4)
  v_mfma_f32_16x16x32_bf16 v[12:15], v[28:31], v[32:35], v[12:15]
  s_bitcmp1_b32 s54, 8
  s_cbranch_scc1 E_0_1_9
E_0_0_9:
  v_mfma_f32_16x16x32_bf16 v[12:15], v[28:31], v[36:39], v[12:15]
  s_bitcmp1_b32 s54, 9
  s_cbranch_scc1 E_0_1_10
E_0_0_10:
  v_lshlrev_b32_sdwa v56, 3, v84 dst_sel:DWORD dst_unused:UNUSED_PAD src0_sel:DWORD src1_sel:WORD_0
  v_lshlrev_b32_sdwa v57, 3, v84 dst_sel:DWORD dst_unused:UNUSED_PAD src0_sel:DWORD src1_sel:WORD_1
  v_lshlrev_b32_sdwa v58, 3, v85 dst_sel:DWORD dst_unused:UNUSED_PAD src0_sel:DWORD src1_sel:WORD_0
  v_lshlrev_b32_sdwa v59, 3, v85 dst_sel:DWORD dst_unused:UNUSED_PAD src0_sel:DWORD src1_sel:WORD_1
  ds_read_b64 v[32:33], v56
  ds_read_b64 v[34:35], v57
  ds_read_b64 v[36:37], v58
  ds_read_b64 v[38:39], v59
  s_waitcnt lgkmcnt(4)
  v_mfma_f32_16x16x32_bf16 v[12:15], v[28:31], v[40:43], v[12:15]
  s_bitcmp1_b32 s54, 10
  s_cbranch_scc1 E_0_1_11
E_0_0_11:
  v_mfma_f32_16x16x32_bf16 v[12:15], v[28:31], v[44:47], v[12:15]
  s_bitcmp1_b32 s54, 11
  s_cbranch_scc1 E_0_1_12
E_0_0_12:
  s_setprio 0
  v_lshlrev_b32_sdwa v56, 3, v86 dst_sel:DWORD dst_unused:UNUSED_PAD src0_sel:DWORD src1_sel:WORD_0
  v_lshlrev_b32_sdwa v57, 3, v86 dst_sel:DWORD dst_unused:UNUSED_PAD src0_sel:DWORD src1_sel:WORD_1
  v_lshlrev_b32_sdwa v58, 3, v87 dst_sel:DWORD dst_unused:UNUSED_PAD src0_sel:DWORD src1_sel:WORD_0
  v_lshlrev_b32_sdwa v59, 3, v87 dst_sel:DWORD dst_unused:UNUSED_PAD src0_sel:DWORD src1_sel:WORD_1
  ds_read_b64 v[40:41], v56
  ds_read_b64 v[42:43], v57
  ds_read_b64 v[44:45], v58
  ds_read_b64 v[46:47], v59
  s_waitcnt lgkmcnt(4)
  v_mfma_f32_16x16x32_bf16 v[12:15], v[28:31], v[32:35], v[12:15]
  s_bitcmp1_b32 s54, 12
  s_cbranch_scc1 E_0_1_13
E_0_0_13:
  v_mfma_f32_16x16x32_bf16 v[12:15], v[28:31], v[36:39], v[12:15]
  s_bitcmp1_b32 s54, 13
  s_cbranch_scc1 E_0_1_14
E_0_0_14:
  v_lshlrev_b32_sdwa v56, 3, v88 dst_sel:DWORD dst_unused:UNUSED_PAD src0_sel:DWORD src1_sel:WORD_0
  v_lshlrev_b32_sdwa v57, 3, v88 dst_sel:DWORD dst_unused:UNUSED_PAD src0_sel:DWORD src1_sel:WORD_1
  v_lshlrev_b32_sdwa v58, 3, v89 dst_sel:DWORD dst_unused:UNUSED_PAD src0_sel:DWORD src1_sel:WORD_0
  v_lshlrev_b32_sdwa v59, 3, v89 dst_sel:DWORD dst_unused:UNUSED_PAD src0_sel:DWORD src1_sel:WORD_1
  ds_read_b64 v[32:33], v56
  ds_read_b64 v[34:35], v57
  ds_read_b64 v[36:37], v58
  ds_read_b64 v[38:39], v59
  s_waitcnt lgkmcnt(4)
  v_mfma_f32_16x16x32_bf16 v[12:15], v[28:31], v[40:43], v[12:15]
  s_bitcmp1_b32 s54, 14
  s_cbranch_scc1 E_0_1_15
E_0_0_15:
  v_mfma_f32_16x16x32_bf16 v[12:15], v[28:31], v[44:47], v[12:15]
  s_bitcmp1_b32 s54, 15
  s_cbranch_scc1 E_0_1_16
E_0_0_16:
  s_waitcnt lgkmcnt(0)
  v_mfma_f32_16x16x32_bf16 v[12:15], v[28:31], v[32:35], v[12:15]
  s_bitcmp1_b32 s54, 16
  s_cbranch_scc1 E_0_1_17
E_0_0_17:
  v_mfma_f32_16x16x32_bf16 v[12:15], v[28:31], v[36:39], v[12:15]
  s_branch PE_0
PE_0:
  s_setprio 0
  s_cmp_gt_u32 s32, 2
  s_cbranch_scc1 DR_15
  s_add_u32 m0, s56, 96256
  s_add_u32 s3, s56, 57344
  buffer_load_dwordx4 v10, s[8:11], s3 offen sc1 lds
DR_15:
  s_cmp_gt_u32 s32, 4
  s_cbranch_scc1 DR_16
  s_add_u32 m0, s56, 112640
  s_add_u32 s3, s56, 73728
  buffer_load_dwordx4 v10, s[8:11], s3 offen sc1 lds
DR_16:
  s_cmp_gt_u32 s32, 6
  s_cbranch_scc1 DR_17
  s_add_u32 m0, s56, 129024
  s_add_u32 s3, s56, 90112
  buffer_load_dwordx4 v10, s[8:11], s3 offen sc1 lds
DR_17:
  s_waitcnt lgkmcnt(0)
  s_waitcnt vmcnt(0)
  s_barrier
  s_mov_b32 s54, s36
  s_setprio 3
  v_lshlrev_b32_sdwa v56, 3, v90 dst_sel:DWORD dst_unused:UNUSED_PAD src0_sel:DWORD src1_sel:WORD_0
  v_lshlrev_b32_sdwa v57, 3, v90 dst_sel:DWORD dst_unused:UNUSED_PAD src0_sel:DWORD src1_sel:WORD_1
  v_lshlrev_b32_sdwa v58, 3, v91 dst_sel:DWORD dst_unused:UNUSED_PAD src0_sel:DWORD src1_sel:WORD_0
  v_lshlrev_b32_sdwa v59, 3, v91 dst_sel:DWORD dst_unused:UNUSED_PAD src0_sel:DWORD src1_sel:WORD_1
  ds_read_b64 v[32:33], v56
  ds_read_b64 v[34:35], v57
  ds_read_b64 v[36:37], v58
  ds_read_b64 v[38:39], v59
  s_cmp_ge_u32 s22, 14
  s_cbranch_scc1 DR_18
  s_add_u32 m0, s56, 65536
  s_add_u32 s3, s56, 186368
  buffer_load_dwordx4 v10, s[8:11], s3 offen sc1 lds
DR_18:
  s_cmp_eq_u32 s38, 1
  s_cbranch_scc1 E_1_1_0
  s_cmp_eq_u32 s38, 2
  s_cbranch_scc1 E_1_2_0
  s_cmp_eq_u32 s38, 3
  s_cbranch_scc1 E_1_3_0
E_1_0_0:
  v_lshlrev_b32_sdwa v56, 3, v92 dst_sel:DWORD dst_unused:UNUSED_PAD src0_sel:DWORD src1_sel:WORD_0
  v_lshlrev_b32_sdwa v57, 3, v92 dst_sel:DWORD dst_unused:UNUSED_PAD src0_sel:DWORD src1_sel:WORD_1
  v_lshlrev_b32_sdwa v58, 3, v93 dst_sel:DWORD dst_unused:UNUSED_PAD src0_sel:DWORD src1_sel:WORD_0
  v_lshlrev_b32_sdwa v59, 3, v93 dst_sel:DWORD dst_unused:UNUSED_PAD src0_sel:DWORD src1_sel:WORD_1
  ds_read_b64 v[40:41], v56
  ds_read_b64 v[42:43], v57
  ds_read_b64 v[44:45], v58
  ds_read_b64 v[46:47], v59
  s_add_u32 m0, s56, 0
  s_add_u32 s3, s56, 120832
  buffer_load_dwordx4 v10, s[8:11], s3 offen sc1 lds
  s_waitcnt lgkmcnt(4)
  v_mfma_f32_16x16x32_bf16 v[12:15], v[28:31], v[32:35], v[12:15]
  s_bitcmp1_b32 s54, 0
  s_cbranch_scc1 E_1_1_1
E_1_0_1:
  v_mfma_f32_16x16x32_bf16 v[12:15], v[28:31], v[36:39], v[12:15]
  s_bitcmp1_b32 s54, 1
  s_cbranch_scc1 E_1_1_2
E_1_0_2:
  v_lshlrev_b32_sdwa v56, 3, v94 dst_sel:DWORD dst_unused:UNUSED_PAD src0_sel:DWORD src1_sel:WORD_0
  v_lshlrev_b32_sdwa v57, 3, v94 dst_sel:DWORD dst_unused:UNUSED_PAD src0_sel:DWORD src1_sel:WORD_1
  v_lshlrev_b32_sdwa v58, 3, v95 dst_sel:DWORD dst_unused:UNUSED_PAD src0_sel:DWORD src1_sel:WORD_0
  v_lshlrev_b32_sdwa v59, 3, v95 dst_sel:DWORD dst_unused:UNUSED_PAD src0_sel:DWORD src1_sel:WORD_1
  ds_read_b64 v[32:33], v56
  ds_read_b64 v[34:35], v57
  ds_read_b64 v[36:37], v58
  ds_read_b64 v[38:39], v59
  s_add_u32 m0, s56, 16384
  s_add_u32 s3, s56, 137216
  buffer_load_dwordx4 v10, s[8:11], s3 offen sc1 lds
  s_waitcnt lgkmcnt(4)
  v_mfma_f32_16x16x32_bf16 v[12:15], v[28:31], v[40:43], v[12:15]
  s_bitcmp1_b32 s54, 2
  s_cbranch_scc1 E_1_1_3
E_1_0_3:
  v_mfma_f32_16x16x32_bf16 v[12:15], v[28:31], v[44:47], v[12:15]
  s_bitcmp1_b32 s54, 3
  s_cbranch_scc1 E_1_1_4
E_1_0_4:
  s_setprio 2
  v_lshlrev_b32_sdwa v56, 3, v96 dst_sel:DWORD dst_unused:UNUSED_PAD src0_sel:DWORD src1_sel:WORD_0
  v_lshlrev_b32_sdwa v57, 3, v96 dst_sel:DWORD dst_unused:UNUSED_PAD src0_sel:DWORD src1_sel:WORD_1
  v_lshlrev_b32_sdwa v58, 3, v97 dst_sel:DWORD dst_unused:UNUSED_PAD src0_sel:DWORD src1_sel:WORD_0
  v_lshlrev_b32_sdwa v59, 3, v97 dst_sel:DWORD dst_unused:UNUSED_PAD src0_sel:DWORD src1_sel:WORD_1
  ds_read_b64 v[40:41], v56
  ds_read_b64 v[42:43], v57
  ds_read_b64 v[44:45], v58
  ds_read_b64 v[46:47], v59
  s_add_u32 m0, s56, 32768
  s_add_u32 s3, s56, 153600
  buffer_load_dwordx4 v10, s[8:11], s3 offen sc1 lds
  s_waitcnt lgkmcnt(4)
  v_mfma_f32_16x16x32_bf16 v[12:15], v[28:31], v[32:35], v[12:15]
  s_bitcmp1_b32 s54, 4
  s_cbranch_scc1 E_1_1_5
E_1_0_5:
  v_mfma_f32_16x16x32_bf16 v[12:15], v[28:31], v[36:39], v[12:15]
  s_bitcmp1_b32 s54, 5
  s_cbranch_scc1 E_1_1_6
E_1_0_6:
  v_lshlrev_b32_sdwa v56, 3, v98 dst_sel:DWORD dst_unused:UNUSED_PAD src0_sel:DWORD src1_sel:WORD_0
  v_lshlrev_b32_sdwa v57, 3, v98 dst_sel:DWORD dst_unused:UNUSED_PAD src0_sel:DWORD src1_sel:WORD_1
  v_lshlrev_b32_sdwa v58, 3, v99 dst_sel:DWORD dst_unused:UNUSED_PAD src0_sel:DWORD src1_sel:WORD_0
  v_lshlrev_b32_sdwa v59, 3, v99 dst_sel:DWORD dst_unused:UNUSED_PAD src0_sel:DWORD src1_sel:WORD_1
  ds_read_b64 v[32:33], v56
  ds_read_b64 v[34:35], v57
  ds_read_b64 v[36:37], v58
  ds_read_b64 v[38:39], v59
  s_add_u32 m0, s56, 49152
  s_add_u32 s3, s56, 169984
  buffer_load_dwordx4 v10, s[8:11], s3 offen sc1 lds
  s_waitcnt lgkmcnt(4)
  v_mfma_f32_16x16x32_bf16 v[12:15], v[28:31], v[40:43], v[12:15]
  s_bitcmp1_b32 s54, 6
  s_cbranch_scc1 E_1_1_7
E_1_0_7:
  v_mfma_f32_16x16x32_bf16 v[12:15], v[28:31], v[44:47], v[12:15]
  s_bitcmp1_b32 s54, 7
  s_cbranch_scc1 E_1_1_8
E_1_0_8:
  s_setprio 1
  v_lshlrev_b32_sdwa v56, 3, v100 dst_sel:DWORD dst_unused:UNUSED_PAD src0_sel:DWORD src1_sel:WORD_0
  v_lshlrev_b32_sdwa v57, 3, v100 dst_sel:DWORD dst_unused:UNUSED_PAD src0_sel:DWORD src1_sel:WORD_1
  v_lshlrev_b32_sdwa v58, 3, v101 dst_sel:DWORD dst_unused:UNUSED_PAD src0_sel:DWORD src1_sel:WORD_0
  v_lshlrev_b32_sdwa v59, 3, v101 dst_sel:DWORD dst_unused:UNUSED_PAD src0_sel:DWORD src1_sel:WORD_1
  ds_read_b64 v[40:41], v56
  ds_read_b64 v[42:43], v57
  ds_read_b64 v[44:45], v58
  ds_read_b64 v[46:47], v59
  s_waitcnt lgkmcnt(4)
  v_mfma_f32_16x16x32_bf16 v[12:15], v[28:31], v[32:35], v[12:15]
  s_bitcmp1_b32 s54, 8
  s_cbranch_scc1 E_1_1_9
E_1_0_9:
  v_mfma_f32_16x16x32_bf16 v[12:15], v[28:31], v[36:39], v[12:15]
  s_bitcmp1_b32 s54, 9
  s_cbranch_scc1 E_1_1_10
E_1_0_10:
  v_lshlrev_b32_sdwa v56, 3, v102 dst_sel:DWORD dst_unused:UNUSED_PAD src0_sel:DWORD src1_sel:WORD_0
  v_lshlrev_b32_sdwa v57, 3, v102 dst_sel:DWORD dst_unused:UNUSED_PAD src0_sel:DWORD src1_sel:WORD_1
  v_lshlrev_b32_sdwa v58, 3, v103 dst_sel:DWORD dst_unused:UNUSED_PAD src0_sel:DWORD src1_sel:WORD_0
  v_lshlrev_b32_sdwa v59, 3, v103 dst_sel:DWORD dst_unused:UNUSED_PAD src0_sel:DWORD src1_sel:WORD_1
  ds_read_b64 v[32:33], v56
  ds_read_b64 v[34:35], v57
  ds_read_b64 v[36:37], v58
  ds_read_b64 v[38:39], v59
  s_waitcnt lgkmcnt(4)
  v_mfma_f32_16x16x32_bf16 v[12:15], v[28:31], v[40:43], v[12:15]
  s_bitcmp1_b32 s54, 10
  s_cbranch_scc1 E_1_1_11
E_1_0_11:
  v_mfma_f32_16x16x32_bf16 v[12:15], v[28:31], v[44:47], v[12:15]
  s_bitcmp1_b32 s54, 11
  s_cbranch_scc1 E_1_1_12
E_1_0_12:
  s_setprio 0
  v_lshlrev_b32_sdwa v56, 3, v104 dst_sel:DWORD dst_unused:UNUSED_PAD src0_sel:DWORD src1_sel:WORD_0
  v_lshlrev_b32_sdwa v57, 3, v104 dst_sel:DWORD dst_unused:UNUSED_PAD src0_sel:DWORD src1_sel:WORD_1
  v_lshlrev_b32_sdwa v58, 3, v105 dst_sel:DWORD dst_unused:UNUSED_PAD src0_sel:DWORD src1_sel:WORD_0
  v_lshlrev_b32_sdwa v59, 3, v105 dst_sel:DWORD dst_unused:UNUSED_PAD src0_sel:DWORD src1_sel:WORD_1
  ds_read_b64 v[40:41], v56
  ds_read_b64 v[42:43], v57
  ds_read_b64 v[44:45], v58
  ds_read_b64 v[46:47], v59
  s_waitcnt lgkmcnt(4)
  v_mfma_f32_16x16x32_bf16 v[12:15], v[28:31], v[32:35], v[12:15]
  s_bitcmp1_b32 s54, 12
  s_cbranch_scc1 E_1_1_13
E_1_0_13:
  v_mfma_f32_16x16x32_bf16 v[12:15], v[28:31], v[36:39], v[12:15]
  s_bitcmp1_b32 s54, 13
  s_cbranch_scc1 E_1_1_14
E_1_0_14:
  v_lshlrev_b32_sdwa v56, 3, v106 dst_sel:DWORD dst_unused:UNUSED_PAD src0_sel:DWORD src1_sel:WORD_0
  v_lshlrev_b32_sdwa v57, 3, v106 dst_sel:DWORD dst_unused:UNUSED_PAD src0_sel:DWORD src1_sel:WORD_1
  v_lshlrev_b32_sdwa v58, 3, v107 dst_sel:DWORD dst_unused:UNUSED_PAD src0_sel:DWORD src1_sel:WORD_0
  v_lshlrev_b32_sdwa v59, 3, v107 dst_sel:DWORD dst_unused:UNUSED_PAD src0_sel:DWORD src1_sel:WORD_1
  ds_read_b64 v[32:33], v56
  ds_read_b64 v[34:35], v57
  ds_read_b64 v[36:37], v58
  ds_read_b64 v[38:39], v59
  s_waitcnt lgkmcnt(4)
  v_mfma_f32_16x16x32_bf16 v[12:15], v[28:31], v[40:43], v[12:15]
  s_bitcmp1_b32 s54, 14
  s_cbranch_scc1 E_1_1_15
E_1_0_15:
  v_mfma_f32_16x16x32_bf16 v[12:15], v[28:31], v[44:47], v[12:15]
  s_bitcmp1_b32 s54, 15
  s_cbranch_scc1 E_1_1_16
E_1_0_16:
  s_waitcnt lgkmcnt(0)
  v_mfma_f32_16x16x32_bf16 v[12:15], v[28:31], v[32:35], v[12:15]
  s_bitcmp1_b32 s54, 16
  s_cbranch_scc1 E_1_1_17
E_1_0_17:
  v_mfma_f32_16x16x32_bf16 v[12:15], v[28:31], v[36:39], v[12:15]
  s_branch PE_1
PE_1:
  s_setprio 0
  s_cmp_gt_u32 s33, 2
  s_cbranch_scc1 DR_19
  s_add_u32 m0, s56, 16384
  s_add_u32 s3, s56, 137216
  buffer_load_dwordx4 v10, s[8:11], s3 offen sc1 lds
DR_19:
  s_cmp_gt_u32 s33, 4
  s_cbranch_scc1 DR_20
  s_add_u32 m0, s56, 32768
  s_add_u32 s3, s56, 153600
  buffer_load_dwordx4 v10, s[8:11], s3 offen sc1 lds
DR_20:
  s_cmp_gt_u32 s33, 6
  s_cbranch_scc1 DR_21
  s_add_u32 m0, s56, 49152
  s_add_u32 s3, s56, 169984
  buffer_load_dwordx4 v10, s[8:11], s3 offen sc1 lds
DR_21:
  s_waitcnt lgkmcnt(0)
  s_waitcnt vmcnt(0)
  s_barrier
  s_mov_b32 s54, s37
  s_setprio 3
  v_lshlrev_b32_sdwa v56, 3, v108 dst_sel:DWORD dst_unused:UNUSED_PAD src0_sel:DWORD src1_sel:WORD_0
  v_lshlrev_b32_sdwa v57, 3, v108 dst_sel:DWORD dst_unused:UNUSED_PAD src0_sel:DWORD src1_sel:WORD_1
  v_lshlrev_b32_sdwa v58, 3, v109 dst_sel:DWORD dst_unused:UNUSED_PAD src0_sel:DWORD src1_sel:WORD_0
  v_lshlrev_b32_sdwa v59, 3, v109 dst_sel:DWORD dst_unused:UNUSED_PAD src0_sel:DWORD src1_sel:WORD_1
  ds_read_b64 v[32:33], v56
  ds_read_b64 v[34:35], v57
  ds_read_b64 v[36:37], v58
  ds_read_b64 v[38:39], v59
  s_cmp_eq_u32 s38, 1
  s_cbranch_scc1 E_2_1_0
  s_cmp_eq_u32 s38, 2
  s_cbranch_scc1 E_2_2_0
  s_cmp_eq_u32 s38, 3
  s_cbranch_scc1 E_2_3_0
E_2_0_0:
  v_lshlrev_b32_sdwa v56, 3, v110 dst_sel:DWORD dst_unused:UNUSED_PAD src0_sel:DWORD src1_sel:WORD_0
  v_lshlrev_b32_sdwa v57, 3, v110 dst_sel:DWORD dst_unused:UNUSED_PAD src0_sel:DWORD src1_sel:WORD_1
  v_lshlrev_b32_sdwa v58, 3, v111 dst_sel:DWORD dst_unused:UNUSED_PAD src0_sel:DWORD src1_sel:WORD_0
  v_lshlrev_b32_sdwa v59, 3, v111 dst_sel:DWORD dst_unused:UNUSED_PAD src0_sel:DWORD src1_sel:WORD_1
  ds_read_b64 v[40:41], v56
  ds_read_b64 v[42:43], v57
  ds_read_b64 v[44:45], v58
  ds_read_b64 v[46:47], v59
  s_waitcnt lgkmcnt(4)
  v_mfma_f32_16x16x32_bf16 v[12:15], v[28:31], v[32:35], v[12:15]
  s_bitcmp1_b32 s54, 0
  s_cbranch_scc1 E_2_1_1
E_2_0_1:
  v_mfma_f32_16x16x32_bf16 v[12:15], v[28:31], v[36:39], v[12:15]
  s_bitcmp1_b32 s54, 1
  s_cbranch_scc1 E_2_1_2
E_2_0_2:
  v_lshlrev_b32_sdwa v56, 3, v112 dst_sel:DWORD dst_unused:UNUSED_PAD src0_sel:DWORD src1_sel:WORD_0
  v_lshlrev_b32_sdwa v57, 3, v112 dst_sel:DWORD dst_unused:UNUSED_PAD src0_sel:DWORD src1_sel:WORD_1
  v_lshlrev_b32_sdwa v58, 3, v113 dst_sel:DWORD dst_unused:UNUSED_PAD src0_sel:DWORD src1_sel:WORD_0
  v_lshlrev_b32_sdwa v59, 3, v113 dst_sel:DWORD dst_unused:UNUSED_PAD src0_sel:DWORD src1_sel:WORD_1
  ds_read_b64 v[32:33], v56
  ds_read_b64 v[34:35], v57
  ds_read_b64 v[36:37], v58
  ds_read_b64 v[38:39], v59
  s_waitcnt lgkmcnt(4)
  v_mfma_f32_16x16x32_bf16 v[12:15], v[28:31], v[40:43], v[12:15]
  s_bitcmp1_b32 s54, 2
  s_cbranch_scc1 E_2_1_3
E_2_0_3:
  v_mfma_f32_16x16x32_bf16 v[12:15], v[28:31], v[44:47], v[12:15]
  s_bitcmp1_b32 s54, 3
  s_cbranch_scc1 E_2_1_4
E_2_0_4:
  s_setprio 2
  v_lshlrev_b32_sdwa v56, 3, v114 dst_sel:DWORD dst_unused:UNUSED_PAD src0_sel:DWORD src1_sel:WORD_0
  v_lshlrev_b32_sdwa v57, 3, v114 dst_sel:DWORD dst_unused:UNUSED_PAD src0_sel:DWORD src1_sel:WORD_1
  v_lshlrev_b32_sdwa v58, 3, v115 dst_sel:DWORD dst_unused:UNUSED_PAD src0_sel:DWORD src1_sel:WORD_0
  v_lshlrev_b32_sdwa v59, 3, v115 dst_sel:DWORD dst_unused:UNUSED_PAD src0_sel:DWORD src1_sel:WORD_1
  ds_read_b64 v[40:41], v56
  ds_read_b64 v[42:43], v57
  ds_read_b64 v[44:45], v58
  ds_read_b64 v[46:47], v59
  s_waitcnt lgkmcnt(4)
  v_mfma_f32_16x16x32_bf16 v[12:15], v[28:31], v[32:35], v[12:15]
  s_bitcmp1_b32 s54, 4
  s_cbranch_scc1 E_2_1_5
E_2_0_5:
  v_mfma_f32_16x16x32_bf16 v[12:15], v[28:31], v[36:39], v[12:15]
  s_bitcmp1_b32 s54, 5
  s_cbranch_scc1 E_2_1_6
E_2_0_6:
  v_lshlrev_b32_sdwa v56, 3, v116 dst_sel:DWORD dst_unused:UNUSED_PAD src0_sel:DWORD src1_sel:WORD_0
  v_lshlrev_b32_sdwa v57, 3, v116 dst_sel:DWORD dst_unused:UNUSED_PAD src0_sel:DWORD src1_sel:WORD_1
  v_lshlrev_b32_sdwa v58, 3, v117 dst_sel:DWORD dst_unused:UNUSED_PAD src0_sel:DWORD src1_sel:WORD_0
  v_lshlrev_b32_sdwa v59, 3, v117 dst_sel:DWORD dst_unused:UNUSED_PAD src0_sel:DWORD src1_sel:WORD_1
  ds_read_b64 v[32:33], v56
  ds_read_b64 v[34:35], v57
  ds_read_b64 v[36:37], v58
  ds_read_b64 v[38:39], v59
  s_waitcnt lgkmcnt(4)
  v_mfma_f32_16x16x32_bf16 v[12:15], v[28:31], v[40:43], v[12:15]
  s_bitcmp1_b32 s54, 6
  s_cbranch_scc1 E_2_1_7
E_2_0_7:
  v_mfma_f32_16x16x32_bf16 v[12:15], v[28:31], v[44:47], v[12:15]
  s_bitcmp1_b32 s54, 7
  s_cbranch_scc1 E_2_1_8
E_2_0_8:
  s_setprio 1
  v_lshlrev_b32_sdwa v56, 3, v118 dst_sel:DWORD dst_unused:UNUSED_PAD src0_sel:DWORD src1_sel:WORD_0
  v_lshlrev_b32_sdwa v57, 3, v118 dst_sel:DWORD dst_unused:UNUSED_PAD src0_sel:DWORD src1_sel:WORD_1
  v_lshlrev_b32_sdwa v58, 3, v119 dst_sel:DWORD dst_unused:UNUSED_PAD src0_sel:DWORD src1_sel:WORD_0
  v_lshlrev_b32_sdwa v59, 3, v119 dst_sel:DWORD dst_unused:UNUSED_PAD src0_sel:DWORD src1_sel:WORD_1
  ds_read_b64 v[40:41], v56
  ds_read_b64 v[42:43], v57
  ds_read_b64 v[44:45], v58
  ds_read_b64 v[46:47], v59
  s_waitcnt lgkmcnt(4)
  v_mfma_f32_16x16x32_bf16 v[12:15], v[28:31], v[32:35], v[12:15]
  s_bitcmp1_b32 s54, 8
  s_cbranch_scc1 E_2_1_9
E_2_0_9:
  v_mfma_f32_16x16x32_bf16 v[12:15], v[28:31], v[36:39], v[12:15]
  s_bitcmp1_b32 s54, 9
  s_cbranch_scc1 E_2_1_10
E_2_0_10:
  v_lshlrev_b32_sdwa v56, 3, v120 dst_sel:DWORD dst_unused:UNUSED_PAD src0_sel:DWORD src1_sel:WORD_0
  v_lshlrev_b32_sdwa v57, 3, v120 dst_sel:DWORD dst_unused:UNUSED_PAD src0_sel:DWORD src1_sel:WORD_1
  v_lshlrev_b32_sdwa v58, 3, v121 dst_sel:DWORD dst_unused:UNUSED_PAD src0_sel:DWORD src1_sel:WORD_0
  v_lshlrev_b32_sdwa v59, 3, v121 dst_sel:DWORD dst_unused:UNUSED_PAD src0_sel:DWORD src1_sel:WORD_1
  ds_read_b64 v[32:33], v56
  ds_read_b64 v[34:35], v57
  ds_read_b64 v[36:37], v58
  ds_read_b64 v[38:39], v59
  s_waitcnt lgkmcnt(4)
  v_mfma_f32_16x16x32_bf16 v[12:15], v[28:31], v[40:43], v[12:15]
  s_bitcmp1_b32 s54, 10
  s_cbranch_scc1 E_2_1_11
E_2_0_11:
  v_mfma_f32_16x16x32_bf16 v[12:15], v[28:31], v[44:47], v[12:15]
  s_bitcmp1_b32 s54, 11
  s_cbranch_scc1 E_2_1_12
E_2_0_12:
  s_setprio 0
  v_lshlrev_b32_sdwa v56, 3, v122 dst_sel:DWORD dst_unused:UNUSED_PAD src0_sel:DWORD src1_sel:WORD_0
  v_lshlrev_b32_sdwa v57, 3, v122 dst_sel:DWORD dst_unused:UNUSED_PAD src0_sel:DWORD src1_sel:WORD_1
  v_lshlrev_b32_sdwa v58, 3, v123 dst_sel:DWORD dst_unused:UNUSED_PAD src0_sel:DWORD src1_sel:WORD_0
  v_lshlrev_b32_sdwa v59, 3, v123 dst_sel:DWORD dst_unused:UNUSED_PAD src0_sel:DWORD src1_sel:WORD_1
  ds_read_b64 v[40:41], v56
  ds_read_b64 v[42:43], v57
  ds_read_b64 v[44:45], v58
  ds_read_b64 v[46:47], v59
  s_waitcnt lgkmcnt(4)
  v_mfma_f32_16x16x32_bf16 v[12:15], v[28:31], v[32:35], v[12:15]
  s_bitcmp1_b32 s54, 12
  s_cbranch_scc1 E_2_1_13
E_2_0_13:
  v_mfma_f32_16x16x32_bf16 v[12:15], v[28:31], v[36:39], v[12:15]
  s_bitcmp1_b32 s54, 13
  s_cbranch_scc1 E_2_1_14
E_2_0_14:
  v_lshlrev_b32_sdwa v56, 3, v124 dst_sel:DWORD dst_unused:UNUSED_PAD src0_sel:DWORD src1_sel:WORD_0
  v_lshlrev_b32_sdwa v57, 3, v124 dst_sel:DWORD dst_unused:UNUSED_PAD src0_sel:DWORD src1_sel:WORD_1
  v_lshlrev_b32_sdwa v58, 3, v125 dst_sel:DWORD dst_unused:UNUSED_PAD src0_sel:DWORD src1_sel:WORD_0
  v_lshlrev_b32_sdwa v59, 3, v125 dst_sel:DWORD dst_unused:UNUSED_PAD src0_sel:DWORD src1_sel:WORD_1
  ds_read_b64 v[32:33], v56
  ds_read_b64 v[34:35], v57
  ds_read_b64 v[36:37], v58
  ds_read_b64 v[38:39], v59
  s_waitcnt lgkmcnt(4)
  v_mfma_f32_16x16x32_bf16 v[12:15], v[28:31], v[40:43], v[12:15]
  s_bitcmp1_b32 s54, 14
  s_cbranch_scc1 E_2_1_15
E_2_0_15:
  v_mfma_f32_16x16x32_bf16 v[12:15], v[28:31], v[44:47], v[12:15]
  s_bitcmp1_b32 s54, 15
  s_cbranch_scc1 E_2_1_16
E_2_0_16:
  v_lshlrev_b32_sdwa v56, 3, v126 dst_sel:DWORD dst_unused:UNUSED_PAD src0_sel:DWORD src1_sel:WORD_0
  v_lshlrev_b32_sdwa v57, 3, v126 dst_sel:DWORD dst_unused:UNUSED_PAD src0_sel:DWORD src1_sel:WORD_1
  v_lshlrev_b32_sdwa v58, 3, v127 dst_sel:DWORD dst_unused:UNUSED_PAD src0_sel:DWORD src1_sel:WORD_0
  v_lshlrev_b32_sdwa v59, 3, v127 dst_sel:DWORD dst_unused:UNUSED_PAD src0_sel:DWORD src1_sel:WORD_1
  ds_read_b64 v[40:41], v56
  ds_read_b64 v[42:43], v57
  ds_read_b64 v[44:45], v58
  ds_read_b64 v[46:47], v59
  s_waitcnt lgkmcnt(4)
  v_mfma_f32_16x16x32_bf16 v[12:15], v[28:31], v[32:35], v[12:15]
  s_bitcmp1_b32 s54, 16
  s_cbranch_scc1 E_2_1_17
E_2_0_17:
  v_mfma_f32_16x16x32_bf16 v[12:15], v[28:31], v[36:39], v[12:15]
  s_bitcmp1_b32 s54, 17
  s_cbranch_scc1 E_2_1_18
E_2_0_18:
  s_waitcnt lgkmcnt(0)
  v_mfma_f32_16x16x32_bf16 v[12:15], v[28:31], v[40:43], v[12:15]
  s_bitcmp1_b32 s54, 18
  s_cbranch_scc1 E_2_1_19
E_2_0_19:
  v_mfma_f32_16x16x32_bf16 v[12:15], v[28:31], v[44:47], v[12:15]
  s_branch PE_2
PE_2:
  s_setprio 0
  s_waitcnt lgkmcnt(0)
K3_EPI:
  s_nop 7
  s_nop 1
  v_mul_f32 v12, v12, v6
  v_mul_f32 v13, v13, v6
  v_mul_f32 v14, v14, v6
  v_mul_f32 v15, v15, v6
  v_cvt_pk_bf16_f32 v32, v12, v13
  v_cvt_pk_bf16_f32 v33, v14, v15
  ds_write_b64 v2, v[32:33]
  v_mul_f32 v16, v16, v7
  v_mul_f32 v17, v17, v7
  v_mul_f32 v18, v18, v7
  v_mul_f32 v19, v19, v7
  v_cvt_pk_bf16_f32 v34, v16, v17
  v_cvt_pk_bf16_f32 v35, v18, v19
  ds_write_b64 v3, v[34:35]
  v_mul_f32 v20, v20, v8
  v_mul_f32 v21, v21, v8
  v_mul_f32 v22, v22, v8
  v_mul_f32 v23, v23, v8
  v_cvt_pk_bf16_f32 v36, v20, v21
  v_cvt_pk_bf16_f32 v37, v22, v23
  ds_write_b64 v4, v[36:37]
  v_mul_f32 v24, v24, v9
  v_mul_f32 v25, v25, v9
  v_mul_f32 v26, v26, v9
  v_mul_f32 v27, v27, v9
  v_cvt_pk_bf16_f32 v38, v24, v25
  v_cvt_pk_bf16_f32 v39, v26, v27
  ds_write_b64 v5, v[38:39]
  s_waitcnt lgkmcnt(0)
  s_barrier
  ds_read_b128 v[32:35], v11
  ds_read_b128 v[36:39], v11 offset:16384
  s_add_u32 s23, s23, 1
  s_cmp_ge_u32 s23, 7
  s_cbranch_scc1 K3_FIN
  s_waitcnt lgkmcnt(1)
  v_lshlrev_b32 v12, 16, v32
  v_and_b32 v13, s51, v32
  v_lshlrev_b32 v14, 16, v33
  v_and_b32 v15, s51, v33
  v_lshlrev_b32 v16, 16, v34
  v_and_b32 v17, s51, v34
  v_lshlrev_b32 v18, 16, v35
  v_and_b32 v19, s51, v35
  v_mul_f32 v12, v12, v64
  v_mul_f32 v13, v13, v64
  v_mul_f32 v14, v14, v64
  v_mul_f32 v15, v15, v64
  v_mul_f32 v16, v16, v65
  v_mul_f32 v17, v17, v65
  v_mul_f32 v18, v18, v65
  v_mul_f32 v19, v19, v65
  v_cvt_pk_bf16_f32 v40, v12, v13
  v_cvt_pk_bf16_f32 v41, v14, v15
  v_cvt_pk_bf16_f32 v42, v16, v17
  v_cvt_pk_bf16_f32 v43, v18, v19
  s_waitcnt lgkmcnt(0)
  v_lshlrev_b32 v20, 16, v36
  v_and_b32 v21, s51, v36
  v_lshlrev_b32 v22, 16, v37
  v_and_b32 v23, s51, v37
  v_lshlrev_b32 v24, 16, v38
  v_and_b32 v25, s51, v38
  v_lshlrev_b32 v26, 16, v39
  v_and_b32 v27, s51, v39
  v_mul_f32 v20, v20, v66
  v_mul_f32 v21, v21, v66
  v_mul_f32 v22, v22, v66
  v_mul_f32 v23, v23, v66
  v_mul_f32 v24, v24, v67
  v_mul_f32 v25, v25, v67
  v_mul_f32 v26, v26, v67
  v_mul_f32 v27, v27, v67
  v_cvt_pk_bf16_f32 v44, v20, v21
  v_cvt_pk_bf16_f32 v45, v22, v23
  v_cvt_pk_bf16_f32 v46, v24, v25
  v_cvt_pk_bf16_f32 v47, v26, v27
  s_cmp_lg_u32 s50, 2
  s_cbranch_scc1 K3_XD
K3_XP:
  v_cmp_eq_u32 vcc, 0, v71
  s_cbranch_vccz K3_XE
  global_load_dword v71, v70, s[4:5] sc1
  s_waitcnt vmcnt(0)
  s_branch K3_XP
K3_XE:
  v_cmp_ne_u32 vcc, s44, v71
  s_cmp_lg_u64 vcc, 0
  s_cselect_b32 s50, 1, 0
K3_XD:
  s_cmp_lg_u32 s50, 0
  s_cbranch_scc1 K3_GS1
  buffer_store_dwordx4 v[40:43], v68, s[12:15], 0 offen
  buffer_store_dwordx4 v[44:47], v69, s[12:15], 0 offen
  s_branch K3_GS2
K3_GS1:
  buffer_store_dwordx4 v[40:43], v68, s[12:15], 0 offen sc1
  buffer_store_dwordx4 v[44:47], v69, s[12:15], 0 offen sc1
K3_GS2:
  s_waitcnt vmcnt(0) lgkmcnt(0)
  s_barrier
  s_cmp_eq_u32 s22, 0
  s_cbranch_scc1 K3_W0
  buffer_store_dwordx4 v[32:35], v68, s[24:27], 0 offen
  buffer_store_dwordx4 v[36:39], v69, s[24:27], 0 offen
  s_branch K3_WAIT
K3_W0:
  v_mov_b32 v56, s67
  v_mov_b32 v57, s23
  v_cmp_eq_u32 vcc, 0, v1
  s_and_saveexec_b64 s[30:31], vcc
  s_cmp_lg_u32 s50, 0
  s_cbranch_scc1 K3_FS1
  global_store_dword v56, v57, s[4:5]
  s_branch K3_FS2
K3_FS1:
  global_store_dword v56, v57, s[4:5] sc1
K3_FS2:
  s_mov_b64 exec, s[30:31]
  v_and_b32 v56, 7, v1
  v_lshlrev_b32 v56, 5, v56
  v_add_u32 v56, s66, v56
K3_POLL:
  global_load_dword v57, v56, s[4:5] sc1
  s_waitcnt vmcnt(0)
  v_cmp_gt_u32 vcc, s23, v57
  s_cbranch_vccnz K3_POLL
  buffer_store_dwordx4 v[32:35], v68, s[24:27], 0 offen
  buffer_store_dwordx4 v[36:39], v69, s[24:27], 0 offen
K3_WAIT:
  s_barrier
  s_branch K3_HOP
K3_SLOWHOP:
  s_add_u32 s52, s4, 67725824
  s_addc_u32 s53, s5, 0
  s_mov_b32 s54, 401408
  s_mov_b32 s55, 0x20000
  s_add_u32 s56, s4, 66677248
  s_addc_u32 s57, s5, 0
  s_mov_b32 s58, 1048576
  s_mov_b32 s59, 0x20000
  v_mov_b32 v12, 0
  v_mov_b32 v13, 0
  v_mov_b32 v14, 0
  v_mov_b32 v15, 0
  s_add_u32 s3, s22, 0
  s_lshl_b32 s3, s3, 6
  v_add_u32 v32, s3, v1
  v_cmp_gt_u32 vcc, 3136, v32
  s_and_saveexec_b64 s[30:31], vcc
  s_cbranch_execz SX_23
  v_add_u32 v32, s41, v32
  v_lshlrev_b32 v32, 4, v32
  buffer_load_dwordx4 v[36:39], v32, s[52:55], 0 offen
  s_waitcnt vmcnt(0)
  v_mov_b32 v33, v36
SL_22:
  v_cmp_lt_u32 vcc, v33, v39
  s_and_b64 exec, exec, vcc
  s_cbranch_execz SX_23
  v_lshlrev_b32 v34, 1, v33
  buffer_load_ushort v35, v34, s[56:59], 0 offen
  s_waitcnt vmcnt(0)
  v_cmp_le_u32 vcc, v37, v33
  v_subrev_u32 v40, 4864, v35
  s_nop 0
  v_cndmask_b32 v41, v35, v40, vcc
  v_cmp_le_u32 vcc, v38, v33
  v_add_u32 v40, 15104, v35
  s_nop 0
  v_cndmask_b32 v41, v41, v40, vcc
  v_cmp_eq_u32 vcc, 19968, v35
  v_lshlrev_b32 v41, 3, v41
  v_mov_b32 v40, 0x7ffffff0
  s_nop 0
  v_cndmask_b32 v41, v41, v40, vcc
  s_mov_b32 s10, 200000
  buffer_load_dwordx2 v[42:43], v41, s[8:11], 0 offen sc1
  s_waitcnt vmcnt(0)
  v_lshlrev_b32 v44, 16, v42
  v_and_b32 v45, s51, v42
  v_lshlrev_b32 v46, 16, v43
  v_and_b32 v47, s51, v43
  v_add_f32 v12, v12, v44
  v_add_f32 v13, v13, v45
  v_add_f32 v14, v14, v46
  v_add_f32 v15, v15, v47
  v_add_u32 v33, 1, v33
  s_branch SL_22
SX_23:
  s_mov_b64 exec, s[30:31]
  v_mov_b32 v16, 0
  v_mov_b32 v17, 0
  v_mov_b32 v18, 0
  v_mov_b32 v19, 0
  s_add_u32 s3, s22, 16
  s_lshl_b32 s3, s3, 6
  v_add_u32 v32, s3, v1
  v_cmp_gt_u32 vcc, 3136, v32
  s_and_saveexec_b64 s[30:31], vcc
  s_cbranch_execz SX_25
  v_add_u32 v32, s41, v32
  v_lshlrev_b32 v32, 4, v32
  buffer_load_dwordx4 v[36:39], v32, s[52:55], 0 offen
  s_waitcnt vmcnt(0)
  v_mov_b32 v33, v36
SL_24:
  v_cmp_lt_u32 vcc, v33, v39
  s_and_b64 exec, exec, vcc
  s_cbranch_execz SX_25
  v_lshlrev_b32 v34, 1, v33
  buffer_load_ushort v35, v34, s[56:59], 0 offen
  s_waitcnt vmcnt(0)
  v_cmp_le_u32 vcc, v37, v33
  v_subrev_u32 v40, 4864, v35
  s_nop 0
  v_cndmask_b32 v41, v35, v40, vcc
  v_cmp_le_u32 vcc, v38, v33
  v_add_u32 v40, 15104, v35
  s_nop 0
  v_cndmask_b32 v41, v41, v40, vcc
  v_cmp_eq_u32 vcc, 19968, v35
  v_lshlrev_b32 v41, 3, v41
  v_mov_b32 v40, 0x7ffffff0
  s_nop 0
  v_cndmask_b32 v41, v41, v40, vcc
  s_mov_b32 s10, 200000
  buffer_load_dwordx2 v[42:43], v41, s[8:11], 0 offen sc1
  s_waitcnt vmcnt(0)
  v_lshlrev_b32 v44, 16, v42
  v_and_b32 v45, s51, v42
  v_lshlrev_b32 v46, 16, v43
  v_and_b32 v47, s51, v43
  v_add_f32 v16, v16, v44
  v_add_f32 v17, v17, v45
  v_add_f32 v18, v18, v46
  v_add_f32 v19, v19, v47
  v_add_u32 v33, 1, v33
  s_branch SL_24
SX_25:
  s_mov_b64 exec, s[30:31]
  v_mov_b32 v20, 0
  v_mov_b32 v21, 0
  v_mov_b32 v22, 0
  v_mov_b32 v23, 0
  s_add_u32 s3, s22, 32
  s_lshl_b32 s3, s3, 6
  v_add_u32 v32, s3, v1
  v_cmp_gt_u32 vcc, 3136, v32
  s_and_saveexec_b64 s[30:31], vcc
  s_cbranch_execz SX_27
  v_add_u32 v32, s41, v32
  v_lshlrev_b32 v32, 4, v32
  buffer_load_dwordx4 v[36:39], v32, s[52:55], 0 offen
  s_waitcnt vmcnt(0)
  v_mov_b32 v33, v36
SL_26:
  v_cmp_lt_u32 vcc, v33, v39
  s_and_b64 exec, exec, vcc
  s_cbranch_execz SX_27
  v_lshlrev_b32 v34, 1, v33
  buffer_load_ushort v35, v34, s[56:59], 0 offen
  s_waitcnt vmcnt(0)
  v_cmp_le_u32 vcc, v37, v33
  v_subrev_u32 v40, 4864, v35
  s_nop 0
  v_cndmask_b32 v41, v35, v40, vcc
  v_cmp_le_u32 vcc, v38, v33
  v_add_u32 v40, 15104, v35
  s_nop 0
  v_cndmask_b32 v41, v41, v40, vcc
  v_cmp_eq_u32 vcc, 19968, v35
  v_lshlrev_b32 v41, 3, v41
  v_mov_b32 v40, 0x7ffffff0
  s_nop 0
  v_cndmask_b32 v41, v41, v40, vcc
  s_mov_b32 s10, 200000
  buffer_load_dwordx2 v[42:43], v41, s[8:11], 0 offen sc1
  s_waitcnt vmcnt(0)
  v_lshlrev_b32 v44, 16, v42
  v_and_b32 v45, s51, v42
  v_lshlrev_b32 v46, 16, v43
  v_and_b32 v47, s51, v43
  v_add_f32 v20, v20, v44
  v_add_f32 v21, v21, v45
  v_add_f32 v22, v22, v46
  v_add_f32 v23, v23, v47
  v_add_u32 v33, 1, v33
  s_branch SL_26
SX_27:
  s_mov_b64 exec, s[30:31]
  v_mov_b32 v24, 0
  v_mov_b32 v25, 0
  v_mov_b32 v26, 0
  v_mov_b32 v27, 0
  s_add_u32 s3, s22, 48
  s_lshl_b32 s3, s3, 6
  v_add_u32 v32, s3, v1
  v_cmp_gt_u32 vcc, 3136, v32
  s_and_saveexec_b64 s[30:31], vcc
  s_cbranch_execz SX_29
  v_add_u32 v32, s41, v32
  v_lshlrev_b32 v32, 4, v32
  buffer_load_dwordx4 v[36:39], v32, s[52:55], 0 offen
  s_waitcnt vmcnt(0)
  v_mov_b32 v33, v36
SL_28:
  v_cmp_lt_u32 vcc, v33, v39
  s_and_b64 exec, exec, vcc
  s_cbranch_execz SX_29
  v_lshlrev_b32 v34, 1, v33
  buffer_load_ushort v35, v34, s[56:59], 0 offen
  s_waitcnt vmcnt(0)
  v_cmp_le_u32 vcc, v37, v33
  v_subrev_u32 v40, 4864, v35
  s_nop 0
  v_cndmask_b32 v41, v35, v40, vcc
  v_cmp_le_u32 vcc, v38, v33
  v_add_u32 v40, 15104, v35
  s_nop 0
  v_cndmask_b32 v41, v41, v40, vcc
  v_cmp_eq_u32 vcc, 19968, v35
  v_lshlrev_b32 v41, 3, v41
  v_mov_b32 v40, 0x7ffffff0
  s_nop 0
  v_cndmask_b32 v41, v41, v40, vcc
  s_mov_b32 s10, 200000
  buffer_load_dwordx2 v[42:43], v41, s[8:11], 0 offen sc1
  s_waitcnt vmcnt(0)
  v_lshlrev_b32 v44, 16, v42
  v_and_b32 v45, s51, v42
  v_lshlrev_b32 v46, 16, v43
  v_and_b32 v47, s51, v43
  v_add_f32 v24, v24, v44
  v_add_f32 v25, v25, v45
  v_add_f32 v26, v26, v46
  v_add_f32 v27, v27, v47
  v_add_u32 v33, 1, v33
  s_branch SL_28
SX_29:
  s_mov_b64 exec, s[30:31]
  s_mov_b32 s10, 202752
  s_branch K3_EPI
BU_0_0:
  s_cmp_le_u32 s32, 1
  s_cbranch_scc1 BF_0_1
  v_mov_b32 v16, v17
  v_mov_b32 v12, v13
  v_mov_b32 v17, v18
  v_mov_b32 v13, v14
  v_mov_b32 v18, v19
  v_mov_b32 v14, v15
  v_mov_b32 v21, v16
  v_mov_b32 v22, v12
  s_branch BB_0_0
BU_0_1:
  s_cmp_le_u32 s32, 2
  s_cbranch_scc1 BF_0_2
  v_mov_b32 v16, v17
  v_mov_b32 v12, v13
  v_mov_b32 v17, v18
  v_mov_b32 v13, v14
  v_mov_b32 v18, v19
  v_mov_b32 v14, v15
  v_mov_b32 v20, v16
  v_mov_b32 v22, v12
  s_branch BB_0_1
BU_0_2:
  s_cmp_le_u32 s32, 3
  s_cbranch_scc1 BF_0_3
  v_mov_b32 v16, v17
  v_mov_b32 v12, v13
  v_mov_b32 v17, v18
  v_mov_b32 v13, v14
  v_mov_b32 v18, v19
  v_mov_b32 v14, v15
  v_mov_b32 v21, v16
  v_mov_b32 v22, v12
  s_branch BB_0_2
BU_0_3:
  s_cmp_le_u32 s32, 4
  s_cbranch_scc1 BF_0_4
  v_mov_b32 v16, v17
  v_mov_b32 v12, v13
  v_mov_b32 v17, v18
  v_mov_b32 v13, v14
  v_mov_b32 v18, v19
  v_mov_b32 v14, v15
  v_mov_b32 v20, v16
  v_mov_b32 v22, v12
  s_branch BB_0_3
BU_0_4:
  s_cmp_le_u32 s32, 5
  s_cbranch_scc1 BF_0_5
  v_mov_b32 v16, v17
  v_mov_b32 v12, v13
  v_mov_b32 v17, v18
  v_mov_b32 v13, v14
  v_mov_b32 v18, v19
  v_mov_b32 v14, v15
  v_mov_b32 v21, v16
  v_mov_b32 v22, v12
  s_branch BB_0_4
BU_0_5:
  s_cmp_le_u32 s32, 6
  s_cbranch_scc1 BF_0_6
  v_mov_b32 v16, v17
  v_mov_b32 v12, v13
  v_mov_b32 v17, v18
  v_mov_b32 v13, v14
  v_mov_b32 v18, v19
  v_mov_b32 v14, v15
  v_mov_b32 v20, v16
  v_mov_b32 v22, v12
  s_branch BB_0_5
BU_0_6:
  s_cmp_le_u32 s32, 7
  s_cbranch_scc1 BF_0_7
  v_mov_b32 v16, v17
  v_mov_b32 v12, v13
  v_mov_b32 v17, v18
  v_mov_b32 v13, v14
  v_mov_b32 v18, v19
  v_mov_b32 v14, v15
  v_mov_b32 v21, v16
  v_mov_b32 v22, v12
  s_branch BB_0_6
BU_0_7:
  s_cmp_le_u32 s32, 8
  s_cbranch_scc1 BF_0_8
  v_mov_b32 v16, v17
  v_mov_b32 v12, v13
  v_mov_b32 v17, v18
  v_mov_b32 v13, v14
  v_mov_b32 v18, v19
  v_mov_b32 v14, v15
  v_mov_b32 v20, v16
  v_mov_b32 v22, v12
  s_branch BB_0_7
BU_0_8:
  s_cmp_le_u32 s32, 9
  s_cbranch_scc1 BF_0_9
  v_mov_b32 v16, v17
  v_mov_b32 v12, v13
  v_mov_b32 v17, v18
  v_mov_b32 v13, v14
  v_mov_b32 v18, v19
  v_mov_b32 v14, v15
  v_mov_b32 v21, v16
  v_mov_b32 v22, v12
  s_branch BB_0_8
BU_0_9:
  s_cmp_le_u32 s32, 10
  s_cbranch_scc1 BF_0_10
  v_mov_b32 v16, v17
  v_mov_b32 v12, v13
  v_mov_b32 v17, v18
  v_mov_b32 v13, v14
  v_mov_b32 v18, v19
  v_mov_b32 v14, v15
  v_mov_b32 v20, v16
  v_mov_b32 v22, v12
  s_branch BB_0_9
BU_0_10:
  s_cmp_le_u32 s32, 11
  s_cbranch_scc1 BF_0_11
  v_mov_b32 v16, v17
  v_mov_b32 v12, v13
  v_mov_b32 v17, v18
  v_mov_b32 v13, v14
  v_mov_b32 v18, v19
  v_mov_b32 v14, v15
  v_mov_b32 v21, v16
  v_mov_b32 v22, v12
  s_branch BB_0_10
BU_0_11:
  s_cmp_le_u32 s32, 12
  s_cbranch_scc1 BF_0_12
  v_mov_b32 v16, v17
  v_mov_b32 v12, v13
  v_mov_b32 v17, v18
  v_mov_b32 v13, v14
  v_mov_b32 v18, v19
  v_mov_b32 v14, v15
  v_mov_b32 v20, v16
  v_mov_b32 v22, v12
  s_branch BB_0_11
BU_0_12:
  s_cmp_le_u32 s32, 13
  s_cbranch_scc1 BF_0_13
  v_mov_b32 v16, v17
  v_mov_b32 v12, v13
  v_mov_b32 v17, v18
  v_mov_b32 v13, v14
  v_mov_b32 v18, v19
  v_mov_b32 v14, v15
  v_mov_b32 v21, v16
  v_mov_b32 v22, v12
  s_branch BB_0_12
BU_0_13:
  s_cmp_le_u32 s32, 14
  s_cbranch_scc1 BF_0_14
  v_mov_b32 v16, v17
  v_mov_b32 v12, v13
  v_mov_b32 v17, v18
  v_mov_b32 v13, v14
  v_mov_b32 v18, v19
  v_mov_b32 v14, v15
  v_mov_b32 v20, v16
  v_mov_b32 v22, v12
  s_branch BB_0_13
BU_0_14:
  s_cmp_le_u32 s32, 15
  s_cbranch_scc1 BF_0_15
  v_mov_b32 v16, v17
  v_mov_b32 v12, v13
  v_mov_b32 v17, v18
  v_mov_b32 v13, v14
  v_mov_b32 v18, v19
  v_mov_b32 v14, v15
  v_mov_b32 v21, v16
  v_mov_b32 v22, v12
  s_branch BB_0_14
BU_0_15:
  s_cmp_le_u32 s32, 16
  s_cbranch_scc1 BF_0_16
  v_mov_b32 v16, v17
  v_mov_b32 v12, v13
  v_mov_b32 v17, v18
  v_mov_b32 v13, v14
  v_mov_b32 v18, v19
  v_mov_b32 v14, v15
  v_mov_b32 v20, v16
  v_mov_b32 v22, v12
  s_branch BB_0_15
BU_0_16:
  s_cmp_le_u32 s32, 17
  s_cbranch_scc1 BF_0_17
  v_mov_b32 v16, v17
  v_mov_b32 v12, v13
  v_mov_b32 v17, v18
  v_mov_b32 v13, v14
  v_mov_b32 v18, v19
  v_mov_b32 v14, v15
  v_mov_b32 v21, v16
  v_mov_b32 v22, v12
  s_branch BB_0_16
BU_0_17:
  s_cmp_le_u32 s32, 18
  s_cbranch_scc1 BF_0_18
  v_mov_b32 v16, v17
  v_mov_b32 v12, v13
  v_mov_b32 v17, v18
  v_mov_b32 v13, v14
  v_mov_b32 v18, v19
  v_mov_b32 v14, v15
  v_mov_b32 v20, v16
  v_mov_b32 v22, v12
  s_branch BB_0_17
BU_1_0:
  s_cmp_le_u32 s33, 1
  s_cbranch_scc1 BF_1_1
  v_mov_b32 v16, v17
  v_mov_b32 v12, v13
  v_mov_b32 v17, v18
  v_mov_b32 v13, v14
  v_mov_b32 v18, v19
  v_mov_b32 v14, v15
  v_mov_b32 v21, v16
  v_mov_b32 v22, v12
  s_branch BB_1_0
BU_1_1:
  s_cmp_le_u32 s33, 2
  s_cbranch_scc1 BF_1_2
  v_mov_b32 v16, v17
  v_mov_b32 v12, v13
  v_mov_b32 v17, v18
  v_mov_b32 v13, v14
  v_mov_b32 v18, v19
  v_mov_b32 v14, v15
  v_mov_b32 v20, v16
  v_mov_b32 v22, v12
  s_branch BB_1_1
BU_1_2:
  s_cmp_le_u32 s33, 3
  s_cbranch_scc1 BF_1_3
  v_mov_b32 v16, v17
  v_mov_b32 v12, v13
  v_mov_b32 v17, v18
  v_mov_b32 v13, v14
  v_mov_b32 v18, v19
  v_mov_b32 v14, v15
  v_mov_b32 v21, v16
  v_mov_b32 v22, v12
  s_branch BB_1_2
BU_1_3:
  s_cmp_le_u32 s33, 4
  s_cbranch_scc1 BF_1_4
  v_mov_b32 v16, v17
  v_mov_b32 v12, v13
  v_mov_b32 v17, v18
  v_mov_b32 v13, v14
  v_mov_b32 v18, v19
  v_mov_b32 v14, v15
  v_mov_b32 v20, v16
  v_mov_b32 v22, v12
  s_branch BB_1_3
BU_1_4:
  s_cmp_le_u32 s33, 5
  s_cbranch_scc1 BF_1_5
  v_mov_b32 v16, v17
  v_mov_b32 v12, v13
  v_mov_b32 v17, v18
  v_mov_b32 v13, v14
  v_mov_b32 v18, v19
  v_mov_b32 v14, v15
  v_mov_b32 v21, v16
  v_mov_b32 v22, v12
  s_branch BB_1_4
BU_1_5:
  s_cmp_le_u32 s33, 6
  s_cbranch_scc1 BF_1_6
  v_mov_b32 v16, v17
  v_mov_b32 v12, v13
  v_mov_b32 v17, v18
  v_mov_b32 v13, v14
  v_mov_b32 v18, v19
  v_mov_b32 v14, v15
  v_mov_b32 v20, v16
  v_mov_b32 v22, v12
  s_branch BB_1_5
BU_1_6:
  s_cmp_le_u32 s33, 7
  s_cbranch_scc1 BF_1_7
  v_mov_b32 v16, v17
  v_mov_b32 v12, v13
  v_mov_b32 v17, v18
  v_mov_b32 v13, v14
  v_mov_b32 v18, v19
  v_mov_b32 v14, v15
  v_mov_b32 v21, v16
  v_mov_b32 v22, v12
  s_branch BB_1_6
BU_1_7:
  s_cmp_le_u32 s33, 8
  s_cbranch_scc1 BF_1_8
  v_mov_b32 v16, v17
  v_mov_b32 v12, v13
  v_mov_b32 v17, v18
  v_mov_b32 v13, v14
  v_mov_b32 v18, v19
  v_mov_b32 v14, v15
  v_mov_b32 v20, v16
  v_mov_b32 v22, v12
  s_branch BB_1_7
BU_1_8:
  s_cmp_le_u32 s33, 9
  s_cbranch_scc1 BF_1_9
  v_mov_b32 v16, v17
  v_mov_b32 v12, v13
  v_mov_b32 v17, v18
  v_mov_b32 v13, v14
  v_mov_b32 v18, v19
  v_mov_b32 v14, v15
  v_mov_b32 v21, v16
  v_mov_b32 v22, v12
  s_branch BB_1_8
BU_1_9:
  s_cmp_le_u32 s33, 10
  s_cbranch_scc1 BF_1_10
  v_mov_b32 v16, v17
  v_mov_b32 v12, v13
  v_mov_b32 v17, v18
  v_mov_b32 v13, v14
  v_mov_b32 v18, v19
  v_mov_b32 v14, v15
  v_mov_b32 v20, v16
  v_mov_b32 v22, v12
  s_branch BB_1_9
BU_1_10:
  s_cmp_le_u32 s33, 11
  s_cbranch_scc1 BF_1_11
  v_mov_b32 v16, v17
  v_mov_b32 v12, v13
  v_mov_b32 v17, v18
  v_mov_b32 v13, v14
  v_mov_b32 v18, v19
  v_mov_b32 v14, v15
  v_mov_b32 v21, v16
  v_mov_b32 v22, v12
  s_branch BB_1_10
BU_1_11:
  s_cmp_le_u32 s33, 12
  s_cbranch_scc1 BF_1_12
  v_mov_b32 v16, v17
  v_mov_b32 v12, v13
  v_mov_b32 v17, v18
  v_mov_b32 v13, v14
  v_mov_b32 v18, v19
  v_mov_b32 v14, v15
  v_mov_b32 v20, v16
  v_mov_b32 v22, v12
  s_branch BB_1_11
BU_1_12:
  s_cmp_le_u32 s33, 13
  s_cbranch_scc1 BF_1_13
  v_mov_b32 v16, v17
  v_mov_b32 v12, v13
  v_mov_b32 v17, v18
  v_mov_b32 v13, v14
  v_mov_b32 v18, v19
  v_mov_b32 v14, v15
  v_mov_b32 v21, v16
  v_mov_b32 v22, v12
  s_branch BB_1_12
BU_1_13:
  s_cmp_le_u32 s33, 14
  s_cbranch_scc1 BF_1_14
  v_mov_b32 v16, v17
  v_mov_b32 v12, v13
  v_mov_b32 v17, v18
  v_mov_b32 v13, v14
  v_mov_b32 v18, v19
  v_mov_b32 v14, v15
  v_mov_b32 v20, v16
  v_mov_b32 v22, v12
  s_branch BB_1_13
BU_1_14:
  s_cmp_le_u32 s33, 15
  s_cbranch_scc1 BF_1_15
  v_mov_b32 v16, v17
  v_mov_b32 v12, v13
  v_mov_b32 v17, v18
  v_mov_b32 v13, v14
  v_mov_b32 v18, v19
  v_mov_b32 v14, v15
  v_mov_b32 v21, v16
  v_mov_b32 v22, v12
  s_branch BB_1_14
BU_1_15:
  s_cmp_le_u32 s33, 16
  s_cbranch_scc1 BF_1_16
  v_mov_b32 v16, v17
  v_mov_b32 v12, v13
  v_mov_b32 v17, v18
  v_mov_b32 v13, v14
  v_mov_b32 v18, v19
  v_mov_b32 v14, v15
  v_mov_b32 v20, v16
  v_mov_b32 v22, v12
  s_branch BB_1_15
BU_1_16:
  s_cmp_le_u32 s33, 17
  s_cbranch_scc1 BF_1_17
  v_mov_b32 v16, v17
  v_mov_b32 v12, v13
  v_mov_b32 v17, v18
  v_mov_b32 v13, v14
  v_mov_b32 v18, v19
  v_mov_b32 v14, v15
  v_mov_b32 v21, v16
  v_mov_b32 v22, v12
  s_branch BB_1_16
BU_1_17:
  s_cmp_le_u32 s33, 18
  s_cbranch_scc1 BF_1_18
  v_mov_b32 v16, v17
  v_mov_b32 v12, v13
  v_mov_b32 v17, v18
  v_mov_b32 v13, v14
  v_mov_b32 v18, v19
  v_mov_b32 v14, v15
  v_mov_b32 v20, v16
  v_mov_b32 v22, v12
  s_branch BB_1_17
BU_2_0:
  s_cmp_le_u32 s34, 1
  s_cbranch_scc1 BF_2_1
  v_mov_b32 v16, v17
  v_mov_b32 v12, v13
  v_mov_b32 v17, v18
  v_mov_b32 v13, v14
  v_mov_b32 v18, v19
  v_mov_b32 v14, v15
  v_mov_b32 v21, v16
  v_mov_b32 v22, v12
  s_branch BB_2_0
BU_2_1:
  s_cmp_le_u32 s34, 2
  s_cbranch_scc1 BF_2_2
  v_mov_b32 v16, v17
  v_mov_b32 v12, v13
  v_mov_b32 v17, v18
  v_mov_b32 v13, v14
  v_mov_b32 v18, v19
  v_mov_b32 v14, v15
  v_mov_b32 v20, v16
  v_mov_b32 v22, v12
  s_branch BB_2_1
BU_2_2:
  s_cmp_le_u32 s34, 3
  s_cbranch_scc1 BF_2_3
  v_mov_b32 v16, v17
  v_mov_b32 v12, v13
  v_mov_b32 v17, v18
  v_mov_b32 v13, v14
  v_mov_b32 v18, v19
  v_mov_b32 v14, v15
  v_mov_b32 v21, v16
  v_mov_b32 v22, v12
  s_branch BB_2_2
BU_2_3:
  s_cmp_le_u32 s34, 4
  s_cbranch_scc1 BF_2_4
  v_mov_b32 v16, v17
  v_mov_b32 v12, v13
  v_mov_b32 v17, v18
  v_mov_b32 v13, v14
  v_mov_b32 v18, v19
  v_mov_b32 v14, v15
  v_mov_b32 v20, v16
  v_mov_b32 v22, v12
  s_branch BB_2_3
BU_2_4:
  s_cmp_le_u32 s34, 5
  s_cbranch_scc1 BF_2_5
  v_mov_b32 v16, v17
  v_mov_b32 v12, v13
  v_mov_b32 v17, v18
  v_mov_b32 v13, v14
  v_mov_b32 v18, v19
  v_mov_b32 v14, v15
  v_mov_b32 v21, v16
  v_mov_b32 v22, v12
  s_branch BB_2_4
BU_2_5:
  s_cmp_le_u32 s34, 6
  s_cbranch_scc1 BF_2_6
  v_mov_b32 v16, v17
  v_mov_b32 v12, v13
  v_mov_b32 v17, v18
  v_mov_b32 v13, v14
  v_mov_b32 v18, v19
  v_mov_b32 v14, v15
  v_mov_b32 v20, v16
  v_mov_b32 v22, v12
  s_branch BB_2_5
BU_2_6:
  s_cmp_le_u32 s34, 7
  s_cbranch_scc1 BF_2_7
  v_mov_b32 v16, v17
  v_mov_b32 v12, v13
  v_mov_b32 v17, v18
  v_mov_b32 v13, v14
  v_mov_b32 v18, v19
  v_mov_b32 v14, v15
  v_mov_b32 v21, v16
  v_mov_b32 v22, v12
  s_branch BB_2_6
BU_2_7:
  s_cmp_le_u32 s34, 8
  s_cbranch_scc1 BF_2_8
  v_mov_b32 v16, v17
  v_mov_b32 v12, v13
  v_mov_b32 v17, v18
  v_mov_b32 v13, v14
  v_mov_b32 v18, v19
  v_mov_b32 v14, v15
  v_mov_b32 v20, v16
  v_mov_b32 v22, v12
  s_branch BB_2_7
BU_2_8:
  s_cmp_le_u32 s34, 9
  s_cbranch_scc1 BF_2_9
  v_mov_b32 v16, v17
  v_mov_b32 v12, v13
  v_mov_b32 v17, v18
  v_mov_b32 v13, v14
  v_mov_b32 v18, v19
  v_mov_b32 v14, v15
  v_mov_b32 v21, v16
  v_mov_b32 v22, v12
  s_branch BB_2_8
BU_2_9:
  s_cmp_le_u32 s34, 10
  s_cbranch_scc1 BF_2_10
  v_mov_b32 v16, v17
  v_mov_b32 v12, v13
  v_mov_b32 v17, v18
  v_mov_b32 v13, v14
  v_mov_b32 v18, v19
  v_mov_b32 v14, v15
  v_mov_b32 v20, v16
  v_mov_b32 v22, v12
  s_branch BB_2_9
BU_2_10:
  s_cmp_le_u32 s34, 11
  s_cbranch_scc1 BF_2_11
  v_mov_b32 v16, v17
  v_mov_b32 v12, v13
  v_mov_b32 v17, v18
  v_mov_b32 v13, v14
  v_mov_b32 v18, v19
  v_mov_b32 v14, v15
  v_mov_b32 v21, v16
  v_mov_b32 v22, v12
  s_branch BB_2_10
BU_2_11:
  s_cmp_le_u32 s34, 12
  s_cbranch_scc1 BF_2_12
  v_mov_b32 v16, v17
  v_mov_b32 v12, v13
  v_mov_b32 v17, v18
  v_mov_b32 v13, v14
  v_mov_b32 v18, v19
  v_mov_b32 v14, v15
  v_mov_b32 v20, v16
  v_mov_b32 v22, v12
  s_branch BB_2_11
BU_2_12:
  s_cmp_le_u32 s34, 13
  s_cbranch_scc1 BF_2_13
  v_mov_b32 v16, v17
  v_mov_b32 v12, v13
  v_mov_b32 v17, v18
  v_mov_b32 v13, v14
  v_mov_b32 v18, v19
  v_mov_b32 v14, v15
  v_mov_b32 v21, v16
  v_mov_b32 v22, v12
  s_branch BB_2_12
BU_2_13:
  s_cmp_le_u32 s34, 14
  s_cbranch_scc1 BF_2_14
  v_mov_b32 v16, v17
  v_mov_b32 v12, v13
  v_mov_b32 v17, v18
  v_mov_b32 v13, v14
  v_mov_b32 v18, v19
  v_mov_b32 v14, v15
  v_mov_b32 v20, v16
  v_mov_b32 v22, v12
  s_branch BB_2_13
BU_2_14:
  s_cmp_le_u32 s34, 15
  s_cbranch_scc1 BF_2_15
  v_mov_b32 v16, v17
  v_mov_b32 v12, v13
  v_mov_b32 v17, v18
  v_mov_b32 v13, v14
  v_mov_b32 v18, v19
  v_mov_b32 v14, v15
  v_mov_b32 v21, v16
  v_mov_b32 v22, v12
  s_branch BB_2_14
BU_2_15:
  s_cmp_le_u32 s34, 16
  s_cbranch_scc1 BF_2_16
  v_mov_b32 v16, v17
  v_mov_b32 v12, v13
  v_mov_b32 v17, v18
  v_mov_b32 v13, v14
  v_mov_b32 v18, v19
  v_mov_b32 v14, v15
  v_mov_b32 v20, v16
  v_mov_b32 v22, v12
  s_branch BB_2_15
BU_2_16:
  s_cmp_le_u32 s34, 17
  s_cbranch_scc1 BF_2_17
  v_mov_b32 v16, v17
  v_mov_b32 v12, v13
  v_mov_b32 v17, v18
  v_mov_b32 v13, v14
  v_mov_b32 v18, v19
  v_mov_b32 v14, v15
  v_mov_b32 v21, v16
  v_mov_b32 v22, v12
  s_branch BB_2_16
BU_2_17:
  s_cmp_le_u32 s34, 18
  s_cbranch_scc1 BF_2_18
  v_mov_b32 v16, v17
  v_mov_b32 v12, v13
  v_mov_b32 v17, v18
  v_mov_b32 v13, v14
  v_mov_b32 v18, v19
  v_mov_b32 v14, v15
  v_mov_b32 v20, v16
  v_mov_b32 v22, v12
  s_branch BB_2_17
BU_2_18:
  s_cmp_le_u32 s34, 19
  s_cbranch_scc1 BF_2_19
  v_mov_b32 v16, v17
  v_mov_b32 v12, v13
  v_mov_b32 v17, v18
  v_mov_b32 v13, v14
  v_mov_b32 v18, v19
  v_mov_b32 v14, v15
  v_mov_b32 v21, v16
  v_mov_b32 v22, v12
  s_branch BB_2_18
BU_2_19:
  s_cmp_le_u32 s34, 20
  s_cbranch_scc1 BF_2_20
  v_mov_b32 v16, v17
  v_mov_b32 v12, v13
  v_mov_b32 v17, v18
  v_mov_b32 v13, v14
  v_mov_b32 v18, v19
  v_mov_b32 v14, v15
  v_mov_b32 v20, v16
  v_mov_b32 v22, v12
  s_branch BB_2_19
E_0_1_0:
  v_lshlrev_b32_sdwa v56, 3, v74 dst_sel:DWORD dst_unused:UNUSED_PAD src0_sel:DWORD src1_sel:WORD_0
  v_lshlrev_b32_sdwa v57, 3, v74 dst_sel:DWORD dst_unused:UNUSED_PAD src0_sel:DWORD src1_sel:WORD_1
  v_lshlrev_b32_sdwa v58, 3, v75 dst_sel:DWORD dst_unused:UNUSED_PAD src0_sel:DWORD src1_sel:WORD_0
  v_lshlrev_b32_sdwa v59, 3, v75 dst_sel:DWORD dst_unused:UNUSED_PAD src0_sel:DWORD src1_sel:WORD_1
  ds_read_b64 v[40:41], v56
  ds_read_b64 v[42:43], v57
  ds_read_b64 v[44:45], v58
  ds_read_b64 v[46:47], v59
  s_add_u32 m0, s56, 79872
  s_add_u32 s3, s56, 40960
  buffer_load_dwordx4 v10, s[8:11], s3 offen sc1 lds
  s_waitcnt lgkmcnt(4)
  v_mfma_f32_16x16x32_bf16 v[16:19], v[28:31], v[32:35], v[16:19]
  s_bitcmp1_b32 s54, 0
  s_cbranch_scc1 E_0_2_1
E_0_1_1:
  v_mfma_f32_16x16x32_bf16 v[16:19], v[28:31], v[36:39], v[16:19]
  s_bitcmp1_b32 s54, 1
  s_cbranch_scc1 E_0_2_2
E_0_1_2:
  v_lshlrev_b32_sdwa v56, 3, v76 dst_sel:DWORD dst_unused:UNUSED_PAD src0_sel:DWORD src1_sel:WORD_0
  v_lshlrev_b32_sdwa v57, 3, v76 dst_sel:DWORD dst_unused:UNUSED_PAD src0_sel:DWORD src1_sel:WORD_1
  v_lshlrev_b32_sdwa v58, 3, v77 dst_sel:DWORD dst_unused:UNUSED_PAD src0_sel:DWORD src1_sel:WORD_0
  v_lshlrev_b32_sdwa v59, 3, v77 dst_sel:DWORD dst_unused:UNUSED_PAD src0_sel:DWORD src1_sel:WORD_1
  ds_read_b64 v[32:33], v56
  ds_read_b64 v[34:35], v57
  ds_read_b64 v[36:37], v58
  ds_read_b64 v[38:39], v59
  s_add_u32 m0, s56, 96256
  s_add_u32 s3, s56, 57344
  buffer_load_dwordx4 v10, s[8:11], s3 offen sc1 lds
  s_waitcnt lgkmcnt(4)
  v_mfma_f32_16x16x32_bf16 v[16:19], v[28:31], v[40:43], v[16:19]
  s_bitcmp1_b32 s54, 2
  s_cbranch_scc1 E_0_2_3
E_0_1_3:
  v_mfma_f32_16x16x32_bf16 v[16:19], v[28:31], v[44:47], v[16:19]
  s_bitcmp1_b32 s54, 3
  s_cbranch_scc1 E_0_2_4
E_0_1_4:
  s_setprio 2
  v_lshlrev_b32_sdwa v56, 3, v78 dst_sel:DWORD dst_unused:UNUSED_PAD src0_sel:DWORD src1_sel:WORD_0
  v_lshlrev_b32_sdwa v57, 3, v78 dst_sel:DWORD dst_unused:UNUSED_PAD src0_sel:DWORD src1_sel:WORD_1
  v_lshlrev_b32_sdwa v58, 3, v79 dst_sel:DWORD dst_unused:UNUSED_PAD src0_sel:DWORD src1_sel:WORD_0
  v_lshlrev_b32_sdwa v59, 3, v79 dst_sel:DWORD dst_unused:UNUSED_PAD src0_sel:DWORD src1_sel:WORD_1
  ds_read_b64 v[40:41], v56
  ds_read_b64 v[42:43], v57
  ds_read_b64 v[44:45], v58
  ds_read_b64 v[46:47], v59
  s_add_u32 m0, s56, 112640
  s_add_u32 s3, s56, 73728
  buffer_load_dwordx4 v10, s[8:11], s3 offen sc1 lds
  s_waitcnt lgkmcnt(4)
  v_mfma_f32_16x16x32_bf16 v[16:19], v[28:31], v[32:35], v[16:19]
  s_bitcmp1_b32 s54, 4
  s_cbranch_scc1 E_0_2_5
E_0_1_5:
  v_mfma_f32_16x16x32_bf16 v[16:19], v[28:31], v[36:39], v[16:19]
  s_bitcmp1_b32 s54, 5
  s_cbranch_scc1 E_0_2_6
E_0_1_6:
  v_lshlrev_b32_sdwa v56, 3, v80 dst_sel:DWORD dst_unused:UNUSED_PAD src0_sel:DWORD src1_sel:WORD_0
  v_lshlrev_b32_sdwa v57, 3, v80 dst_sel:DWORD dst_unused:UNUSED_PAD src0_sel:DWORD src1_sel:WORD_1
  v_lshlrev_b32_sdwa v58, 3, v81 dst_sel:DWORD dst_unused:UNUSED_PAD src0_sel:DWORD src1_sel:WORD_0
  v_lshlrev_b32_sdwa v59, 3, v81 dst_sel:DWORD dst_unused:UNUSED_PAD src0_sel:DWORD src1_sel:WORD_1
  ds_read_b64 v[32:33], v56
  ds_read_b64 v[34:35], v57
  ds_read_b64 v[36:37], v58
  ds_read_b64 v[38:39], v59
  s_add_u32 m0, s56, 129024
  s_add_u32 s3, s56, 90112
  buffer_load_dwordx4 v10, s[8:11], s3 offen sc1 lds
  s_waitcnt lgkmcnt(4)
  v_mfma_f32_16x16x32_bf16 v[16:19], v[28:31], v[40:43], v[16:19]
  s_bitcmp1_b32 s54, 6
  s_cbranch_scc1 E_0_2_7
E_0_1_7:
  v_mfma_f32_16x16x32_bf16 v[16:19], v[28:31], v[44:47], v[16:19]
  s_bitcmp1_b32 s54, 7
  s_cbranch_scc1 E_0_2_8
E_0_1_8:
  s_setprio 1
  v_lshlrev_b32_sdwa v56, 3, v82 dst_sel:DWORD dst_unused:UNUSED_PAD src0_sel:DWORD src1_sel:WORD_0
  v_lshlrev_b32_sdwa v57, 3, v82 dst_sel:DWORD dst_unused:UNUSED_PAD src0_sel:DWORD src1_sel:WORD_1
  v_lshlrev_b32_sdwa v58, 3, v83 dst_sel:DWORD dst_unused:UNUSED_PAD src0_sel:DWORD src1_sel:WORD_0
  v_lshlrev_b32_sdwa v59, 3, v83 dst_sel:DWORD dst_unused:UNUSED_PAD src0_sel:DWORD src1_sel:WORD_1
  ds_read_b64 v[40:41], v56
  ds_read_b64 v[42:43], v57
  ds_read_b64 v[44:45], v58
  ds_read_b64 v[46:47], v59
  s_waitcnt lgkmcnt(4)
  v_mfma_f32_16x16x32_bf16 v[16:19], v[28:31], v[32:35], v[16:19]
  s_bitcmp1_b32 s54, 8
  s_cbranch_scc1 E_0_2_9
E_0_1_9:
  v_mfma_f32_16x16x32_bf16 v[16:19], v[28:31], v[36:39], v[16:19]
  s_bitcmp1_b32 s54, 9
  s_cbranch_scc1 E_0_2_10
E_0_1_10:
  v_lshlrev_b32_sdwa v56, 3, v84 dst_sel:DWORD dst_unused:UNUSED_PAD src0_sel:DWORD src1_sel:WORD_0
  v_lshlrev_b32_sdwa v57, 3, v84 dst_sel:DWORD dst_unused:UNUSED_PAD src0_sel:DWORD src1_sel:WORD_1
  v_lshlrev_b32_sdwa v58, 3, v85 dst_sel:DWORD dst_unused:UNUSED_PAD src0_sel:DWORD src1_sel:WORD_0
  v_lshlrev_b32_sdwa v59, 3, v85 dst_sel:DWORD dst_unused:UNUSED_PAD src0_sel:DWORD src1_sel:WORD_1
  ds_read_b64 v[32:33], v56
  ds_read_b64 v[34:35], v57
  ds_read_b64 v[36:37], v58
  ds_read_b64 v[38:39], v59
  s_waitcnt lgkmcnt(4)
  v_mfma_f32_16x16x32_bf16 v[16:19], v[28:31], v[40:43], v[16:19]
  s_bitcmp1_b32 s54, 10
  s_cbranch_scc1 E_0_2_11
E_0_1_11:
  v_mfma_f32_16x16x32_bf16 v[16:19], v[28:31], v[44:47], v[16:19]
  s_bitcmp1_b32 s54, 11
  s_cbranch_scc1 E_0_2_12
E_0_1_12:
  s_setprio 0
  v_lshlrev_b32_sdwa v56, 3, v86 dst_sel:DWORD dst_unused:UNUSED_PAD src0_sel:DWORD src1_sel:WORD_0
  v_lshlrev_b32_sdwa v57, 3, v86 dst_sel:DWORD dst_unused:UNUSED_PAD src0_sel:DWORD src1_sel:WORD_1
  v_lshlrev_b32_sdwa v58, 3, v87 dst_sel:DWORD dst_unused:UNUSED_PAD src0_sel:DWORD src1_sel:WORD_0
  v_lshlrev_b32_sdwa v59, 3, v87 dst_sel:DWORD dst_unused:UNUSED_PAD src0_sel:DWORD src1_sel:WORD_1
  ds_read_b64 v[40:41], v56
  ds_read_b64 v[42:43], v57
  ds_read_b64 v[44:45], v58
  ds_read_b64 v[46:47], v59
  s_waitcnt lgkmcnt(4)
  v_mfma_f32_16x16x32_bf16 v[16:19], v[28:31], v[32:35], v[16:19]
  s_bitcmp1_b32 s54, 12
  s_cbranch_scc1 E_0_2_13
E_0_1_13:
  v_mfma_f32_16x16x32_bf16 v[16:19], v[28:31], v[36:39], v[16:19]
  s_bitcmp1_b32 s54, 13
  s_cbranch_scc1 E_0_2_14
E_0_1_14:
  v_lshlrev_b32_sdwa v56, 3, v88 dst_sel:DWORD dst_unused:UNUSED_PAD src0_sel:DWORD src1_sel:WORD_0
  v_lshlrev_b32_sdwa v57, 3, v88 dst_sel:DWORD dst_unused:UNUSED_PAD src0_sel:DWORD src1_sel:WORD_1
  v_lshlrev_b32_sdwa v58, 3, v89 dst_sel:DWORD dst_unused:UNUSED_PAD src0_sel:DWORD src1_sel:WORD_0
  v_lshlrev_b32_sdwa v59, 3, v89 dst_sel:DWORD dst_unused:UNUSED_PAD src0_sel:DWORD src1_sel:WORD_1
  ds_read_b64 v[32:33], v56
  ds_read_b64 v[34:35], v57
  ds_read_b64 v[36:37], v58
  ds_read_b64 v[38:39], v59
  s_waitcnt lgkmcnt(4)
  v_mfma_f32_16x16x32_bf16 v[16:19], v[28:31], v[40:43], v[16:19]
  s_bitcmp1_b32 s54, 14
  s_cbranch_scc1 E_0_2_15
E_0_1_15:
  v_mfma_f32_16x16x32_bf16 v[16:19], v[28:31], v[44:47], v[16:19]
  s_bitcmp1_b32 s54, 15
  s_cbranch_scc1 E_0_2_16
E_0_1_16:
  s_waitcnt lgkmcnt(0)
  v_mfma_f32_16x16x32_bf16 v[16:19], v[28:31], v[32:35], v[16:19]
  s_bitcmp1_b32 s54, 16
  s_cbranch_scc1 E_0_2_17
E_0_1_17:
  v_mfma_f32_16x16x32_bf16 v[16:19], v[28:31], v[36:39], v[16:19]
  s_branch PE_0
E_0_2_0:
  v_lshlrev_b32_sdwa v56, 3, v74 dst_sel:DWORD dst_unused:UNUSED_PAD src0_sel:DWORD src1_sel:WORD_0
  v_lshlrev_b32_sdwa v57, 3, v74 dst_sel:DWORD dst_unused:UNUSED_PAD src0_sel:DWORD src1_sel:WORD_1
  v_lshlrev_b32_sdwa v58, 3, v75 dst_sel:DWORD dst_unused:UNUSED_PAD src0_sel:DWORD src1_sel:WORD_0
  v_lshlrev_b32_sdwa v59, 3, v75 dst_sel:DWORD dst_unused:UNUSED_PAD src0_sel:DWORD src1_sel:WORD_1
  ds_read_b64 v[40:41], v56
  ds_read_b64 v[42:43], v57
  ds_read_b64 v[44:45], v58
  ds_read_b64 v[46:47], v59
  s_add_u32 m0, s56, 79872
  s_add_u32 s3, s56, 40960
  buffer_load_dwordx4 v10, s[8:11], s3 offen sc1 lds
  s_waitcnt lgkmcnt(4)
  v_mfma_f32_16x16x32_bf16 v[20:23], v[28:31], v[32:35], v[20:23]
  s_bitcmp1_b32 s54, 0
  s_cbranch_scc1 E_0_3_1
E_0_2_1:
  v_mfma_f32_16x16x32_bf16 v[20:23], v[28:31], v[36:39], v[20:23]
  s_bitcmp1_b32 s54, 1
  s_cbranch_scc1 E_0_3_2
E_0_2_2:
  v_lshlrev_b32_sdwa v56, 3, v76 dst_sel:DWORD dst_unused:UNUSED_PAD src0_sel:DWORD src1_sel:WORD_0
  v_lshlrev_b32_sdwa v57, 3, v76 dst_sel:DWORD dst_unused:UNUSED_PAD src0_sel:DWORD src1_sel:WORD_1
  v_lshlrev_b32_sdwa v58, 3, v77 dst_sel:DWORD dst_unused:UNUSED_PAD src0_sel:DWORD src1_sel:WORD_0
  v_lshlrev_b32_sdwa v59, 3, v77 dst_sel:DWORD dst_unused:UNUSED_PAD src0_sel:DWORD src1_sel:WORD_1
  ds_read_b64 v[32:33], v56
  ds_read_b64 v[34:35], v57
  ds_read_b64 v[36:37], v58
  ds_read_b64 v[38:39], v59
  s_add_u32 m0, s56, 96256
  s_add_u32 s3, s56, 57344
  buffer_load_dwordx4 v10, s[8:11], s3 offen sc1 lds
  s_waitcnt lgkmcnt(4)
  v_mfma_f32_16x16x32_bf16 v[20:23], v[28:31], v[40:43], v[20:23]
  s_bitcmp1_b32 s54, 2
  s_cbranch_scc1 E_0_3_3
E_0_2_3:
  v_mfma_f32_16x16x32_bf16 v[20:23], v[28:31], v[44:47], v[20:23]
  s_bitcmp1_b32 s54, 3
  s_cbranch_scc1 E_0_3_4
E_0_2_4:
  s_setprio 2
  v_lshlrev_b32_sdwa v56, 3, v78 dst_sel:DWORD dst_unused:UNUSED_PAD src0_sel:DWORD src1_sel:WORD_0
  v_lshlrev_b32_sdwa v57, 3, v78 dst_sel:DWORD dst_unused:UNUSED_PAD src0_sel:DWORD src1_sel:WORD_1
  v_lshlrev_b32_sdwa v58, 3, v79 dst_sel:DWORD dst_unused:UNUSED_PAD src0_sel:DWORD src1_sel:WORD_0
  v_lshlrev_b32_sdwa v59, 3, v79 dst_sel:DWORD dst_unused:UNUSED_PAD src0_sel:DWORD src1_sel:WORD_1
  ds_read_b64 v[40:41], v56
  ds_read_b64 v[42:43], v57
  ds_read_b64 v[44:45], v58
  ds_read_b64 v[46:47], v59
  s_add_u32 m0, s56, 112640
  s_add_u32 s3, s56, 73728
  buffer_load_dwordx4 v10, s[8:11], s3 offen sc1 lds
  s_waitcnt lgkmcnt(4)
  v_mfma_f32_16x16x32_bf16 v[20:23], v[28:31], v[32:35], v[20:23]
  s_bitcmp1_b32 s54, 4
  s_cbranch_scc1 E_0_3_5
E_0_2_5:
  v_mfma_f32_16x16x32_bf16 v[20:23], v[28:31], v[36:39], v[20:23]
  s_bitcmp1_b32 s54, 5
  s_cbranch_scc1 E_0_3_6
E_0_2_6:
  v_lshlrev_b32_sdwa v56, 3, v80 dst_sel:DWORD dst_unused:UNUSED_PAD src0_sel:DWORD src1_sel:WORD_0
  v_lshlrev_b32_sdwa v57, 3, v80 dst_sel:DWORD dst_unused:UNUSED_PAD src0_sel:DWORD src1_sel:WORD_1
  v_lshlrev_b32_sdwa v58, 3, v81 dst_sel:DWORD dst_unused:UNUSED_PAD src0_sel:DWORD src1_sel:WORD_0
  v_lshlrev_b32_sdwa v59, 3, v81 dst_sel:DWORD dst_unused:UNUSED_PAD src0_sel:DWORD src1_sel:WORD_1
  ds_read_b64 v[32:33], v56
  ds_read_b64 v[34:35], v57
  ds_read_b64 v[36:37], v58
  ds_read_b64 v[38:39], v59
  s_add_u32 m0, s56, 129024
  s_add_u32 s3, s56, 90112
  buffer_load_dwordx4 v10, s[8:11], s3 offen sc1 lds
  s_waitcnt lgkmcnt(4)
  v_mfma_f32_16x16x32_bf16 v[20:23], v[28:31], v[40:43], v[20:23]
  s_bitcmp1_b32 s54, 6
  s_cbranch_scc1 E_0_3_7
E_0_2_7:
  v_mfma_f32_16x16x32_bf16 v[20:23], v[28:31], v[44:47], v[20:23]
  s_bitcmp1_b32 s54, 7
  s_cbranch_scc1 E_0_3_8
E_0_2_8:
  s_setprio 1
  v_lshlrev_b32_sdwa v56, 3, v82 dst_sel:DWORD dst_unused:UNUSED_PAD src0_sel:DWORD src1_sel:WORD_0
  v_lshlrev_b32_sdwa v57, 3, v82 dst_sel:DWORD dst_unused:UNUSED_PAD src0_sel:DWORD src1_sel:WORD_1
  v_lshlrev_b32_sdwa v58, 3, v83 dst_sel:DWORD dst_unused:UNUSED_PAD src0_sel:DWORD src1_sel:WORD_0
  v_lshlrev_b32_sdwa v59, 3, v83 dst_sel:DWORD dst_unused:UNUSED_PAD src0_sel:DWORD src1_sel:WORD_1
  ds_read_b64 v[40:41], v56
  ds_read_b64 v[42:43], v57
  ds_read_b64 v[44:45], v58
  ds_read_b64 v[46:47], v59
  s_waitcnt lgkmcnt(4)
  v_mfma_f32_16x16x32_bf16 v[20:23], v[28:31], v[32:35], v[20:23]
  s_bitcmp1_b32 s54, 8
  s_cbranch_scc1 E_0_3_9
E_0_2_9:
  v_mfma_f32_16x16x32_bf16 v[20:23], v[28:31], v[36:39], v[20:23]
  s_bitcmp1_b32 s54, 9
  s_cbranch_scc1 E_0_3_10
E_0_2_10:
  v_lshlrev_b32_sdwa v56, 3, v84 dst_sel:DWORD dst_unused:UNUSED_PAD src0_sel:DWORD src1_sel:WORD_0
  v_lshlrev_b32_sdwa v57, 3, v84 dst_sel:DWORD dst_unused:UNUSED_PAD src0_sel:DWORD src1_sel:WORD_1
  v_lshlrev_b32_sdwa v58, 3, v85 dst_sel:DWORD dst_unused:UNUSED_PAD src0_sel:DWORD src1_sel:WORD_0
  v_lshlrev_b32_sdwa v59, 3, v85 dst_sel:DWORD dst_unused:UNUSED_PAD src0_sel:DWORD src1_sel:WORD_1
  ds_read_b64 v[32:33], v56
  ds_read_b64 v[34:35], v57
  ds_read_b64 v[36:37], v58
  ds_read_b64 v[38:39], v59
  s_waitcnt lgkmcnt(4)
  v_mfma_f32_16x16x32_bf16 v[20:23], v[28:31], v[40:43], v[20:23]
  s_bitcmp1_b32 s54, 10
  s_cbranch_scc1 E_0_3_11
E_0_2_11:
  v_mfma_f32_16x16x32_bf16 v[20:23], v[28:31], v[44:47], v[20:23]
  s_bitcmp1_b32 s54, 11
  s_cbranch_scc1 E_0_3_12
E_0_2_12:
  s_setprio 0
  v_lshlrev_b32_sdwa v56, 3, v86 dst_sel:DWORD dst_unused:UNUSED_PAD src0_sel:DWORD src1_sel:WORD_0
  v_lshlrev_b32_sdwa v57, 3, v86 dst_sel:DWORD dst_unused:UNUSED_PAD src0_sel:DWORD src1_sel:WORD_1
  v_lshlrev_b32_sdwa v58, 3, v87 dst_sel:DWORD dst_unused:UNUSED_PAD src0_sel:DWORD src1_sel:WORD_0
  v_lshlrev_b32_sdwa v59, 3, v87 dst_sel:DWORD dst_unused:UNUSED_PAD src0_sel:DWORD src1_sel:WORD_1
  ds_read_b64 v[40:41], v56
  ds_read_b64 v[42:43], v57
  ds_read_b64 v[44:45], v58
  ds_read_b64 v[46:47], v59
  s_waitcnt lgkmcnt(4)
  v_mfma_f32_16x16x32_bf16 v[20:23], v[28:31], v[32:35], v[20:23]
  s_bitcmp1_b32 s54, 12
  s_cbranch_scc1 E_0_3_13
E_0_2_13:
  v_mfma_f32_16x16x32_bf16 v[20:23], v[28:31], v[36:39], v[20:23]
  s_bitcmp1_b32 s54, 13
  s_cbranch_scc1 E_0_3_14
E_0_2_14:
  v_lshlrev_b32_sdwa v56, 3, v88 dst_sel:DWORD dst_unused:UNUSED_PAD src0_sel:DWORD src1_sel:WORD_0
  v_lshlrev_b32_sdwa v57, 3, v88 dst_sel:DWORD dst_unused:UNUSED_PAD src0_sel:DWORD src1_sel:WORD_1
  v_lshlrev_b32_sdwa v58, 3, v89 dst_sel:DWORD dst_unused:UNUSED_PAD src0_sel:DWORD src1_sel:WORD_0
  v_lshlrev_b32_sdwa v59, 3, v89 dst_sel:DWORD dst_unused:UNUSED_PAD src0_sel:DWORD src1_sel:WORD_1
  ds_read_b64 v[32:33], v56
  ds_read_b64 v[34:35], v57
  ds_read_b64 v[36:37], v58
  ds_read_b64 v[38:39], v59
  s_waitcnt lgkmcnt(4)
  v_mfma_f32_16x16x32_bf16 v[20:23], v[28:31], v[40:43], v[20:23]
  s_bitcmp1_b32 s54, 14
  s_cbranch_scc1 E_0_3_15
E_0_2_15:
  v_mfma_f32_16x16x32_bf16 v[20:23], v[28:31], v[44:47], v[20:23]
  s_bitcmp1_b32 s54, 15
  s_cbranch_scc1 E_0_3_16
E_0_2_16:
  s_waitcnt lgkmcnt(0)
  v_mfma_f32_16x16x32_bf16 v[20:23], v[28:31], v[32:35], v[20:23]
  s_bitcmp1_b32 s54, 16
  s_cbranch_scc1 E_0_3_17
E_0_2_17:
  v_mfma_f32_16x16x32_bf16 v[20:23], v[28:31], v[36:39], v[20:23]
  s_branch PE_0
E_0_3_0:
  s_cmp_le_u32 s32, 2
  s_cbranch_scc1 T_0_0
  v_lshlrev_b32_sdwa v56, 3, v74 dst_sel:DWORD dst_unused:UNUSED_PAD src0_sel:DWORD src1_sel:WORD_0
  v_lshlrev_b32_sdwa v57, 3, v74 dst_sel:DWORD dst_unused:UNUSED_PAD src0_sel:DWORD src1_sel:WORD_1
  v_lshlrev_b32_sdwa v58, 3, v75 dst_sel:DWORD dst_unused:UNUSED_PAD src0_sel:DWORD src1_sel:WORD_0
  v_lshlrev_b32_sdwa v59, 3, v75 dst_sel:DWORD dst_unused:UNUSED_PAD src0_sel:DWORD src1_sel:WORD_1
  ds_read_b64 v[40:41], v56
  ds_read_b64 v[42:43], v57
  ds_read_b64 v[44:45], v58
  ds_read_b64 v[46:47], v59
  s_add_u32 m0, s56, 79872
  s_add_u32 s3, s56, 40960
  buffer_load_dwordx4 v10, s[8:11], s3 offen sc1 lds
  s_waitcnt lgkmcnt(4)
M_0_0:
  v_mfma_f32_16x16x32_bf16 v[24:27], v[28:31], v[32:35], v[24:27]
  s_bitcmp1_b32 s54, 0
  s_cbranch_scc1 PE_0
E_0_3_1:
  v_mfma_f32_16x16x32_bf16 v[24:27], v[28:31], v[36:39], v[24:27]
  s_bitcmp1_b32 s54, 1
  s_cbranch_scc1 PE_0
E_0_3_2:
  s_cmp_le_u32 s32, 4
  s_cbranch_scc1 T_0_2
  v_lshlrev_b32_sdwa v56, 3, v76 dst_sel:DWORD dst_unused:UNUSED_PAD src0_sel:DWORD src1_sel:WORD_0
  v_lshlrev_b32_sdwa v57, 3, v76 dst_sel:DWORD dst_unused:UNUSED_PAD src0_sel:DWORD src1_sel:WORD_1
  v_lshlrev_b32_sdwa v58, 3, v77 dst_sel:DWORD dst_unused:UNUSED_PAD src0_sel:DWORD src1_sel:WORD_0
  v_lshlrev_b32_sdwa v59, 3, v77 dst_sel:DWORD dst_unused:UNUSED_PAD src0_sel:DWORD src1_sel:WORD_1
  ds_read_b64 v[32:33], v56
  ds_read_b64 v[34:35], v57
  ds_read_b64 v[36:37], v58
  ds_read_b64 v[38:39], v59
  s_add_u32 m0, s56, 96256
  s_add_u32 s3, s56, 57344
  buffer_load_dwordx4 v10, s[8:11], s3 offen sc1 lds
  s_waitcnt lgkmcnt(4)
M_0_2:
  v_mfma_f32_16x16x32_bf16 v[24:27], v[28:31], v[40:43], v[24:27]
  s_bitcmp1_b32 s54, 2
  s_cbranch_scc1 PE_0
E_0_3_3:
  v_mfma_f32_16x16x32_bf16 v[24:27], v[28:31], v[44:47], v[24:27]
  s_bitcmp1_b32 s54, 3
  s_cbranch_scc1 PE_0
E_0_3_4:
  s_setprio 2
  s_cmp_le_u32 s32, 6
  s_cbranch_scc1 T_0_4
  v_lshlrev_b32_sdwa v56, 3, v78 dst_sel:DWORD dst_unused:UNUSED_PAD src0_sel:DWORD src1_sel:WORD_0
  v_lshlrev_b32_sdwa v57, 3, v78 dst_sel:DWORD dst_unused:UNUSED_PAD src0_sel:DWORD src1_sel:WORD_1
  v_lshlrev_b32_sdwa v58, 3, v79 dst_sel:DWORD dst_unused:UNUSED_PAD src0_sel:DWORD src1_sel:WORD_0
  v_lshlrev_b32_sdwa v59, 3, v79 dst_sel:DWORD dst_unused:UNUSED_PAD src0_sel:DWORD src1_sel:WORD_1
  ds_read_b64 v[40:41], v56
  ds_read_b64 v[42:43], v57
  ds_read_b64 v[44:45], v58
  ds_read_b64 v[46:47], v59
  s_add_u32 m0, s56, 112640
  s_add_u32 s3, s56, 73728
  buffer_load_dwordx4 v10, s[8:11], s3 offen sc1 lds
  s_waitcnt lgkmcnt(4)
M_0_4:
  v_mfma_f32_16x16x32_bf16 v[24:27], v[28:31], v[32:35], v[24:27]
  s_bitcmp1_b32 s54, 4
  s_cbranch_scc1 PE_0
E_0_3_5:
  v_mfma_f32_16x16x32_bf16 v[24:27], v[28:31], v[36:39], v[24:27]
  s_bitcmp1_b32 s54, 5
  s_cbranch_scc1 PE_0
E_0_3_6:
  s_cmp_le_u32 s32, 8
  s_cbranch_scc1 T_0_6
  v_lshlrev_b32_sdwa v56, 3, v80 dst_sel:DWORD dst_unused:UNUSED_PAD src0_sel:DWORD src1_sel:WORD_0
  v_lshlrev_b32_sdwa v57, 3, v80 dst_sel:DWORD dst_unused:UNUSED_PAD src0_sel:DWORD src1_sel:WORD_1
  v_lshlrev_b32_sdwa v58, 3, v81 dst_sel:DWORD dst_unused:UNUSED_PAD src0_sel:DWORD src1_sel:WORD_0
  v_lshlrev_b32_sdwa v59, 3, v81 dst_sel:DWORD dst_unused:UNUSED_PAD src0_sel:DWORD src1_sel:WORD_1
  ds_read_b64 v[32:33], v56
  ds_read_b64 v[34:35], v57
  ds_read_b64 v[36:37], v58
  ds_read_b64 v[38:39], v59
  s_add_u32 m0, s56, 129024
  s_add_u32 s3, s56, 90112
  buffer_load_dwordx4 v10, s[8:11], s3 offen sc1 lds
  s_waitcnt lgkmcnt(4)
M_0_6:
  v_mfma_f32_16x16x32_bf16 v[24:27], v[28:31], v[40:43], v[24:27]
  s_bitcmp1_b32 s54, 6
  s_cbranch_scc1 PE_0
E_0_3_7:
  v_mfma_f32_16x16x32_bf16 v[24:27], v[28:31], v[44:47], v[24:27]
  s_bitcmp1_b32 s54, 7
  s_cbranch_scc1 PE_0
E_0_3_8:
  s_setprio 1
  s_cmp_le_u32 s32, 10
  s_cbranch_scc1 T_0_8
  v_lshlrev_b32_sdwa v56, 3, v82 dst_sel:DWORD dst_unused:UNUSED_PAD src0_sel:DWORD src1_sel:WORD_0
  v_lshlrev_b32_sdwa v57, 3, v82 dst_sel:DWORD dst_unused:UNUSED_PAD src0_sel:DWORD src1_sel:WORD_1
  v_lshlrev_b32_sdwa v58, 3, v83 dst_sel:DWORD dst_unused:UNUSED_PAD src0_sel:DWORD src1_sel:WORD_0
  v_lshlrev_b32_sdwa v59, 3, v83 dst_sel:DWORD dst_unused:UNUSED_PAD src0_sel:DWORD src1_sel:WORD_1
  ds_read_b64 v[40:41], v56
  ds_read_b64 v[42:43], v57
  ds_read_b64 v[44:45], v58
  ds_read_b64 v[46:47], v59
  s_waitcnt lgkmcnt(4)
M_0_8:
  v_mfma_f32_16x16x32_bf16 v[24:27], v[28:31], v[32:35], v[24:27]
  s_bitcmp1_b32 s54, 8
  s_cbranch_scc1 PE_0
E_0_3_9:
  v_mfma_f32_16x16x32_bf16 v[24:27], v[28:31], v[36:39], v[24:27]
  s_bitcmp1_b32 s54, 9
  s_cbranch_scc1 PE_0
E_0_3_10:
  s_cmp_le_u32 s32, 12
  s_cbranch_scc1 T_0_10
  v_lshlrev_b32_sdwa v56, 3, v84 dst_sel:DWORD dst_unused:UNUSED_PAD src0_sel:DWORD src1_sel:WORD_0
  v_lshlrev_b32_sdwa v57, 3, v84 dst_sel:DWORD dst_unused:UNUSED_PAD src0_sel:DWORD src1_sel:WORD_1
  v_lshlrev_b32_sdwa v58, 3, v85 dst_sel:DWORD dst_unused:UNUSED_PAD src0_sel:DWORD src1_sel:WORD_0
  v_lshlrev_b32_sdwa v59, 3, v85 dst_sel:DWORD dst_unused:UNUSED_PAD src0_sel:DWORD src1_sel:WORD_1
  ds_read_b64 v[32:33], v56
  ds_read_b64 v[34:35], v57
  ds_read_b64 v[36:37], v58
  ds_read_b64 v[38:39], v59
  s_waitcnt lgkmcnt(4)
M_0_10:
  v_mfma_f32_16x16x32_bf16 v[24:27], v[28:31], v[40:43], v[24:27]
  s_bitcmp1_b32 s54, 10
  s_cbranch_scc1 PE_0
E_0_3_11:
  v_mfma_f32_16x16x32_bf16 v[24:27], v[28:31], v[44:47], v[24:27]
  s_bitcmp1_b32 s54, 11
  s_cbranch_scc1 PE_0
E_0_3_12:
  s_setprio 0
  s_cmp_le_u32 s32, 14
  s_cbranch_scc1 T_0_12
  v_lshlrev_b32_sdwa v56, 3, v86 dst_sel:DWORD dst_unused:UNUSED_PAD src0_sel:DWORD src1_sel:WORD_0
  v_lshlrev_b32_sdwa v57, 3, v86 dst_sel:DWORD dst_unused:UNUSED_PAD src0_sel:DWORD src1_sel:WORD_1
  v_lshlrev_b32_sdwa v58, 3, v87 dst_sel:DWORD dst_unused:UNUSED_PAD src0_sel:DWORD src1_sel:WORD_0
  v_lshlrev_b32_sdwa v59, 3, v87 dst_sel:DWORD dst_unused:UNUSED_PAD src0_sel:DWORD src1_sel:WORD_1
  ds_read_b64 v[40:41], v56
  ds_read_b64 v[42:43], v57
  ds_read_b64 v[44:45], v58
  ds_read_b64 v[46:47], v59
  s_waitcnt lgkmcnt(4)
M_0_12:
  v_mfma_f32_16x16x32_bf16 v[24:27], v[28:31], v[32:35], v[24:27]
  s_bitcmp1_b32 s54, 12
  s_cbranch_scc1 PE_0
E_0_3_13:
  v_mfma_f32_16x16x32_bf16 v[24:27], v[28:31], v[36:39], v[24:27]
  s_bitcmp1_b32 s54, 13
  s_cbranch_scc1 PE_0
E_0_3_14:
  s_cmp_le_u32 s32, 16
  s_cbranch_scc1 T_0_14
  v_lshlrev_b32_sdwa v56, 3, v88 dst_sel:DWORD dst_unused:UNUSED_PAD src0_sel:DWORD src1_sel:WORD_0
  v_lshlrev_b32_sdwa v57, 3, v88 dst_sel:DWORD dst_unused:UNUSED_PAD src0_sel:DWORD src1_sel:WORD_1
  v_lshlrev_b32_sdwa v58, 3, v89 dst_sel:DWORD dst_unused:UNUSED_PAD src0_sel:DWORD src1_sel:WORD_0
  v_lshlrev_b32_sdwa v59, 3, v89 dst_sel:DWORD dst_unused:UNUSED_PAD src0_sel:DWORD src1_sel:WORD_1
  ds_read_b64 v[32:33], v56
  ds_read_b64 v[34:35], v57
  ds_read_b64 v[36:37], v58
  ds_read_b64 v[38:39], v59
  s_waitcnt lgkmcnt(4)
M_0_14:
  v_mfma_f32_16x16x32_bf16 v[24:27], v[28:31], v[40:43], v[24:27]
  s_bitcmp1_b32 s54, 14
  s_cbranch_scc1 PE_0
E_0_3_15:
  v_mfma_f32_16x16x32_bf16 v[24:27], v[28:31], v[44:47], v[24:27]
  s_bitcmp1_b32 s54, 15
  s_cbranch_scc1 PE_0
E_0_3_16:
  s_waitcnt lgkmcnt(0)
  v_mfma_f32_16x16x32_bf16 v[24:27], v[28:31], v[32:35], v[24:27]
  s_bitcmp1_b32 s54, 16
  s_cbranch_scc1 PE_0
E_0_3_17:
  v_mfma_f32_16x16x32_bf16 v[24:27], v[28:31], v[36:39], v[24:27]
  s_branch PE_0
T_0_0:
  s_add_u32 m0, s56, 79872
  s_add_u32 s3, s56, 40960
  buffer_load_dwordx4 v10, s[8:11], s3 offen sc1 lds
  s_waitcnt lgkmcnt(0)
  s_branch M_0_0
T_0_2:
  s_add_u32 m0, s56, 96256
  s_add_u32 s3, s56, 57344
  buffer_load_dwordx4 v10, s[8:11], s3 offen sc1 lds
  s_waitcnt lgkmcnt(0)
  s_branch M_0_2
T_0_4:
  s_add_u32 m0, s56, 112640
  s_add_u32 s3, s56, 73728
  buffer_load_dwordx4 v10, s[8:11], s3 offen sc1 lds
  s_waitcnt lgkmcnt(0)
  s_branch M_0_4
T_0_6:
  s_add_u32 m0, s56, 129024
  s_add_u32 s3, s56, 90112
  buffer_load_dwordx4 v10, s[8:11], s3 offen sc1 lds
  s_waitcnt lgkmcnt(0)
  s_branch M_0_6
T_0_8:
  s_waitcnt lgkmcnt(0)
  s_branch M_0_8
T_0_10:
  s_waitcnt lgkmcnt(0)
  s_branch M_0_10
T_0_12:
  s_waitcnt lgkmcnt(0)
  s_branch M_0_12
T_0_14:
  s_waitcnt lgkmcnt(0)
  s_branch M_0_14
E_1_1_0:
  v_lshlrev_b32_sdwa v56, 3, v92 dst_sel:DWORD dst_unused:UNUSED_PAD src0_sel:DWORD src1_sel:WORD_0
  v_lshlrev_b32_sdwa v57, 3, v92 dst_sel:DWORD dst_unused:UNUSED_PAD src0_sel:DWORD src1_sel:WORD_1
  v_lshlrev_b32_sdwa v58, 3, v93 dst_sel:DWORD dst_unused:UNUSED_PAD src0_sel:DWORD src1_sel:WORD_0
  v_lshlrev_b32_sdwa v59, 3, v93 dst_sel:DWORD dst_unused:UNUSED_PAD src0_sel:DWORD src1_sel:WORD_1
  ds_read_b64 v[40:41], v56
  ds_read_b64 v[42:43], v57
  ds_read_b64 v[44:45], v58
  ds_read_b64 v[46:47], v59
  s_add_u32 m0, s56, 0
  s_add_u32 s3, s56, 120832
  buffer_load_dwordx4 v10, s[8:11], s3 offen sc1 lds
  s_waitcnt lgkmcnt(4)
  v_mfma_f32_16x16x32_bf16 v[16:19], v[28:31], v[32:35], v[16:19]
  s_bitcmp1_b32 s54, 0
  s_cbranch_scc1 E_1_2_1
E_1_1_1:
  v_mfma_f32_16x16x32_bf16 v[16:19], v[28:31], v[36:39], v[16:19]
  s_bitcmp1_b32 s54, 1
  s_cbranch_scc1 E_1_2_2
E_1_1_2:
  v_lshlrev_b32_sdwa v56, 3, v94 dst_sel:DWORD dst_unused:UNUSED_PAD src0_sel:DWORD src1_sel:WORD_0
  v_lshlrev_b32_sdwa v57, 3, v94 dst_sel:DWORD dst_unused:UNUSED_PAD src0_sel:DWORD src1_sel:WORD_1
  v_lshlrev_b32_sdwa v58, 3, v95 dst_sel:DWORD dst_unused:UNUSED_PAD src0_sel:DWORD src1_sel:WORD_0
  v_lshlrev_b32_sdwa v59, 3, v95 dst_sel:DWORD dst_unused:UNUSED_PAD src0_sel:DWORD src1_sel:WORD_1
  ds_read_b64 v[32:33], v56
  ds_read_b64 v[34:35], v57
  ds_read_b64 v[36:37], v58
  ds_read_b64 v[38:39], v59
  s_add_u32 m0, s56, 16384
  s_add_u32 s3, s56, 137216
  buffer_load_dwordx4 v10, s[8:11], s3 offen sc1 lds
  s_waitcnt lgkmcnt(4)
  v_mfma_f32_16x16x32_bf16 v[16:19], v[28:31], v[40:43], v[16:19]
  s_bitcmp1_b32 s54, 2
  s_cbranch_scc1 E_1_2_3
E_1_1_3:
  v_mfma_f32_16x16x32_bf16 v[16:19], v[28:31], v[44:47], v[16:19]
  s_bitcmp1_b32 s54, 3
  s_cbranch_scc1 E_1_2_4
E_1_1_4:
  s_setprio 2
  v_lshlrev_b32_sdwa v56, 3, v96 dst_sel:DWORD dst_unused:UNUSED_PAD src0_sel:DWORD src1_sel:WORD_0
  v_lshlrev_b32_sdwa v57, 3, v96 dst_sel:DWORD dst_unused:UNUSED_PAD src0_sel:DWORD src1_sel:WORD_1
  v_lshlrev_b32_sdwa v58, 3, v97 dst_sel:DWORD dst_unused:UNUSED_PAD src0_sel:DWORD src1_sel:WORD_0
  v_lshlrev_b32_sdwa v59, 3, v97 dst_sel:DWORD dst_unused:UNUSED_PAD src0_sel:DWORD src1_sel:WORD_1
  ds_read_b64 v[40:41], v56
  ds_read_b64 v[42:43], v57
  ds_read_b64 v[44:45], v58
  ds_read_b64 v[46:47], v59
  s_add_u32 m0, s56, 32768
  s_add_u32 s3, s56, 153600
  buffer_load_dwordx4 v10, s[8:11], s3 offen sc1 lds
  s_waitcnt lgkmcnt(4)
  v_mfma_f32_16x16x32_bf16 v[16:19], v[28:31], v[32:35], v[16:19]
  s_bitcmp1_b32 s54, 4
  s_cbranch_scc1 E_1_2_5
E_1_1_5:
  v_mfma_f32_16x16x32_bf16 v[16:19], v[28:31], v[36:39], v[16:19]
  s_bitcmp1_b32 s54, 5
  s_cbranch_scc1 E_1_2_6
E_1_1_6:
  v_lshlrev_b32_sdwa v56, 3, v98 dst_sel:DWORD dst_unused:UNUSED_PAD src0_sel:DWORD src1_sel:WORD_0
  v_lshlrev_b32_sdwa v57, 3, v98 dst_sel:DWORD dst_unused:UNUSED_PAD src0_sel:DWORD src1_sel:WORD_1
  v_lshlrev_b32_sdwa v58, 3, v99 dst_sel:DWORD dst_unused:UNUSED_PAD src0_sel:DWORD src1_sel:WORD_0
  v_lshlrev_b32_sdwa v59, 3, v99 dst_sel:DWORD dst_unused:UNUSED_PAD src0_sel:DWORD src1_sel:WORD_1
  ds_read_b64 v[32:33], v56
  ds_read_b64 v[34:35], v57
  ds_read_b64 v[36:37], v58
  ds_read_b64 v[38:39], v59
  s_add_u32 m0, s56, 49152
  s_add_u32 s3, s56, 169984
  buffer_load_dwordx4 v10, s[8:11], s3 offen sc1 lds
  s_waitcnt lgkmcnt(4)
  v_mfma_f32_16x16x32_bf16 v[16:19], v[28:31], v[40:43], v[16:19]
  s_bitcmp1_b32 s54, 6
  s_cbranch_scc1 E_1_2_7
E_1_1_7:
  v_mfma_f32_16x16x32_bf16 v[16:19], v[28:31], v[44:47], v[16:19]
  s_bitcmp1_b32 s54, 7
  s_cbranch_scc1 E_1_2_8
E_1_1_8:
  s_setprio 1
  v_lshlrev_b32_sdwa v56, 3, v100 dst_sel:DWORD dst_unused:UNUSED_PAD src0_sel:DWORD src1_sel:WORD_0
  v_lshlrev_b32_sdwa v57, 3, v100 dst_sel:DWORD dst_unused:UNUSED_PAD src0_sel:DWORD src1_sel:WORD_1
  v_lshlrev_b32_sdwa v58, 3, v101 dst_sel:DWORD dst_unused:UNUSED_PAD src0_sel:DWORD src1_sel:WORD_0
  v_lshlrev_b32_sdwa v59, 3, v101 dst_sel:DWORD dst_unused:UNUSED_PAD src0_sel:DWORD src1_sel:WORD_1
  ds_read_b64 v[40:41], v56
  ds_read_b64 v[42:43], v57
  ds_read_b64 v[44:45], v58
  ds_read_b64 v[46:47], v59
  s_waitcnt lgkmcnt(4)
  v_mfma_f32_16x16x32_bf16 v[16:19], v[28:31], v[32:35], v[16:19]
  s_bitcmp1_b32 s54, 8
  s_cbranch_scc1 E_1_2_9
E_1_1_9:
  v_mfma_f32_16x16x32_bf16 v[16:19], v[28:31], v[36:39], v[16:19]
  s_bitcmp1_b32 s54, 9
  s_cbranch_scc1 E_1_2_10
E_1_1_10:
  v_lshlrev_b32_sdwa v56, 3, v102 dst_sel:DWORD dst_unused:UNUSED_PAD src0_sel:DWORD src1_sel:WORD_0
  v_lshlrev_b32_sdwa v57, 3, v102 dst_sel:DWORD dst_unused:UNUSED_PAD src0_sel:DWORD src1_sel:WORD_1
  v_lshlrev_b32_sdwa v58, 3, v103 dst_sel:DWORD dst_unused:UNUSED_PAD src0_sel:DWORD src1_sel:WORD_0
  v_lshlrev_b32_sdwa v59, 3, v103 dst_sel:DWORD dst_unused:UNUSED_PAD src0_sel:DWORD src1_sel:WORD_1
  ds_read_b64 v[32:33], v56
  ds_read_b64 v[34:35], v57
  ds_read_b64 v[36:37], v58
  ds_read_b64 v[38:39], v59
  s_waitcnt lgkmcnt(4)
  v_mfma_f32_16x16x32_bf16 v[16:19], v[28:31], v[40:43], v[16:19]
  s_bitcmp1_b32 s54, 10
  s_cbranch_scc1 E_1_2_11
E_1_1_11:
  v_mfma_f32_16x16x32_bf16 v[16:19], v[28:31], v[44:47], v[16:19]
  s_bitcmp1_b32 s54, 11
  s_cbranch_scc1 E_1_2_12
E_1_1_12:
  s_setprio 0
  v_lshlrev_b32_sdwa v56, 3, v104 dst_sel:DWORD dst_unused:UNUSED_PAD src0_sel:DWORD src1_sel:WORD_0
  v_lshlrev_b32_sdwa v57, 3, v104 dst_sel:DWORD dst_unused:UNUSED_PAD src0_sel:DWORD src1_sel:WORD_1
  v_lshlrev_b32_sdwa v58, 3, v105 dst_sel:DWORD dst_unused:UNUSED_PAD src0_sel:DWORD src1_sel:WORD_0
  v_lshlrev_b32_sdwa v59, 3, v105 dst_sel:DWORD dst_unused:UNUSED_PAD src0_sel:DWORD src1_sel:WORD_1
  ds_read_b64 v[40:41], v56
  ds_read_b64 v[42:43], v57
  ds_read_b64 v[44:45], v58
  ds_read_b64 v[46:47], v59
  s_waitcnt lgkmcnt(4)
  v_mfma_f32_16x16x32_bf16 v[16:19], v[28:31], v[32:35], v[16:19]
  s_bitcmp1_b32 s54, 12
  s_cbranch_scc1 E_1_2_13
E_1_1_13:
  v_mfma_f32_16x16x32_bf16 v[16:19], v[28:31], v[36:39], v[16:19]
  s_bitcmp1_b32 s54, 13
  s_cbranch_scc1 E_1_2_14
E_1_1_14:
  v_lshlrev_b32_sdwa v56, 3, v106 dst_sel:DWORD dst_unused:UNUSED_PAD src0_sel:DWORD src1_sel:WORD_0
  v_lshlrev_b32_sdwa v57, 3, v106 dst_sel:DWORD dst_unused:UNUSED_PAD src0_sel:DWORD src1_sel:WORD_1
  v_lshlrev_b32_sdwa v58, 3, v107 dst_sel:DWORD dst_unused:UNUSED_PAD src0_sel:DWORD src1_sel:WORD_0
  v_lshlrev_b32_sdwa v59, 3, v107 dst_sel:DWORD dst_unused:UNUSED_PAD src0_sel:DWORD src1_sel:WORD_1
  ds_read_b64 v[32:33], v56
  ds_read_b64 v[34:35], v57
  ds_read_b64 v[36:37], v58
  ds_read_b64 v[38:39], v59
  s_waitcnt lgkmcnt(4)
  v_mfma_f32_16x16x32_bf16 v[16:19], v[28:31], v[40:43], v[16:19]
  s_bitcmp1_b32 s54, 14
  s_cbranch_scc1 E_1_2_15
E_1_1_15:
  v_mfma_f32_16x16x32_bf16 v[16:19], v[28:31], v[44:47], v[16:19]
  s_bitcmp1_b32 s54, 15
  s_cbranch_scc1 E_1_2_16
E_1_1_16:
  s_waitcnt lgkmcnt(0)
  v_mfma_f32_16x16x32_bf16 v[16:19], v[28:31], v[32:35], v[16:19]
  s_bitcmp1_b32 s54, 16
  s_cbranch_scc1 E_1_2_17
E_1_1_17:
  v_mfma_f32_16x16x32_bf16 v[16:19], v[28:31], v[36:39], v[16:19]
  s_branch PE_1
E_1_2_0:
  v_lshlrev_b32_sdwa v56, 3, v92 dst_sel:DWORD dst_unused:UNUSED_PAD src0_sel:DWORD src1_sel:WORD_0
  v_lshlrev_b32_sdwa v57, 3, v92 dst_sel:DWORD dst_unused:UNUSED_PAD src0_sel:DWORD src1_sel:WORD_1
  v_lshlrev_b32_sdwa v58, 3, v93 dst_sel:DWORD dst_unused:UNUSED_PAD src0_sel:DWORD src1_sel:WORD_0
  v_lshlrev_b32_sdwa v59, 3, v93 dst_sel:DWORD dst_unused:UNUSED_PAD src0_sel:DWORD src1_sel:WORD_1
  ds_read_b64 v[40:41], v56
  ds_read_b64 v[42:43], v57
  ds_read_b64 v[44:45], v58
  ds_read_b64 v[46:47], v59
  s_add_u32 m0, s56, 0
  s_add_u32 s3, s56, 120832
  buffer_load_dwordx4 v10, s[8:11], s3 offen sc1 lds
  s_waitcnt lgkmcnt(4)
  v_mfma_f32_16x16x32_bf16 v[20:23], v[28:31], v[32:35], v[20:23]
  s_bitcmp1_b32 s54, 0
  s_cbranch_scc1 E_1_3_1
E_1_2_1:
  v_mfma_f32_16x16x32_bf16 v[20:23], v[28:31], v[36:39], v[20:23]
  s_bitcmp1_b32 s54, 1
  s_cbranch_scc1 E_1_3_2
E_1_2_2:
  v_lshlrev_b32_sdwa v56, 3, v94 dst_sel:DWORD dst_unused:UNUSED_PAD src0_sel:DWORD src1_sel:WORD_0
  v_lshlrev_b32_sdwa v57, 3, v94 dst_sel:DWORD dst_unused:UNUSED_PAD src0_sel:DWORD src1_sel:WORD_1
  v_lshlrev_b32_sdwa v58, 3, v95 dst_sel:DWORD dst_unused:UNUSED_PAD src0_sel:DWORD src1_sel:WORD_0
  v_lshlrev_b32_sdwa v59, 3, v95 dst_sel:DWORD dst_unused:UNUSED_PAD src0_sel:DWORD src1_sel:WORD_1
  ds_read_b64 v[32:33], v56
  ds_read_b64 v[34:35], v57
  ds_read_b64 v[36:37], v58
  ds_read_b64 v[38:39], v59
  s_add_u32 m0, s56, 16384
  s_add_u32 s3, s56, 137216
  buffer_load_dwordx4 v10, s[8:11], s3 offen sc1 lds
  s_waitcnt lgkmcnt(4)
  v_mfma_f32_16x16x32_bf16 v[20:23], v[28:31], v[40:43], v[20:23]
  s_bitcmp1_b32 s54, 2
  s_cbranch_scc1 E_1_3_3
E_1_2_3:
  v_mfma_f32_16x16x32_bf16 v[20:23], v[28:31], v[44:47], v[20:23]
  s_bitcmp1_b32 s54, 3
  s_cbranch_scc1 E_1_3_4
E_1_2_4:
  s_setprio 2
  v_lshlrev_b32_sdwa v56, 3, v96 dst_sel:DWORD dst_unused:UNUSED_PAD src0_sel:DWORD src1_sel:WORD_0
  v_lshlrev_b32_sdwa v57, 3, v96 dst_sel:DWORD dst_unused:UNUSED_PAD src0_sel:DWORD src1_sel:WORD_1
  v_lshlrev_b32_sdwa v58, 3, v97 dst_sel:DWORD dst_unused:UNUSED_PAD src0_sel:DWORD src1_sel:WORD_0
  v_lshlrev_b32_sdwa v59, 3, v97 dst_sel:DWORD dst_unused:UNUSED_PAD src0_sel:DWORD src1_sel:WORD_1
  ds_read_b64 v[40:41], v56
  ds_read_b64 v[42:43], v57
  ds_read_b64 v[44:45], v58
  ds_read_b64 v[46:47], v59
  s_add_u32 m0, s56, 32768
  s_add_u32 s3, s56, 153600
  buffer_load_dwordx4 v10, s[8:11], s3 offen sc1 lds
  s_waitcnt lgkmcnt(4)
  v_mfma_f32_16x16x32_bf16 v[20:23], v[28:31], v[32:35], v[20:23]
  s_bitcmp1_b32 s54, 4
  s_cbranch_scc1 E_1_3_5
E_1_2_5:
  v_mfma_f32_16x16x32_bf16 v[20:23], v[28:31], v[36:39], v[20:23]
  s_bitcmp1_b32 s54, 5
  s_cbranch_scc1 E_1_3_6
E_1_2_6:
  v_lshlrev_b32_sdwa v56, 3, v98 dst_sel:DWORD dst_unused:UNUSED_PAD src0_sel:DWORD src1_sel:WORD_0
  v_lshlrev_b32_sdwa v57, 3, v98 dst_sel:DWORD dst_unused:UNUSED_PAD src0_sel:DWORD src1_sel:WORD_1
  v_lshlrev_b32_sdwa v58, 3, v99 dst_sel:DWORD dst_unused:UNUSED_PAD src0_sel:DWORD src1_sel:WORD_0
  v_lshlrev_b32_sdwa v59, 3, v99 dst_sel:DWORD dst_unused:UNUSED_PAD src0_sel:DWORD src1_sel:WORD_1
  ds_read_b64 v[32:33], v56
  ds_read_b64 v[34:35], v57
  ds_read_b64 v[36:37], v58
  ds_read_b64 v[38:39], v59
  s_add_u32 m0, s56, 49152
  s_add_u32 s3, s56, 169984
  buffer_load_dwordx4 v10, s[8:11], s3 offen sc1 lds
  s_waitcnt lgkmcnt(4)
  v_mfma_f32_16x16x32_bf16 v[20:23], v[28:31], v[40:43], v[20:23]
  s_bitcmp1_b32 s54, 6
  s_cbranch_scc1 E_1_3_7
E_1_2_7:
  v_mfma_f32_16x16x32_bf16 v[20:23], v[28:31], v[44:47], v[20:23]
  s_bitcmp1_b32 s54, 7
  s_cbranch_scc1 E_1_3_8
E_1_2_8:
  s_setprio 1
  v_lshlrev_b32_sdwa v56, 3, v100 dst_sel:DWORD dst_unused:UNUSED_PAD src0_sel:DWORD src1_sel:WORD_0
  v_lshlrev_b32_sdwa v57, 3, v100 dst_sel:DWORD dst_unused:UNUSED_PAD src0_sel:DWORD src1_sel:WORD_1
  v_lshlrev_b32_sdwa v58, 3, v101 dst_sel:DWORD dst_unused:UNUSED_PAD src0_sel:DWORD src1_sel:WORD_0
  v_lshlrev_b32_sdwa v59, 3, v101 dst_sel:DWORD dst_unused:UNUSED_PAD src0_sel:DWORD src1_sel:WORD_1
  ds_read_b64 v[40:41], v56
  ds_read_b64 v[42:43], v57
  ds_read_b64 v[44:45], v58
  ds_read_b64 v[46:47], v59
  s_waitcnt lgkmcnt(4)
  v_mfma_f32_16x16x32_bf16 v[20:23], v[28:31], v[32:35], v[20:23]
  s_bitcmp1_b32 s54, 8
  s_cbranch_scc1 E_1_3_9
E_1_2_9:
  v_mfma_f32_16x16x32_bf16 v[20:23], v[28:31], v[36:39], v[20:23]
  s_bitcmp1_b32 s54, 9
  s_cbranch_scc1 E_1_3_10
E_1_2_10:
  v_lshlrev_b32_sdwa v56, 3, v102 dst_sel:DWORD dst_unused:UNUSED_PAD src0_sel:DWORD src1_sel:WORD_0
  v_lshlrev_b32_sdwa v57, 3, v102 dst_sel:DWORD dst_unused:UNUSED_PAD src0_sel:DWORD src1_sel:WORD_1
  v_lshlrev_b32_sdwa v58, 3, v103 dst_sel:DWORD dst_unused:UNUSED_PAD src0_sel:DWORD src1_sel:WORD_0
  v_lshlrev_b32_sdwa v59, 3, v103 dst_sel:DWORD dst_unused:UNUSED_PAD src0_sel:DWORD src1_sel:WORD_1
  ds_read_b64 v[32:33], v56
  ds_read_b64 v[34:35], v57
  ds_read_b64 v[36:37], v58
  ds_read_b64 v[38:39], v59
  s_waitcnt lgkmcnt(4)
  v_mfma_f32_16x16x32_bf16 v[20:23], v[28:31], v[40:43], v[20:23]
  s_bitcmp1_b32 s54, 10
  s_cbranch_scc1 E_1_3_11
E_1_2_11:
  v_mfma_f32_16x16x32_bf16 v[20:23], v[28:31], v[44:47], v[20:23]
  s_bitcmp1_b32 s54, 11
  s_cbranch_scc1 E_1_3_12
E_1_2_12:
  s_setprio 0
  v_lshlrev_b32_sdwa v56, 3, v104 dst_sel:DWORD dst_unused:UNUSED_PAD src0_sel:DWORD src1_sel:WORD_0
  v_lshlrev_b32_sdwa v57, 3, v104 dst_sel:DWORD dst_unused:UNUSED_PAD src0_sel:DWORD src1_sel:WORD_1
  v_lshlrev_b32_sdwa v58, 3, v105 dst_sel:DWORD dst_unused:UNUSED_PAD src0_sel:DWORD src1_sel:WORD_0
  v_lshlrev_b32_sdwa v59, 3, v105 dst_sel:DWORD dst_unused:UNUSED_PAD src0_sel:DWORD src1_sel:WORD_1
  ds_read_b64 v[40:41], v56
  ds_read_b64 v[42:43], v57
  ds_read_b64 v[44:45], v58
  ds_read_b64 v[46:47], v59
  s_waitcnt lgkmcnt(4)
  v_mfma_f32_16x16x32_bf16 v[20:23], v[28:31], v[32:35], v[20:23]
  s_bitcmp1_b32 s54, 12
  s_cbranch_scc1 E_1_3_13
E_1_2_13:
  v_mfma_f32_16x16x32_bf16 v[20:23], v[28:31], v[36:39], v[20:23]
  s_bitcmp1_b32 s54, 13
  s_cbranch_scc1 E_1_3_14
E_1_2_14:
  v_lshlrev_b32_sdwa v56, 3, v106 dst_sel:DWORD dst_unused:UNUSED_PAD src0_sel:DWORD src1_sel:WORD_0
  v_lshlrev_b32_sdwa v57, 3, v106 dst_sel:DWORD dst_unused:UNUSED_PAD src0_sel:DWORD src1_sel:WORD_1
  v_lshlrev_b32_sdwa v58, 3, v107 dst_sel:DWORD dst_unused:UNUSED_PAD src0_sel:DWORD src1_sel:WORD_0
  v_lshlrev_b32_sdwa v59, 3, v107 dst_sel:DWORD dst_unused:UNUSED_PAD src0_sel:DWORD src1_sel:WORD_1
  ds_read_b64 v[32:33], v56
  ds_read_b64 v[34:35], v57
  ds_read_b64 v[36:37], v58
  ds_read_b64 v[38:39], v59
  s_waitcnt lgkmcnt(4)
  v_mfma_f32_16x16x32_bf16 v[20:23], v[28:31], v[40:43], v[20:23]
  s_bitcmp1_b32 s54, 14
  s_cbranch_scc1 E_1_3_15
E_1_2_15:
  v_mfma_f32_16x16x32_bf16 v[20:23], v[28:31], v[44:47], v[20:23]
  s_bitcmp1_b32 s54, 15
  s_cbranch_scc1 E_1_3_16
E_1_2_16:
  s_waitcnt lgkmcnt(0)
  v_mfma_f32_16x16x32_bf16 v[20:23], v[28:31], v[32:35], v[20:23]
  s_bitcmp1_b32 s54, 16
  s_cbranch_scc1 E_1_3_17
E_1_2_17:
  v_mfma_f32_16x16x32_bf16 v[20:23], v[28:31], v[36:39], v[20:23]
  s_branch PE_1
E_1_3_0:
  s_cmp_le_u32 s33, 2
  s_cbranch_scc1 T_1_0
  v_lshlrev_b32_sdwa v56, 3, v92 dst_sel:DWORD dst_unused:UNUSED_PAD src0_sel:DWORD src1_sel:WORD_0
  v_lshlrev_b32_sdwa v57, 3, v92 dst_sel:DWORD dst_unused:UNUSED_PAD src0_sel:DWORD src1_sel:WORD_1
  v_lshlrev_b32_sdwa v58, 3, v93 dst_sel:DWORD dst_unused:UNUSED_PAD src0_sel:DWORD src1_sel:WORD_0
  v_lshlrev_b32_sdwa v59, 3, v93 dst_sel:DWORD dst_unused:UNUSED_PAD src0_sel:DWORD src1_sel:WORD_1
  ds_read_b64 v[40:41], v56
  ds_read_b64 v[42:43], v57
  ds_read_b64 v[44:45], v58
  ds_read_b64 v[46:47], v59
  s_add_u32 m0, s56, 0
  s_add_u32 s3, s56, 120832
  buffer_load_dwordx4 v10, s[8:11], s3 offen sc1 lds
  s_waitcnt lgkmcnt(4)
M_1_0:
  v_mfma_f32_16x16x32_bf16 v[24:27], v[28:31], v[32:35], v[24:27]
  s_bitcmp1_b32 s54, 0
  s_cbranch_scc1 PE_1
E_1_3_1:
  v_mfma_f32_16x16x32_bf16 v[24:27], v[28:31], v[36:39], v[24:27]
  s_bitcmp1_b32 s54, 1
  s_cbranch_scc1 PE_1
E_1_3_2:
  s_cmp_le_u32 s33, 4
  s_cbranch_scc1 T_1_2
  v_lshlrev_b32_sdwa v56, 3, v94 dst_sel:DWORD dst_unused:UNUSED_PAD src0_sel:DWORD src1_sel:WORD_0
  v_lshlrev_b32_sdwa v57, 3, v94 dst_sel:DWORD dst_unused:UNUSED_PAD src0_sel:DWORD src1_sel:WORD_1
  v_lshlrev_b32_sdwa v58, 3, v95 dst_sel:DWORD dst_unused:UNUSED_PAD src0_sel:DWORD src1_sel:WORD_0
  v_lshlrev_b32_sdwa v59, 3, v95 dst_sel:DWORD dst_unused:UNUSED_PAD src0_sel:DWORD src1_sel:WORD_1
  ds_read_b64 v[32:33], v56
  ds_read_b64 v[34:35], v57
  ds_read_b64 v[36:37], v58
  ds_read_b64 v[38:39], v59
  s_add_u32 m0, s56, 16384
  s_add_u32 s3, s56, 137216
  buffer_load_dwordx4 v10, s[8:11], s3 offen sc1 lds
  s_waitcnt lgkmcnt(4)
M_1_2:
  v_mfma_f32_16x16x32_bf16 v[24:27], v[28:31], v[40:43], v[24:27]
  s_bitcmp1_b32 s54, 2
  s_cbranch_scc1 PE_1
E_1_3_3:
  v_mfma_f32_16x16x32_bf16 v[24:27], v[28:31], v[44:47], v[24:27]
  s_bitcmp1_b32 s54, 3
  s_cbranch_scc1 PE_1
E_1_3_4:
  s_setprio 2
  s_cmp_le_u32 s33, 6
  s_cbranch_scc1 T_1_4
  v_lshlrev_b32_sdwa v56, 3, v96 dst_sel:DWORD dst_unused:UNUSED_PAD src0_sel:DWORD src1_sel:WORD_0
  v_lshlrev_b32_sdwa v57, 3, v96 dst_sel:DWORD dst_unused:UNUSED_PAD src0_sel:DWORD src1_sel:WORD_1
  v_lshlrev_b32_sdwa v58, 3, v97 dst_sel:DWORD dst_unused:UNUSED_PAD src0_sel:DWORD src1_sel:WORD_0
  v_lshlrev_b32_sdwa v59, 3, v97 dst_sel:DWORD dst_unused:UNUSED_PAD src0_sel:DWORD src1_sel:WORD_1
  ds_read_b64 v[40:41], v56
  ds_read_b64 v[42:43], v57
  ds_read_b64 v[44:45], v58
  ds_read_b64 v[46:47], v59
  s_add_u32 m0, s56, 32768
  s_add_u32 s3, s56, 153600
  buffer_load_dwordx4 v10, s[8:11], s3 offen sc1 lds
  s_waitcnt lgkmcnt(4)
M_1_4:
  v_mfma_f32_16x16x32_bf16 v[24:27], v[28:31], v[32:35], v[24:27]
  s_bitcmp1_b32 s54, 4
  s_cbranch_scc1 PE_1
E_1_3_5:
  v_mfma_f32_16x16x32_bf16 v[24:27], v[28:31], v[36:39], v[24:27]
  s_bitcmp1_b32 s54, 5
  s_cbranch_scc1 PE_1
E_1_3_6:
  s_cmp_le_u32 s33, 8
  s_cbranch_scc1 T_1_6
  v_lshlrev_b32_sdwa v56, 3, v98 dst_sel:DWORD dst_unused:UNUSED_PAD src0_sel:DWORD src1_sel:WORD_0
  v_lshlrev_b32_sdwa v57, 3, v98 dst_sel:DWORD dst_unused:UNUSED_PAD src0_sel:DWORD src1_sel:WORD_1
  v_lshlrev_b32_sdwa v58, 3, v99 dst_sel:DWORD dst_unused:UNUSED_PAD src0_sel:DWORD src1_sel:WORD_0
  v_lshlrev_b32_sdwa v59, 3, v99 dst_sel:DWORD dst_unused:UNUSED_PAD src0_sel:DWORD src1_sel:WORD_1
  ds_read_b64 v[32:33], v56
  ds_read_b64 v[34:35], v57
  ds_read_b64 v[36:37], v58
  ds_read_b64 v[38:39], v59
  s_add_u32 m0, s56, 49152
  s_add_u32 s3, s56, 169984
  buffer_load_dwordx4 v10, s[8:11], s3 offen sc1 lds
  s_waitcnt lgkmcnt(4)
M_1_6:
  v_mfma_f32_16x16x32_bf16 v[24:27], v[28:31], v[40:43], v[24:27]
  s_bitcmp1_b32 s54, 6
  s_cbranch_scc1 PE_1
E_1_3_7:
  v_mfma_f32_16x16x32_bf16 v[24:27], v[28:31], v[44:47], v[24:27]
  s_bitcmp1_b32 s54, 7
  s_cbranch_scc1 PE_1
E_1_3_8:
  s_setprio 1
  s_cmp_le_u32 s33, 10
  s_cbranch_scc1 T_1_8
  v_lshlrev_b32_sdwa v56, 3, v100 dst_sel:DWORD dst_unused:UNUSED_PAD src0_sel:DWORD src1_sel:WORD_0
  v_lshlrev_b32_sdwa v57, 3, v100 dst_sel:DWORD dst_unused:UNUSED_PAD src0_sel:DWORD src1_sel:WORD_1
  v_lshlrev_b32_sdwa v58, 3, v101 dst_sel:DWORD dst_unused:UNUSED_PAD src0_sel:DWORD src1_sel:WORD_0
  v_lshlrev_b32_sdwa v59, 3, v101 dst_sel:DWORD dst_unused:UNUSED_PAD src0_sel:DWORD src1_sel:WORD_1
  ds_read_b64 v[40:41], v56
  ds_read_b64 v[42:43], v57
  ds_read_b64 v[44:45], v58
  ds_read_b64 v[46:47], v59
  s_waitcnt lgkmcnt(4)
M_1_8:
  v_mfma_f32_16x16x32_bf16 v[24:27], v[28:31], v[32:35], v[24:27]
  s_bitcmp1_b32 s54, 8
  s_cbranch_scc1 PE_1
E_1_3_9:
  v_mfma_f32_16x16x32_bf16 v[24:27], v[28:31], v[36:39], v[24:27]
  s_bitcmp1_b32 s54, 9
  s_cbranch_scc1 PE_1
E_1_3_10:
  s_cmp_le_u32 s33, 12
  s_cbranch_scc1 T_1_10
  v_lshlrev_b32_sdwa v56, 3, v102 dst_sel:DWORD dst_unused:UNUSED_PAD src0_sel:DWORD src1_sel:WORD_0
  v_lshlrev_b32_sdwa v57, 3, v102 dst_sel:DWORD dst_unused:UNUSED_PAD src0_sel:DWORD src1_sel:WORD_1
  v_lshlrev_b32_sdwa v58, 3, v103 dst_sel:DWORD dst_unused:UNUSED_PAD src0_sel:DWORD src1_sel:WORD_0
  v_lshlrev_b32_sdwa v59, 3, v103 dst_sel:DWORD dst_unused:UNUSED_PAD src0_sel:DWORD src1_sel:WORD_1
  ds_read_b64 v[32:33], v56
  ds_read_b64 v[34:35], v57
  ds_read_b64 v[36:37], v58
  ds_read_b64 v[38:39], v59
  s_waitcnt lgkmcnt(4)
M_1_10:
  v_mfma_f32_16x16x32_bf16 v[24:27], v[28:31], v[40:43], v[24:27]
  s_bitcmp1_b32 s54, 10
  s_cbranch_scc1 PE_1
E_1_3_11:
  v_mfma_f32_16x16x32_bf16 v[24:27], v[28:31], v[44:47], v[24:27]
  s_bitcmp1_b32 s54, 11
  s_cbranch_scc1 PE_1
E_1_3_12:
  s_setprio 0
  s_cmp_le_u32 s33, 14
  s_cbranch_scc1 T_1_12
  v_lshlrev_b32_sdwa v56, 3, v104 dst_sel:DWORD dst_unused:UNUSED_PAD src0_sel:DWORD src1_sel:WORD_0
  v_lshlrev_b32_sdwa v57, 3, v104 dst_sel:DWORD dst_unused:UNUSED_PAD src0_sel:DWORD src1_sel:WORD_1
  v_lshlrev_b32_sdwa v58, 3, v105 dst_sel:DWORD dst_unused:UNUSED_PAD src0_sel:DWORD src1_sel:WORD_0
  v_lshlrev_b32_sdwa v59, 3, v105 dst_sel:DWORD dst_unused:UNUSED_PAD src0_sel:DWORD src1_sel:WORD_1
  ds_read_b64 v[40:41], v56
  ds_read_b64 v[42:43], v57
  ds_read_b64 v[44:45], v58
  ds_read_b64 v[46:47], v59
  s_waitcnt lgkmcnt(4)
M_1_12:
  v_mfma_f32_16x16x32_bf16 v[24:27], v[28:31], v[32:35], v[24:27]
  s_bitcmp1_b32 s54, 12
  s_cbranch_scc1 PE_1
E_1_3_13:
  v_mfma_f32_16x16x32_bf16 v[24:27], v[28:31], v[36:39], v[24:27]
  s_bitcmp1_b32 s54, 13
  s_cbranch_scc1 PE_1
E_1_3_14:
  s_cmp_le_u32 s33, 16
  s_cbranch_scc1 T_1_14
  v_lshlrev_b32_sdwa v56, 3, v106 dst_sel:DWORD dst_unused:UNUSED_PAD src0_sel:DWORD src1_sel:WORD_0
  v_lshlrev_b32_sdwa v57, 3, v106 dst_sel:DWORD dst_unused:UNUSED_PAD src0_sel:DWORD src1_sel:WORD_1
  v_lshlrev_b32_sdwa v58, 3, v107 dst_sel:DWORD dst_unused:UNUSED_PAD src0_sel:DWORD src1_sel:WORD_0
  v_lshlrev_b32_sdwa v59, 3, v107 dst_sel:DWORD dst_unused:UNUSED_PAD src0_sel:DWORD src1_sel:WORD_1
  ds_read_b64 v[32:33], v56
  ds_read_b64 v[34:35], v57
  ds_read_b64 v[36:37], v58
  ds_read_b64 v[38:39], v59
  s_waitcnt lgkmcnt(4)
M_1_14:
  v_mfma_f32_16x16x32_bf16 v[24:27], v[28:31], v[40:43], v[24:27]
  s_bitcmp1_b32 s54, 14
  s_cbranch_scc1 PE_1
E_1_3_15:
  v_mfma_f32_16x16x32_bf16 v[24:27], v[28:31], v[44:47], v[24:27]
  s_bitcmp1_b32 s54, 15
  s_cbranch_scc1 PE_1
E_1_3_16:
  s_waitcnt lgkmcnt(0)
  v_mfma_f32_16x16x32_bf16 v[24:27], v[28:31], v[32:35], v[24:27]
  s_bitcmp1_b32 s54, 16
  s_cbranch_scc1 PE_1
E_1_3_17:
  v_mfma_f32_16x16x32_bf16 v[24:27], v[28:31], v[36:39], v[24:27]
  s_branch PE_1
T_1_0:
  s_add_u32 m0, s56, 0
  s_add_u32 s3, s56, 120832
  buffer_load_dwordx4 v10, s[8:11], s3 offen sc1 lds
  s_waitcnt lgkmcnt(0)
  s_branch M_1_0
T_1_2:
  s_add_u32 m0, s56, 16384
  s_add_u32 s3, s56, 137216
  buffer_load_dwordx4 v10, s[8:11], s3 offen sc1 lds
  s_waitcnt lgkmcnt(0)
  s_branch M_1_2
T_1_4:
  s_add_u32 m0, s56, 32768
  s_add_u32 s3, s56, 153600
  buffer_load_dwordx4 v10, s[8:11], s3 offen sc1 lds
  s_waitcnt lgkmcnt(0)
  s_branch M_1_4
T_1_6:
  s_add_u32 m0, s56, 49152
  s_add_u32 s3, s56, 169984
  buffer_load_dwordx4 v10, s[8:11], s3 offen sc1 lds
  s_waitcnt lgkmcnt(0)
  s_branch M_1_6
T_1_8:
  s_waitcnt lgkmcnt(0)
  s_branch M_1_8
T_1_10:
  s_waitcnt lgkmcnt(0)
  s_branch M_1_10
T_1_12:
  s_waitcnt lgkmcnt(0)
  s_branch M_1_12
T_1_14:
  s_waitcnt lgkmcnt(0)
  s_branch M_1_14
E_2_1_0:
  v_lshlrev_b32_sdwa v56, 3, v110 dst_sel:DWORD dst_unused:UNUSED_PAD src0_sel:DWORD src1_sel:WORD_0
  v_lshlrev_b32_sdwa v57, 3, v110 dst_sel:DWORD dst_unused:UNUSED_PAD src0_sel:DWORD src1_sel:WORD_1
  v_lshlrev_b32_sdwa v58, 3, v111 dst_sel:DWORD dst_unused:UNUSED_PAD src0_sel:DWORD src1_sel:WORD_0
  v_lshlrev_b32_sdwa v59, 3, v111 dst_sel:DWORD dst_unused:UNUSED_PAD src0_sel:DWORD src1_sel:WORD_1
  ds_read_b64 v[40:41], v56
  ds_read_b64 v[42:43], v57
  ds_read_b64 v[44:45], v58
  ds_read_b64 v[46:47], v59
  s_waitcnt lgkmcnt(4)
  v_mfma_f32_16x16x32_bf16 v[16:19], v[28:31], v[32:35], v[16:19]
  s_bitcmp1_b32 s54, 0
  s_cbranch_scc1 E_2_2_1
E_2_1_1:
  v_mfma_f32_16x16x32_bf16 v[16:19], v[28:31], v[36:39], v[16:19]
  s_bitcmp1_b32 s54, 1
  s_cbranch_scc1 E_2_2_2
E_2_1_2:
  v_lshlrev_b32_sdwa v56, 3, v112 dst_sel:DWORD dst_unused:UNUSED_PAD src0_sel:DWORD src1_sel:WORD_0
  v_lshlrev_b32_sdwa v57, 3, v112 dst_sel:DWORD dst_unused:UNUSED_PAD src0_sel:DWORD src1_sel:WORD_1
  v_lshlrev_b32_sdwa v58, 3, v113 dst_sel:DWORD dst_unused:UNUSED_PAD src0_sel:DWORD src1_sel:WORD_0
  v_lshlrev_b32_sdwa v59, 3, v113 dst_sel:DWORD dst_unused:UNUSED_PAD src0_sel:DWORD src1_sel:WORD_1
  ds_read_b64 v[32:33], v56
  ds_read_b64 v[34:35], v57
  ds_read_b64 v[36:37], v58
  ds_read_b64 v[38:39], v59
  s_waitcnt lgkmcnt(4)
  v_mfma_f32_16x16x32_bf16 v[16:19], v[28:31], v[40:43], v[16:19]
  s_bitcmp1_b32 s54, 2
  s_cbranch_scc1 E_2_2_3
E_2_1_3:
  v_mfma_f32_16x16x32_bf16 v[16:19], v[28:31], v[44:47], v[16:19]
  s_bitcmp1_b32 s54, 3
  s_cbranch_scc1 E_2_2_4
E_2_1_4:
  s_setprio 2
  v_lshlrev_b32_sdwa v56, 3, v114 dst_sel:DWORD dst_unused:UNUSED_PAD src0_sel:DWORD src1_sel:WORD_0
  v_lshlrev_b32_sdwa v57, 3, v114 dst_sel:DWORD dst_unused:UNUSED_PAD src0_sel:DWORD src1_sel:WORD_1
  v_lshlrev_b32_sdwa v58, 3, v115 dst_sel:DWORD dst_unused:UNUSED_PAD src0_sel:DWORD src1_sel:WORD_0
  v_lshlrev_b32_sdwa v59, 3, v115 dst_sel:DWORD dst_unused:UNUSED_PAD src0_sel:DWORD src1_sel:WORD_1
  ds_read_b64 v[40:41], v56
  ds_read_b64 v[42:43], v57
  ds_read_b64 v[44:45], v58
  ds_read_b64 v[46:47], v59
  s_waitcnt lgkmcnt(4)
  v_mfma_f32_16x16x32_bf16 v[16:19], v[28:31], v[32:35], v[16:19]
  s_bitcmp1_b32 s54, 4
  s_cbranch_scc1 E_2_2_5
E_2_1_5:
  v_mfma_f32_16x16x32_bf16 v[16:19], v[28:31], v[36:39], v[16:19]
  s_bitcmp1_b32 s54, 5
  s_cbranch_scc1 E_2_2_6
E_2_1_6:
  v_lshlrev_b32_sdwa v56, 3, v116 dst_sel:DWORD dst_unused:UNUSED_PAD src0_sel:DWORD src1_sel:WORD_0
  v_lshlrev_b32_sdwa v57, 3, v116 dst_sel:DWORD dst_unused:UNUSED_PAD src0_sel:DWORD src1_sel:WORD_1
  v_lshlrev_b32_sdwa v58, 3, v117 dst_sel:DWORD dst_unused:UNUSED_PAD src0_sel:DWORD src1_sel:WORD_0
  v_lshlrev_b32_sdwa v59, 3, v117 dst_sel:DWORD dst_unused:UNUSED_PAD src0_sel:DWORD src1_sel:WORD_1
  ds_read_b64 v[32:33], v56
  ds_read_b64 v[34:35], v57
  ds_read_b64 v[36:37], v58
  ds_read_b64 v[38:39], v59
  s_waitcnt lgkmcnt(4)
  v_mfma_f32_16x16x32_bf16 v[16:19], v[28:31], v[40:43], v[16:19]
  s_bitcmp1_b32 s54, 6
  s_cbranch_scc1 E_2_2_7
E_2_1_7:
  v_mfma_f32_16x16x32_bf16 v[16:19], v[28:31], v[44:47], v[16:19]
  s_bitcmp1_b32 s54, 7
  s_cbranch_scc1 E_2_2_8
E_2_1_8:
  s_setprio 1
  v_lshlrev_b32_sdwa v56, 3, v118 dst_sel:DWORD dst_unused:UNUSED_PAD src0_sel:DWORD src1_sel:WORD_0
  v_lshlrev_b32_sdwa v57, 3, v118 dst_sel:DWORD dst_unused:UNUSED_PAD src0_sel:DWORD src1_sel:WORD_1
  v_lshlrev_b32_sdwa v58, 3, v119 dst_sel:DWORD dst_unused:UNUSED_PAD src0_sel:DWORD src1_sel:WORD_0
  v_lshlrev_b32_sdwa v59, 3, v119 dst_sel:DWORD dst_unused:UNUSED_PAD src0_sel:DWORD src1_sel:WORD_1
  ds_read_b64 v[40:41], v56
  ds_read_b64 v[42:43], v57
  ds_read_b64 v[44:45], v58
  ds_read_b64 v[46:47], v59
  s_waitcnt lgkmcnt(4)
  v_mfma_f32_16x16x32_bf16 v[16:19], v[28:31], v[32:35], v[16:19]
  s_bitcmp1_b32 s54, 8
  s_cbranch_scc1 E_2_2_9
E_2_1_9:
  v_mfma_f32_16x16x32_bf16 v[16:19], v[28:31], v[36:39], v[16:19]
  s_bitcmp1_b32 s54, 9
  s_cbranch_scc1 E_2_2_10
E_2_1_10:
  v_lshlrev_b32_sdwa v56, 3, v120 dst_sel:DWORD dst_unused:UNUSED_PAD src0_sel:DWORD src1_sel:WORD_0
  v_lshlrev_b32_sdwa v57, 3, v120 dst_sel:DWORD dst_unused:UNUSED_PAD src0_sel:DWORD src1_sel:WORD_1
  v_lshlrev_b32_sdwa v58, 3, v121 dst_sel:DWORD dst_unused:UNUSED_PAD src0_sel:DWORD src1_sel:WORD_0
  v_lshlrev_b32_sdwa v59, 3, v121 dst_sel:DWORD dst_unused:UNUSED_PAD src0_sel:DWORD src1_sel:WORD_1
  ds_read_b64 v[32:33], v56
  ds_read_b64 v[34:35], v57
  ds_read_b64 v[36:37], v58
  ds_read_b64 v[38:39], v59
  s_waitcnt lgkmcnt(4)
  v_mfma_f32_16x16x32_bf16 v[16:19], v[28:31], v[40:43], v[16:19]
  s_bitcmp1_b32 s54, 10
  s_cbranch_scc1 E_2_2_11
E_2_1_11:
  v_mfma_f32_16x16x32_bf16 v[16:19], v[28:31], v[44:47], v[16:19]
  s_bitcmp1_b32 s54, 11
  s_cbranch_scc1 E_2_2_12
E_2_1_12:
  s_setprio 0
  v_lshlrev_b32_sdwa v56, 3, v122 dst_sel:DWORD dst_unused:UNUSED_PAD src0_sel:DWORD src1_sel:WORD_0
  v_lshlrev_b32_sdwa v57, 3, v122 dst_sel:DWORD dst_unused:UNUSED_PAD src0_sel:DWORD src1_sel:WORD_1
  v_lshlrev_b32_sdwa v58, 3, v123 dst_sel:DWORD dst_unused:UNUSED_PAD src0_sel:DWORD src1_sel:WORD_0
  v_lshlrev_b32_sdwa v59, 3, v123 dst_sel:DWORD dst_unused:UNUSED_PAD src0_sel:DWORD src1_sel:WORD_1
  ds_read_b64 v[40:41], v56
  ds_read_b64 v[42:43], v57
  ds_read_b64 v[44:45], v58
  ds_read_b64 v[46:47], v59
  s_waitcnt lgkmcnt(4)
  v_mfma_f32_16x16x32_bf16 v[16:19], v[28:31], v[32:35], v[16:19]
  s_bitcmp1_b32 s54, 12
  s_cbranch_scc1 E_2_2_13
E_2_1_13:
  v_mfma_f32_16x16x32_bf16 v[16:19], v[28:31], v[36:39], v[16:19]
  s_bitcmp1_b32 s54, 13
  s_cbranch_scc1 E_2_2_14
E_2_1_14:
  v_lshlrev_b32_sdwa v56, 3, v124 dst_sel:DWORD dst_unused:UNUSED_PAD src0_sel:DWORD src1_sel:WORD_0
  v_lshlrev_b32_sdwa v57, 3, v124 dst_sel:DWORD dst_unused:UNUSED_PAD src0_sel:DWORD src1_sel:WORD_1
  v_lshlrev_b32_sdwa v58, 3, v125 dst_sel:DWORD dst_unused:UNUSED_PAD src0_sel:DWORD src1_sel:WORD_0
  v_lshlrev_b32_sdwa v59, 3, v125 dst_sel:DWORD dst_unused:UNUSED_PAD src0_sel:DWORD src1_sel:WORD_1
  ds_read_b64 v[32:33], v56
  ds_read_b64 v[34:35], v57
  ds_read_b64 v[36:37], v58
  ds_read_b64 v[38:39], v59
  s_waitcnt lgkmcnt(4)
  v_mfma_f32_16x16x32_bf16 v[16:19], v[28:31], v[40:43], v[16:19]
  s_bitcmp1_b32 s54, 14
  s_cbranch_scc1 E_2_2_15
E_2_1_15:
  v_mfma_f32_16x16x32_bf16 v[16:19], v[28:31], v[44:47], v[16:19]
  s_bitcmp1_b32 s54, 15
  s_cbranch_scc1 E_2_2_16
E_2_1_16:
  v_lshlrev_b32_sdwa v56, 3, v126 dst_sel:DWORD dst_unused:UNUSED_PAD src0_sel:DWORD src1_sel:WORD_0
  v_lshlrev_b32_sdwa v57, 3, v126 dst_sel:DWORD dst_unused:UNUSED_PAD src0_sel:DWORD src1_sel:WORD_1
  v_lshlrev_b32_sdwa v58, 3, v127 dst_sel:DWORD dst_unused:UNUSED_PAD src0_sel:DWORD src1_sel:WORD_0
  v_lshlrev_b32_sdwa v59, 3, v127 dst_sel:DWORD dst_unused:UNUSED_PAD src0_sel:DWORD src1_sel:WORD_1
  ds_read_b64 v[40:41], v56
  ds_read_b64 v[42:43], v57
  ds_read_b64 v[44:45], v58
  ds_read_b64 v[46:47], v59
  s_waitcnt lgkmcnt(4)
  v_mfma_f32_16x16x32_bf16 v[16:19], v[28:31], v[32:35], v[16:19]
  s_bitcmp1_b32 s54, 16
  s_cbranch_scc1 E_2_2_17
E_2_1_17:
  v_mfma_f32_16x16x32_bf16 v[16:19], v[28:31], v[36:39], v[16:19]
  s_bitcmp1_b32 s54, 17
  s_cbranch_scc1 E_2_2_18
E_2_1_18:
  s_waitcnt lgkmcnt(0)
  v_mfma_f32_16x16x32_bf16 v[16:19], v[28:31], v[40:43], v[16:19]
  s_bitcmp1_b32 s54, 18
  s_cbranch_scc1 E_2_2_19
E_2_1_19:
  v_mfma_f32_16x16x32_bf16 v[16:19], v[28:31], v[44:47], v[16:19]
  s_branch PE_2
E_2_2_0:
  v_lshlrev_b32_sdwa v56, 3, v110 dst_sel:DWORD dst_unused:UNUSED_PAD src0_sel:DWORD src1_sel:WORD_0
  v_lshlrev_b32_sdwa v57, 3, v110 dst_sel:DWORD dst_unused:UNUSED_PAD src0_sel:DWORD src1_sel:WORD_1
  v_lshlrev_b32_sdwa v58, 3, v111 dst_sel:DWORD dst_unused:UNUSED_PAD src0_sel:DWORD src1_sel:WORD_0
  v_lshlrev_b32_sdwa v59, 3, v111 dst_sel:DWORD dst_unused:UNUSED_PAD src0_sel:DWORD src1_sel:WORD_1
  ds_read_b64 v[40:41], v56
  ds_read_b64 v[42:43], v57
  ds_read_b64 v[44:45], v58
  ds_read_b64 v[46:47], v59
  s_waitcnt lgkmcnt(4)
  v_mfma_f32_16x16x32_bf16 v[20:23], v[28:31], v[32:35], v[20:23]
  s_bitcmp1_b32 s54, 0
  s_cbranch_scc1 E_2_3_1
E_2_2_1:
  v_mfma_f32_16x16x32_bf16 v[20:23], v[28:31], v[36:39], v[20:23]
  s_bitcmp1_b32 s54, 1
  s_cbranch_scc1 E_2_3_2
E_2_2_2:
  v_lshlrev_b32_sdwa v56, 3, v112 dst_sel:DWORD dst_unused:UNUSED_PAD src0_sel:DWORD src1_sel:WORD_0
  v_lshlrev_b32_sdwa v57, 3, v112 dst_sel:DWORD dst_unused:UNUSED_PAD src0_sel:DWORD src1_sel:WORD_1
  v_lshlrev_b32_sdwa v58, 3, v113 dst_sel:DWORD dst_unused:UNUSED_PAD src0_sel:DWORD src1_sel:WORD_0
  v_lshlrev_b32_sdwa v59, 3, v113 dst_sel:DWORD dst_unused:UNUSED_PAD src0_sel:DWORD src1_sel:WORD_1
  ds_read_b64 v[32:33], v56
  ds_read_b64 v[34:35], v57
  ds_read_b64 v[36:37], v58
  ds_read_b64 v[38:39], v59
  s_waitcnt lgkmcnt(4)
  v_mfma_f32_16x16x32_bf16 v[20:23], v[28:31], v[40:43], v[20:23]
  s_bitcmp1_b32 s54, 2
  s_cbranch_scc1 E_2_3_3
E_2_2_3:
  v_mfma_f32_16x16x32_bf16 v[20:23], v[28:31], v[44:47], v[20:23]
  s_bitcmp1_b32 s54, 3
  s_cbranch_scc1 E_2_3_4
E_2_2_4:
  s_setprio 2
  v_lshlrev_b32_sdwa v56, 3, v114 dst_sel:DWORD dst_unused:UNUSED_PAD src0_sel:DWORD src1_sel:WORD_0
  v_lshlrev_b32_sdwa v57, 3, v114 dst_sel:DWORD dst_unused:UNUSED_PAD src0_sel:DWORD src1_sel:WORD_1
  v_lshlrev_b32_sdwa v58, 3, v115 dst_sel:DWORD dst_unused:UNUSED_PAD src0_sel:DWORD src1_sel:WORD_0
  v_lshlrev_b32_sdwa v59, 3, v115 dst_sel:DWORD dst_unused:UNUSED_PAD src0_sel:DWORD src1_sel:WORD_1
  ds_read_b64 v[40:41], v56
  ds_read_b64 v[42:43], v57
  ds_read_b64 v[44:45], v58
  ds_read_b64 v[46:47], v59
  s_waitcnt lgkmcnt(4)
  v_mfma_f32_16x16x32_bf16 v[20:23], v[28:31], v[32:35], v[20:23]
  s_bitcmp1_b32 s54, 4
  s_cbranch_scc1 E_2_3_5
E_2_2_5:
  v_mfma_f32_16x16x32_bf16 v[20:23], v[28:31], v[36:39], v[20:23]
  s_bitcmp1_b32 s54, 5
  s_cbranch_scc1 E_2_3_6
E_2_2_6:
  v_lshlrev_b32_sdwa v56, 3, v116 dst_sel:DWORD dst_unused:UNUSED_PAD src0_sel:DWORD src1_sel:WORD_0
  v_lshlrev_b32_sdwa v57, 3, v116 dst_sel:DWORD dst_unused:UNUSED_PAD src0_sel:DWORD src1_sel:WORD_1
  v_lshlrev_b32_sdwa v58, 3, v117 dst_sel:DWORD dst_unused:UNUSED_PAD src0_sel:DWORD src1_sel:WORD_0
  v_lshlrev_b32_sdwa v59, 3, v117 dst_sel:DWORD dst_unused:UNUSED_PAD src0_sel:DWORD src1_sel:WORD_1
  ds_read_b64 v[32:33], v56
  ds_read_b64 v[34:35], v57
  ds_read_b64 v[36:37], v58
  ds_read_b64 v[38:39], v59
  s_waitcnt lgkmcnt(4)
  v_mfma_f32_16x16x32_bf16 v[20:23], v[28:31], v[40:43], v[20:23]
  s_bitcmp1_b32 s54, 6
  s_cbranch_scc1 E_2_3_7
E_2_2_7:
  v_mfma_f32_16x16x32_bf16 v[20:23], v[28:31], v[44:47], v[20:23]
  s_bitcmp1_b32 s54, 7
  s_cbranch_scc1 E_2_3_8
E_2_2_8:
  s_setprio 1
  v_lshlrev_b32_sdwa v56, 3, v118 dst_sel:DWORD dst_unused:UNUSED_PAD src0_sel:DWORD src1_sel:WORD_0
  v_lshlrev_b32_sdwa v57, 3, v118 dst_sel:DWORD dst_unused:UNUSED_PAD src0_sel:DWORD src1_sel:WORD_1
  v_lshlrev_b32_sdwa v58, 3, v119 dst_sel:DWORD dst_unused:UNUSED_PAD src0_sel:DWORD src1_sel:WORD_0
  v_lshlrev_b32_sdwa v59, 3, v119 dst_sel:DWORD dst_unused:UNUSED_PAD src0_sel:DWORD src1_sel:WORD_1
  ds_read_b64 v[40:41], v56
  ds_read_b64 v[42:43], v57
  ds_read_b64 v[44:45], v58
  ds_read_b64 v[46:47], v59
  s_waitcnt lgkmcnt(4)
  v_mfma_f32_16x16x32_bf16 v[20:23], v[28:31], v[32:35], v[20:23]
  s_bitcmp1_b32 s54, 8
  s_cbranch_scc1 E_2_3_9
E_2_2_9:
  v_mfma_f32_16x16x32_bf16 v[20:23], v[28:31], v[36:39], v[20:23]
  s_bitcmp1_b32 s54, 9
  s_cbranch_scc1 E_2_3_10
E_2_2_10:
  v_lshlrev_b32_sdwa v56, 3, v120 dst_sel:DWORD dst_unused:UNUSED_PAD src0_sel:DWORD src1_sel:WORD_0
  v_lshlrev_b32_sdwa v57, 3, v120 dst_sel:DWORD dst_unused:UNUSED_PAD src0_sel:DWORD src1_sel:WORD_1
  v_lshlrev_b32_sdwa v58, 3, v121 dst_sel:DWORD dst_unused:UNUSED_PAD src0_sel:DWORD src1_sel:WORD_0
  v_lshlrev_b32_sdwa v59, 3, v121 dst_sel:DWORD dst_unused:UNUSED_PAD src0_sel:DWORD src1_sel:WORD_1
  ds_read_b64 v[32:33], v56
  ds_read_b64 v[34:35], v57
  ds_read_b64 v[36:37], v58
  ds_read_b64 v[38:39], v59
  s_waitcnt lgkmcnt(4)
  v_mfma_f32_16x16x32_bf16 v[20:23], v[28:31], v[40:43], v[20:23]
  s_bitcmp1_b32 s54, 10
  s_cbranch_scc1 E_2_3_11
E_2_2_11:
  v_mfma_f32_16x16x32_bf16 v[20:23], v[28:31], v[44:47], v[20:23]
  s_bitcmp1_b32 s54, 11
  s_cbranch_scc1 E_2_3_12
E_2_2_12:
  s_setprio 0
  v_lshlrev_b32_sdwa v56, 3, v122 dst_sel:DWORD dst_unused:UNUSED_PAD src0_sel:DWORD src1_sel:WORD_0
  v_lshlrev_b32_sdwa v57, 3, v122 dst_sel:DWORD dst_unused:UNUSED_PAD src0_sel:DWORD src1_sel:WORD_1
  v_lshlrev_b32_sdwa v58, 3, v123 dst_sel:DWORD dst_unused:UNUSED_PAD src0_sel:DWORD src1_sel:WORD_0
  v_lshlrev_b32_sdwa v59, 3, v123 dst_sel:DWORD dst_unused:UNUSED_PAD src0_sel:DWORD src1_sel:WORD_1
  ds_read_b64 v[40:41], v56
  ds_read_b64 v[42:43], v57
  ds_read_b64 v[44:45], v58
  ds_read_b64 v[46:47], v59
  s_waitcnt lgkmcnt(4)
  v_mfma_f32_16x16x32_bf16 v[20:23], v[28:31], v[32:35], v[20:23]
  s_bitcmp1_b32 s54, 12
  s_cbranch_scc1 E_2_3_13
E_2_2_13:
  v_mfma_f32_16x16x32_bf16 v[20:23], v[28:31], v[36:39], v[20:23]
  s_bitcmp1_b32 s54, 13
  s_cbranch_scc1 E_2_3_14
E_2_2_14:
  v_lshlrev_b32_sdwa v56, 3, v124 dst_sel:DWORD dst_unused:UNUSED_PAD src0_sel:DWORD src1_sel:WORD_0
  v_lshlrev_b32_sdwa v57, 3, v124 dst_sel:DWORD dst_unused:UNUSED_PAD src0_sel:DWORD src1_sel:WORD_1
  v_lshlrev_b32_sdwa v58, 3, v125 dst_sel:DWORD dst_unused:UNUSED_PAD src0_sel:DWORD src1_sel:WORD_0
  v_lshlrev_b32_sdwa v59, 3, v125 dst_sel:DWORD dst_unused:UNUSED_PAD src0_sel:DWORD src1_sel:WORD_1
  ds_read_b64 v[32:33], v56
  ds_read_b64 v[34:35], v57
  ds_read_b64 v[36:37], v58
  ds_read_b64 v[38:39], v59
  s_waitcnt lgkmcnt(4)
  v_mfma_f32_16x16x32_bf16 v[20:23], v[28:31], v[40:43], v[20:23]
  s_bitcmp1_b32 s54, 14
  s_cbranch_scc1 E_2_3_15
E_2_2_15:
  v_mfma_f32_16x16x32_bf16 v[20:23], v[28:31], v[44:47], v[20:23]
  s_bitcmp1_b32 s54, 15
  s_cbranch_scc1 E_2_3_16
E_2_2_16:
  v_lshlrev_b32_sdwa v56, 3, v126 dst_sel:DWORD dst_unused:UNUSED_PAD src0_sel:DWORD src1_sel:WORD_0
  v_lshlrev_b32_sdwa v57, 3, v126 dst_sel:DWORD dst_unused:UNUSED_PAD src0_sel:DWORD src1_sel:WORD_1
  v_lshlrev_b32_sdwa v58, 3, v127 dst_sel:DWORD dst_unused:UNUSED_PAD src0_sel:DWORD src1_sel:WORD_0
  v_lshlrev_b32_sdwa v59, 3, v127 dst_sel:DWORD dst_unused:UNUSED_PAD src0_sel:DWORD src1_sel:WORD_1
  ds_read_b64 v[40:41], v56
  ds_read_b64 v[42:43], v57
  ds_read_b64 v[44:45], v58
  ds_read_b64 v[46:47], v59
  s_waitcnt lgkmcnt(4)
  v_mfma_f32_16x16x32_bf16 v[20:23], v[28:31], v[32:35], v[20:23]
  s_bitcmp1_b32 s54, 16
  s_cbranch_scc1 E_2_3_17
E_2_2_17:
  v_mfma_f32_16x16x32_bf16 v[20:23], v[28:31], v[36:39], v[20:23]
  s_bitcmp1_b32 s54, 17
  s_cbranch_scc1 E_2_3_18
E_2_2_18:
  s_waitcnt lgkmcnt(0)
  v_mfma_f32_16x16x32_bf16 v[20:23], v[28:31], v[40:43], v[20:23]
  s_bitcmp1_b32 s54, 18
  s_cbranch_scc1 E_2_3_19
E_2_2_19:
  v_mfma_f32_16x16x32_bf16 v[20:23], v[28:31], v[44:47], v[20:23]
  s_branch PE_2
E_2_3_0:
  s_cmp_le_u32 s34, 2
  s_cbranch_scc1 T_2_0
  v_lshlrev_b32_sdwa v56, 3, v110 dst_sel:DWORD dst_unused:UNUSED_PAD src0_sel:DWORD src1_sel:WORD_0
  v_lshlrev_b32_sdwa v57, 3, v110 dst_sel:DWORD dst_unused:UNUSED_PAD src0_sel:DWORD src1_sel:WORD_1
  v_lshlrev_b32_sdwa v58, 3, v111 dst_sel:DWORD dst_unused:UNUSED_PAD src0_sel:DWORD src1_sel:WORD_0
  v_lshlrev_b32_sdwa v59, 3, v111 dst_sel:DWORD dst_unused:UNUSED_PAD src0_sel:DWORD src1_sel:WORD_1
  ds_read_b64 v[40:41], v56
  ds_read_b64 v[42:43], v57
  ds_read_b64 v[44:45], v58
  ds_read_b64 v[46:47], v59
  s_waitcnt lgkmcnt(4)
M_2_0:
  v_mfma_f32_16x16x32_bf16 v[24:27], v[28:31], v[32:35], v[24:27]
  s_bitcmp1_b32 s54, 0
  s_cbranch_scc1 PE_2
E_2_3_1:
  v_mfma_f32_16x16x32_bf16 v[24:27], v[28:31], v[36:39], v[24:27]
  s_bitcmp1_b32 s54, 1
  s_cbranch_scc1 PE_2
E_2_3_2:
  s_cmp_le_u32 s34, 4
  s_cbranch_scc1 T_2_2
  v_lshlrev_b32_sdwa v56, 3, v112 dst_sel:DWORD dst_unused:UNUSED_PAD src0_sel:DWORD src1_sel:WORD_0
  v_lshlrev_b32_sdwa v57, 3, v112 dst_sel:DWORD dst_unused:UNUSED_PAD src0_sel:DWORD src1_sel:WORD_1
  v_lshlrev_b32_sdwa v58, 3, v113 dst_sel:DWORD dst_unused:UNUSED_PAD src0_sel:DWORD src1_sel:WORD_0
  v_lshlrev_b32_sdwa v59, 3, v113 dst_sel:DWORD dst_unused:UNUSED_PAD src0_sel:DWORD src1_sel:WORD_1
  ds_read_b64 v[32:33], v56
  ds_read_b64 v[34:35], v57
  ds_read_b64 v[36:37], v58
  ds_read_b64 v[38:39], v59
  s_waitcnt lgkmcnt(4)
M_2_2:
  v_mfma_f32_16x16x32_bf16 v[24:27], v[28:31], v[40:43], v[24:27]
  s_bitcmp1_b32 s54, 2
  s_cbranch_scc1 PE_2
E_2_3_3:
  v_mfma_f32_16x16x32_bf16 v[24:27], v[28:31], v[44:47], v[24:27]
  s_bitcmp1_b32 s54, 3
  s_cbranch_scc1 PE_2
E_2_3_4:
  s_setprio 2
  s_cmp_le_u32 s34, 6
  s_cbranch_scc1 T_2_4
  v_lshlrev_b32_sdwa v56, 3, v114 dst_sel:DWORD dst_unused:UNUSED_PAD src0_sel:DWORD src1_sel:WORD_0
  v_lshlrev_b32_sdwa v57, 3, v114 dst_sel:DWORD dst_unused:UNUSED_PAD src0_sel:DWORD src1_sel:WORD_1
  v_lshlrev_b32_sdwa v58, 3, v115 dst_sel:DWORD dst_unused:UNUSED_PAD src0_sel:DWORD src1_sel:WORD_0
  v_lshlrev_b32_sdwa v59, 3, v115 dst_sel:DWORD dst_unused:UNUSED_PAD src0_sel:DWORD src1_sel:WORD_1
  ds_read_b64 v[40:41], v56
  ds_read_b64 v[42:43], v57
  ds_read_b64 v[44:45], v58
  ds_read_b64 v[46:47], v59
  s_waitcnt lgkmcnt(4)
M_2_4:
  v_mfma_f32_16x16x32_bf16 v[24:27], v[28:31], v[32:35], v[24:27]
  s_bitcmp1_b32 s54, 4
  s_cbranch_scc1 PE_2
E_2_3_5:
  v_mfma_f32_16x16x32_bf16 v[24:27], v[28:31], v[36:39], v[24:27]
  s_bitcmp1_b32 s54, 5
  s_cbranch_scc1 PE_2
E_2_3_6:
  s_cmp_le_u32 s34, 8
  s_cbranch_scc1 T_2_6
  v_lshlrev_b32_sdwa v56, 3, v116 dst_sel:DWORD dst_unused:UNUSED_PAD src0_sel:DWORD src1_sel:WORD_0
  v_lshlrev_b32_sdwa v57, 3, v116 dst_sel:DWORD dst_unused:UNUSED_PAD src0_sel:DWORD src1_sel:WORD_1
  v_lshlrev_b32_sdwa v58, 3, v117 dst_sel:DWORD dst_unused:UNUSED_PAD src0_sel:DWORD src1_sel:WORD_0
  v_lshlrev_b32_sdwa v59, 3, v117 dst_sel:DWORD dst_unused:UNUSED_PAD src0_sel:DWORD src1_sel:WORD_1
  ds_read_b64 v[32:33], v56
  ds_read_b64 v[34:35], v57
  ds_read_b64 v[36:37], v58
  ds_read_b64 v[38:39], v59
  s_waitcnt lgkmcnt(4)
M_2_6:
  v_mfma_f32_16x16x32_bf16 v[24:27], v[28:31], v[40:43], v[24:27]
  s_bitcmp1_b32 s54, 6
  s_cbranch_scc1 PE_2
E_2_3_7:
  v_mfma_f32_16x16x32_bf16 v[24:27], v[28:31], v[44:47], v[24:27]
  s_bitcmp1_b32 s54, 7
  s_cbranch_scc1 PE_2
E_2_3_8:
  s_setprio 1
  s_cmp_le_u32 s34, 10
  s_cbranch_scc1 T_2_8
  v_lshlrev_b32_sdwa v56, 3, v118 dst_sel:DWORD dst_unused:UNUSED_PAD src0_sel:DWORD src1_sel:WORD_0
  v_lshlrev_b32_sdwa v57, 3, v118 dst_sel:DWORD dst_unused:UNUSED_PAD src0_sel:DWORD src1_sel:WORD_1
  v_lshlrev_b32_sdwa v58, 3, v119 dst_sel:DWORD dst_unused:UNUSED_PAD src0_sel:DWORD src1_sel:WORD_0
  v_lshlrev_b32_sdwa v59, 3, v119 dst_sel:DWORD dst_unused:UNUSED_PAD src0_sel:DWORD src1_sel:WORD_1
  ds_read_b64 v[40:41], v56
  ds_read_b64 v[42:43], v57
  ds_read_b64 v[44:45], v58
  ds_read_b64 v[46:47], v59
  s_waitcnt lgkmcnt(4)
M_2_8:
  v_mfma_f32_16x16x32_bf16 v[24:27], v[28:31], v[32:35], v[24:27]
  s_bitcmp1_b32 s54, 8
  s_cbranch_scc1 PE_2
E_2_3_9:
  v_mfma_f32_16x16x32_bf16 v[24:27], v[28:31], v[36:39], v[24:27]
  s_bitcmp1_b32 s54, 9
  s_cbranch_scc1 PE_2
E_2_3_10:
  s_cmp_le_u32 s34, 12
  s_cbranch_scc1 T_2_10
  v_lshlrev_b32_sdwa v56, 3, v120 dst_sel:DWORD dst_unused:UNUSED_PAD src0_sel:DWORD src1_sel:WORD_0
  v_lshlrev_b32_sdwa v57, 3, v120 dst_sel:DWORD dst_unused:UNUSED_PAD src0_sel:DWORD src1_sel:WORD_1
  v_lshlrev_b32_sdwa v58, 3, v121 dst_sel:DWORD dst_unused:UNUSED_PAD src0_sel:DWORD src1_sel:WORD_0
  v_lshlrev_b32_sdwa v59, 3, v121 dst_sel:DWORD dst_unused:UNUSED_PAD src0_sel:DWORD src1_sel:WORD_1
  ds_read_b64 v[32:33], v56
  ds_read_b64 v[34:35], v57
  ds_read_b64 v[36:37], v58
  ds_read_b64 v[38:39], v59
  s_waitcnt lgkmcnt(4)
M_2_10:
  v_mfma_f32_16x16x32_bf16 v[24:27], v[28:31], v[40:43], v[24:27]
  s_bitcmp1_b32 s54, 10
  s_cbranch_scc1 PE_2
E_2_3_11:
  v_mfma_f32_16x16x32_bf16 v[24:27], v[28:31], v[44:47], v[24:27]
  s_bitcmp1_b32 s54, 11
  s_cbranch_scc1 PE_2
E_2_3_12:
  s_setprio 0
  s_cmp_le_u32 s34, 14
  s_cbranch_scc1 T_2_12
  v_lshlrev_b32_sdwa v56, 3, v122 dst_sel:DWORD dst_unused:UNUSED_PAD src0_sel:DWORD src1_sel:WORD_0
  v_lshlrev_b32_sdwa v57, 3, v122 dst_sel:DWORD dst_unused:UNUSED_PAD src0_sel:DWORD src1_sel:WORD_1
  v_lshlrev_b32_sdwa v58, 3, v123 dst_sel:DWORD dst_unused:UNUSED_PAD src0_sel:DWORD src1_sel:WORD_0
  v_lshlrev_b32_sdwa v59, 3, v123 dst_sel:DWORD dst_unused:UNUSED_PAD src0_sel:DWORD src1_sel:WORD_1
  ds_read_b64 v[40:41], v56
  ds_read_b64 v[42:43], v57
  ds_read_b64 v[44:45], v58
  ds_read_b64 v[46:47], v59
  s_waitcnt lgkmcnt(4)
M_2_12:
  v_mfma_f32_16x16x32_bf16 v[24:27], v[28:31], v[32:35], v[24:27]
  s_bitcmp1_b32 s54, 12
  s_cbranch_scc1 PE_2
E_2_3_13:
  v_mfma_f32_16x16x32_bf16 v[24:27], v[28:31], v[36:39], v[24:27]
  s_bitcmp1_b32 s54, 13
  s_cbranch_scc1 PE_2
E_2_3_14:
  s_cmp_le_u32 s34, 16
  s_cbranch_scc1 T_2_14
  v_lshlrev_b32_sdwa v56, 3, v124 dst_sel:DWORD dst_unused:UNUSED_PAD src0_sel:DWORD src1_sel:WORD_0
  v_lshlrev_b32_sdwa v57, 3, v124 dst_sel:DWORD dst_unused:UNUSED_PAD src0_sel:DWORD src1_sel:WORD_1
  v_lshlrev_b32_sdwa v58, 3, v125 dst_sel:DWORD dst_unused:UNUSED_PAD src0_sel:DWORD src1_sel:WORD_0
  v_lshlrev_b32_sdwa v59, 3, v125 dst_sel:DWORD dst_unused:UNUSED_PAD src0_sel:DWORD src1_sel:WORD_1
  ds_read_b64 v[32:33], v56
  ds_read_b64 v[34:35], v57
  ds_read_b64 v[36:37], v58
  ds_read_b64 v[38:39], v59
  s_waitcnt lgkmcnt(4)
M_2_14:
  v_mfma_f32_16x16x32_bf16 v[24:27], v[28:31], v[40:43], v[24:27]
  s_bitcmp1_b32 s54, 14
  s_cbranch_scc1 PE_2
E_2_3_15:
  v_mfma_f32_16x16x32_bf16 v[24:27], v[28:31], v[44:47], v[24:27]
  s_bitcmp1_b32 s54, 15
  s_cbranch_scc1 PE_2
E_2_3_16:
  s_cmp_le_u32 s34, 18
  s_cbranch_scc1 T_2_16
  v_lshlrev_b32_sdwa v56, 3, v126 dst_sel:DWORD dst_unused:UNUSED_PAD src0_sel:DWORD src1_sel:WORD_0
  v_lshlrev_b32_sdwa v57, 3, v126 dst_sel:DWORD dst_unused:UNUSED_PAD src0_sel:DWORD src1_sel:WORD_1
  v_lshlrev_b32_sdwa v58, 3, v127 dst_sel:DWORD dst_unused:UNUSED_PAD src0_sel:DWORD src1_sel:WORD_0
  v_lshlrev_b32_sdwa v59, 3, v127 dst_sel:DWORD dst_unused:UNUSED_PAD src0_sel:DWORD src1_sel:WORD_1
  ds_read_b64 v[40:41], v56
  ds_read_b64 v[42:43], v57
  ds_read_b64 v[44:45], v58
  ds_read_b64 v[46:47], v59
  s_waitcnt lgkmcnt(4)
M_2_16:
  v_mfma_f32_16x16x32_bf16 v[24:27], v[28:31], v[32:35], v[24:27]
  s_bitcmp1_b32 s54, 16
  s_cbranch_scc1 PE_2
E_2_3_17:
  v_mfma_f32_16x16x32_bf16 v[24:27], v[28:31], v[36:39], v[24:27]
  s_bitcmp1_b32 s54, 17
  s_cbranch_scc1 PE_2
E_2_3_18:
  s_waitcnt lgkmcnt(0)
  v_mfma_f32_16x16x32_bf16 v[24:27], v[28:31], v[40:43], v[24:27]
  s_bitcmp1_b32 s54, 18
  s_cbranch_scc1 PE_2
E_2_3_19:
  v_mfma_f32_16x16x32_bf16 v[24:27], v[28:31], v[44:47], v[24:27]
  s_branch PE_2
T_2_0:
  s_waitcnt lgkmcnt(0)
  s_branch M_2_0
T_2_2:
  s_waitcnt lgkmcnt(0)
  s_branch M_2_2
T_2_4:
  s_waitcnt lgkmcnt(0)
  s_branch M_2_4
T_2_6:
  s_waitcnt lgkmcnt(0)
  s_branch M_2_6
T_2_8:
  s_waitcnt lgkmcnt(0)
  s_branch M_2_8
T_2_10:
  s_waitcnt lgkmcnt(0)
  s_branch M_2_10
T_2_12:
  s_waitcnt lgkmcnt(0)
  s_branch M_2_12
T_2_14:
  s_waitcnt lgkmcnt(0)
  s_branch M_2_14
T_2_16:
  s_waitcnt lgkmcnt(0)
  s_branch M_2_16
K3_FIN:
  s_waitcnt lgkmcnt(0)
  buffer_store_dwordx4 v[32:35], v68, s[24:27], 0 offen
  buffer_store_dwordx4 v[36:39], v69, s[24:27], 0 offen
K3_END:
  s_endpgm
.section .rodata,"a"
.p2align 6
.amdhsa_kernel hops_kernel
  .amdhsa_next_free_vgpr 128
  .amdhsa_next_free_sgpr 102
  .amdhsa_accum_offset 128
  .amdhsa_group_segment_fixed_size 0
  .amdhsa_kernarg_size 96
  .amdhsa_user_sgpr_count 2
  .amdhsa_user_sgpr_kernarg_segment_ptr 1
  .amdhsa_system_sgpr_workgroup_id_x 1
  .amdhsa_float_denorm_mode_32 3
.end_amdhsa_kernel
.text
.globl final_kernel
.p2align 8
.type final_kernel,@function
final_kernel:
  s_cmp_ge_u32 s2, 256
  s_cbranch_scc1 K4_END
  s_load_dwordx2 s[4:5], s[0:1], 88
  s_load_dwordx2 s[6:7], s[0:1], 72
  s_memtime s[60:61]
  s_memrealtime s[94:95]
  v_lshrrev_b32 v253, 6, v0
  v_and_b32 v1, 63, v0
  s_nop 0
  v_readfirstlane_b32 s24, v253
  s_waitcnt lgkmcnt(0)
  s_add_u32 s8, s4, 12976128
  s_addc_u32 s9, s5, 0
  s_mov_b32 s10, 51904512
  s_mov_b32 s11, 0x20000
  s_mov_b32 s12, s6
  s_mov_b32 s13, s7
  s_mov_b32 s14, 6400000
  s_mov_b32 s15, 0x20000
  s_add_u32 s16, s4, 64880640
  s_addc_u32 s17, s5, 0
  s_mov_b32 s18, 73728
  s_mov_b32 s19, 0x20000
  v_lshrrev_b32 v253, 3, v1
  s_mov_b32 s3, 202752
  v_mul_lo_u32 v253, v253, s3
  v_and_b32 v254, 7, v1
  v_lshlrev_b32 v254, 4, v254
  v_add_u32 v6, v253, v254
  s_getpc_b64 s[20:21]
K4_PC:
  v_lshlrev_b32 v251, 6, v0
  v_cmp_gt_u32 vcc, K4_END-K4_PC, v251
  s_and_saveexec_b64 s[22:23], vcc
  s_cbranch_execz K4_PF1
  global_load_dword v252, v251, s[20:21]
K4_PF1:
  s_mov_b64 exec, s[22:23]
  s_mov_b32 s36, 6
  s_cmp_lt_u32 s2, 27
  s_cselect_b32 s36, 7, s36
  s_mov_b32 s27, 0
  s_mov_b32 s26, 0
  s_mul_i32 s28, s2, 6
  s_add_u32 s28, s28, s27
  s_add_u32 s3, s2, 1536
  s_cmp_eq_u32 s27, 6
  s_cselect_b32 s28, s3, s28
  s_lshl_b32 s29, s28, 7
  s_lshl_b32 s3, s24, 1
  s_mul_i32 s30, s3, 6488064
  s_add_u32 s29, s29, s30
  s_mul_i32 s31, s3, 4128
  s_add_u32 s31, s31, s26
  s_add_u32 m0, s31, 0
  s_add_u32 s3, s29, 0
  buffer_load_dwordx4 v6, s[8:11], s3 offen lds
  s_add_u32 m0, s31, 1024
  s_add_u32 s3, s29, 1622016
  buffer_load_dwordx4 v6, s[8:11], s3 offen lds
  s_add_u32 m0, s31, 2048
  s_add_u32 s3, s29, 3244032
  buffer_load_dwordx4 v6, s[8:11], s3 offen lds
  s_add_u32 m0, s31, 3072
  s_add_u32 s3, s29, 4866048
  buffer_load_dwordx4 v6, s[8:11], s3 offen lds
  s_add_u32 m0, s31, 4128
  s_add_u32 s3, s29, 6488064
  buffer_load_dwordx4 v6, s[8:11], s3 offen lds
  s_add_u32 m0, s31, 5152
  s_add_u32 s3, s29, 8110080
  buffer_load_dwordx4 v6, s[8:11], s3 offen lds
  s_add_u32 m0, s31, 6176
  s_add_u32 s3, s29, 9732096
  buffer_load_dwordx4 v6, s[8:11], s3 offen lds
  s_add_u32 m0, s31, 7200
  s_add_u32 s3, s29, 11354112
  buffer_load_dwordx4 v6, s[8:11], s3 offen lds
  s_mov_b32 s32, s28
  v_lshlrev_b32 v4, 4, v1
  s_lshl_b32 s37, s24, 10
  s_add_u32 m0, s37, 33024
  s_add_u32 s25, s37, 0
  buffer_load_dwordx4 v4, s[16:19], s25 offen lds
  s_add_u32 m0, s37, 37120
  s_add_u32 s25, s37, 4096
  buffer_load_dwordx4 v4, s[16:19], s25 offen lds
  s_add_u32 m0, s37, 41216
  s_add_u32 s25, s37, 8192
  buffer_load_dwordx4 v4, s[16:19], s25 offen lds
  s_add_u32 m0, s37, 45312
  s_add_u32 s25, s37, 12288
  buffer_load_dwordx4 v4, s[16:19], s25 offen lds
  s_add_u32 m0, s37, 49408
  s_add_u32 s25, s37, 16384
  buffer_load_dwordx4 v4, s[16:19], s25 offen lds
  s_add_u32 m0, s37, 53504
  s_add_u32 s25, s37, 20480
  buffer_load_dwordx4 v4, s[16:19], s25 offen lds
  s_add_u32 m0, s37, 57600
  s_add_u32 s25, s37, 24576
  buffer_load_dwordx4 v4, s[16:19], s25 offen lds
  s_add_u32 m0, s37, 61696
  s_add_u32 s25, s37, 28672
  buffer_load_dwordx4 v4, s[16:19], s25 offen lds
  s_add_u32 m0, s37, 65792
  s_add_u32 s25, s37, 32768
  buffer_load_dwordx4 v4, s[16:19], s25 offen lds
  s_add_u32 m0, s37, 69888
  s_add_u32 s25, s37, 36864
  buffer_load_dwordx4 v4, s[16:19], s25 offen lds
  s_add_u32 m0, s37, 73984
  s_add_u32 s25, s37, 40960
  buffer_load_dwordx4 v4, s[16:19], s25 offen lds
  s_add_u32 m0, s37, 78080
  s_add_u32 s25, s37, 45056
  buffer_load_dwordx4 v4, s[16:19], s25 offen lds
  s_add_u32 m0, s37, 82176
  s_add_u32 s25, s37, 49152
  buffer_load_dwordx4 v4, s[16:19], s25 offen lds
  s_add_u32 m0, s37, 86272
  s_add_u32 s25, s37, 53248
  buffer_load_dwordx4 v4, s[16:19], s25 offen lds
  s_add_u32 m0, s37, 90368
  s_add_u32 s25, s37, 57344
  buffer_load_dwordx4 v4, s[16:19], s25 offen lds
  s_add_u32 m0, s37, 94464
  s_add_u32 s25, s37, 61440
  buffer_load_dwordx4 v4, s[16:19], s25 offen lds
  s_add_u32 m0, s37, 99072
  s_add_u32 s25, s37, 65536
  buffer_load_dwordx4 v4, s[16:19], s25 offen lds
  s_add_u32 m0, s37, 103168
  s_add_u32 s25, s37, 69632
  buffer_load_dwordx4 v4, s[16:19], s25 offen lds
  v_and_b32 v253, 7, v1
  v_mul_u32_u24 v253, 4128, v253
  v_bfe_u32 v254, v1, 3, 2
  v_lshlrev_b32 v254, 3, v254
  v_add_u32 v253, v253, v254
  v_lshrrev_b32 v254, 5, v1
  v_lshlrev_b32 v254, 8, v254
  v_add_u32 v253, v253, v254
  s_lshl_b32 s3, s24, 5
  v_add_u32 v2, s3, v253
  v_lshrrev_b32 v253, 5, v1
  v_lshlrev_b32 v253, 2, v253
  v_bfe_u32 v254, v1, 2, 2
  v_add_u32 v253, v253, v254
  v_mul_u32_u24 v253, 4128, v253
  v_bfe_u32 v254, v1, 4, 1
  v_lshlrev_b32 v254, 2, v254
  v_and_b32 v255, 1, v1
  v_lshlrev_b32 v255, 1, v255
  v_add_u32 v254, v254, v255
  v_bfe_u32 v255, v1, 1, 1
  v_add_u32 v254, v254, v255
  v_lshlrev_b32 v254, 7, v254
  v_add_u32 v253, v253, v254
  v_add_u32 v3, s3, v253
  v_bfe_u32 v253, v1, 1, 1
  v_lshlrev_b32 v253, 1, v253
  v_bfe_u32 v254, v1, 3, 1
  v_add_u32 v253, v253, v254
  v_lshlrev_b32 v253, 8, v253
  v_and_b32 v254, 1, v1
  v_lshl_add_u32 v253, v254, 5, v253
  v_bfe_u32 v254, v1, 4, 1
  v_lshl_add_u32 v253, v254, 4, v253
  v_bfe_u32 v254, v1, 5, 1
  v_lshl_add_u32 v253, v254, 3, v253
  v_bfe_u32 v254, v1, 2, 1
  v_cmp_eq_u32 vcc, 1, v254
  v_mov_b32 v255, 0x7f000000
  s_nop 0
  v_cndmask_b32 v5, v253, v255, vcc
  s_mov_b32 s40, 0xff
  s_mov_b32 s41, 0xff
  s_lshl_b64 s[42:43], s[40:41], 8
  s_lshl_b64 s[44:45], s[40:41], 16
  s_lshl_b64 s[46:47], s[40:41], 24
  s_mov_b32 s48, 0x20001
  s_mov_b32 s49, 0x20001
  s_mov_b32 s50, 0x2000100
  s_mov_b32 s51, 0x2000100
  s_mov_b32 s52, 0x80004
  s_mov_b32 s53, 0x80004
  s_mov_b32 s54, 0x8000400
  s_mov_b32 s55, 0x8000400
  s_mov_b32 s56, 0xffff0000
  s_mov_b32 s57, 0x3c000000
  s_mov_b32 s58, 0x3727c5ac
  s_mov_b32 s70, 0xaaaaaaaa
  s_mov_b32 s71, 0xaaaaaaaa
  s_mov_b32 s72, 0xcccccccc
  s_mov_b32 s73, 0xcccccccc
  s_mov_b32 s74, 0xf0f0f0f0
  s_mov_b32 s75, 0xf0f0f0f0
  v_add_u32 v253, 33024, v4
  v_add_u32 v254, 65792, v4
  v_add_u32 v4, 99072, v4
  s_waitcnt vmcnt(0)
  s_barrier
  ds_read_b128 a[0:3], v253 offset:0
  ds_read_b128 a[4:7], v253 offset:1024
  ds_read_b128 a[8:11], v253 offset:2048
  ds_read_b128 a[12:15], v253 offset:3072
  ds_read_b128 a[16:19], v253 offset:4096
  ds_read_b128 a[20:23], v253 offset:5120
  ds_read_b128 a[24:27], v253 offset:6144
  ds_read_b128 a[28:31], v253 offset:7168
  s_waitcnt lgkmcnt(4)
  ds_read_b128 a[32:35], v253 offset:8192
  ds_read_b128 a[36:39], v253 offset:9216
  ds_read_b128 a[40:43], v253 offset:10240
  ds_read_b128 a[44:47], v253 offset:11264
  ds_read_b128 a[48:51], v253 offset:12288
  ds_read_b128 a[52:55], v253 offset:13312
  ds_read_b128 a[56:59], v253 offset:14336
  ds_read_b128 a[60:63], v253 offset:15360
  s_waitcnt lgkmcnt(4)
  ds_read_b128 a[64:67], v253 offset:16384
  ds_read_b128 a[68:71], v253 offset:17408
  ds_read_b128 a[72:75], v253 offset:18432
  ds_read_b128 a[76:79], v253 offset:19456
  ds_read_b128 a[80:83], v253 offset:20480
  ds_read_b128 a[84:87], v253 offset:21504
  ds_read_b128 a[88:91], v253 offset:22528
  ds_read_b128 a[92:95], v253 offset:23552
  s_waitcnt lgkmcnt(4)
  ds_read_b128 a[96:99], v253 offset:24576
  ds_read_b128 a[100:103], v253 offset:25600
  ds_read_b128 a[104:107], v253 offset:26624
  ds_read_b128 a[108:111], v253 offset:27648
  ds_read_b128 a[112:115], v253 offset:28672
  ds_read_b128 a[116:119], v253 offset:29696
  ds_read_b128 a[120:123], v253 offset:30720
  ds_read_b128 a[124:127], v253 offset:31744
  s_waitcnt lgkmcnt(4)
  ds_read_b128 a[128:131], v254 offset:0
  ds_read_b128 a[132:135], v254 offset:1024
  ds_read_b128 a[136:139], v254 offset:2048
  ds_read_b128 a[140:143], v254 offset:3072
  ds_read_b128 a[144:147], v254 offset:4096
  ds_read_b128 a[148:151], v254 offset:5120
  ds_read_b128 a[152:155], v254 offset:6144
  ds_read_b128 a[156:159], v254 offset:7168
  s_waitcnt lgkmcnt(4)
  ds_read_b128 a[160:163], v254 offset:8192
  ds_read_b128 a[164:167], v254 offset:9216
  ds_read_b128 a[168:171], v254 offset:10240
  ds_read_b128 a[172:175], v254 offset:11264
  ds_read_b128 a[176:179], v254 offset:12288
  ds_read_b128 a[180:183], v254 offset:13312
  ds_read_b128 a[184:187], v254 offset:14336
  ds_read_b128 a[188:191], v254 offset:15360
  s_waitcnt lgkmcnt(4)
  ds_read_b128 a[192:195], v254 offset:16384
  ds_read_b128 a[196:199], v254 offset:17408
  ds_read_b128 a[200:203], v254 offset:18432
  ds_read_b128 a[204:207], v254 offset:19456
  ds_read_b128 a[208:211], v254 offset:20480
  ds_read_b128 a[212:215], v254 offset:21504
  ds_read_b128 a[216:219], v254 offset:22528
  ds_read_b128 a[220:223], v254 offset:23552
  s_waitcnt lgkmcnt(4)
  ds_read_b128 a[224:227], v254 offset:24576
  ds_read_b128 a[228:231], v254 offset:25600
  ds_read_b128 a[232:235], v254 offset:26624
  ds_read_b128 a[236:239], v254 offset:27648
  ds_read_b128 a[240:243], v254 offset:28672
  ds_read_b128 a[244:247], v254 offset:29696
  ds_read_b128 a[248:251], v254 offset:30720
  ds_read_b128 a[252:255], v254 offset:31744
  s_waitcnt lgkmcnt(4)
  s_waitcnt lgkmcnt(0)
  s_barrier
  s_mov_b32 s35, 0
  s_mov_b32 s26, 0
  s_mov_b32 s32, s28
  v_mov_b32 v253, v3
  s_mov_b32 s59, 0x7f000000
  s_branch K4_ENTER
K4_ROUND:
  v_add_u32 v253, s26, v3
  s_lshl_b32 s3, s32, 12
  s_lshl_b32 s59, s24, 10
  s_add_u32 s59, s59, s3
  s_add_u32 s35, s35, 1
  s_cmp_ge_u32 s35, s36
  s_cbranch_scc1 K4_LAST
  s_mov_b32 s32, s28
  s_add_u32 s3, s26, 33024
  s_cmp_eq_u32 s3, 99072
  s_cselect_b32 s3, 0, s3
  s_sub_u32 s34, s3, s26
  v_add_u32 v2, s34, v2
  s_mov_b32 s26, s3
  s_waitcnt vmcnt(0)
  s_barrier
K4_ENTER:
  s_add_u32 s27, s35, 1
  s_add_u32 s33, s26, 33024
  s_cmp_eq_u32 s33, 99072
  s_cselect_b32 s33, 0, s33
  s_cmp_ge_u32 s27, s36
  s_cselect_b32 s10, 0, s10
  s_mul_i32 s28, s2, 6
  s_add_u32 s28, s28, s27
  s_add_u32 s3, s2, 1536
  s_cmp_eq_u32 s27, 6
  s_cselect_b32 s28, s3, s28
  s_lshl_b32 s29, s28, 7
  s_lshl_b32 s3, s24, 1
  s_mul_i32 s30, s3, 6488064
  s_add_u32 s29, s29, s30
  s_mul_i32 s31, s3, 4128
  s_add_u32 s31, s31, s33
  s_add_u32 m0, s31, 0
  s_add_u32 s3, s29, 0
  buffer_load_dwordx4 v6, s[8:11], s3 offen lds
  ds_read_b64 v[8:9], v2 offset:0
  ds_read_b64 v[10:11], v2 offset:128
  ds_read_b64 v[12:13], v2 offset:512
  ds_read_b64 v[14:15], v2 offset:640
  ds_read_b64 v[16:17], v2 offset:1024
  ds_read_b64 v[18:19], v2 offset:1152
  ds_read_b64 v[20:21], v2 offset:1536
  ds_read_b64 v[22:23], v2 offset:1664
  ds_read_b64 v[24:25], v2 offset:2048
  ds_read_b64 v[26:27], v2 offset:2176
  ds_read_b64 v[28:29], v2 offset:2560
  ds_read_b64 v[30:31], v2 offset:2688
  ds_read_b64 v[32:33], v2 offset:3072
  ds_read_b64 v[34:35], v2 offset:3200
  ds_read_b64 v[36:37], v2 offset:3584
  s_waitcnt lgkmcnt(14)
  ds_read_b64 v[38:39], v2 offset:3712
  s_waitcnt lgkmcnt(14)
  ds_read_b128 v[152:155], v4 offset:0
  s_waitcnt lgkmcnt(14)
  ds_read_b128 v[156:159], v4 offset:1024
  v_add_f32 v232, v208, v209
  v_add_f32 v233, v210, v211
  v_add_f32 v232, v232, v233
  v_mov_b32 v233, v232
  v_add_f32 v234, v149, v150
  v_mov_b32 v237, v212
  v_permlane32_swap_b32 v232, v233
  v_add_f32 v232, v232, v233
  v_mul_f32 v233, s57, v148
  v_mul_f32 v232, s57, v232
  v_fma_f32 v232, -v233, v233, v232
  v_add_f32 v232, s58, v232
  v_rsq_f32 v232, v232
  v_mov_b32 v238, v213
  v_mfma_f32_32x32x16_bf16 v[88:103], v[8:11], v[8:11], 0
  v_mul_f32 v232, v232, v234
  v_mov_b32 v239, v214
  v_mov_b32 v240, v215
  v_max_f32_dpp v233, v232, v232 quad_perm:[1,0,3,2] row_mask:0xf bank_mask:0xf
  s_waitcnt lgkmcnt(14)
  ds_read_b64_tr_b16 v[160:161], v253 offset:0
  s_waitcnt lgkmcnt(14)
  ds_read_b64_tr_b16 v[162:163], v253 offset:8
  v_mfma_f32_32x32x16_bf16 v[88:103], v[12:15], v[12:15], v[88:103]
  v_max_f32_dpp v233, v233, v233 quad_perm:[2,3,0,1] row_mask:0xf bank_mask:0xf
  s_waitcnt lgkmcnt(14)
  ds_read_b64_tr_b16 v[168:169], v253 offset:1024
  s_waitcnt lgkmcnt(14)
  ds_read_b64_tr_b16 v[170:171], v253 offset:1032
  s_add_u32 m0, s31, 1024
  s_add_u32 s3, s29, 1622016
  buffer_load_dwordx4 v6, s[8:11], s3 offen lds
  v_mfma_f32_32x32x16_bf16 v[88:103], v[16:19], v[16:19], v[88:103]
  v_max_f32_dpp v233, v233, v233 row_half_mirror row_mask:0xf bank_mask:0xf
  v_sub_f32 v232, v232, v233
  v_exp_f32 v232, v232
  s_waitcnt lgkmcnt(14)
  ds_read_b64_tr_b16 v[164:165], v253 offset:16
  s_waitcnt lgkmcnt(14)
  ds_read_b64_tr_b16 v[166:167], v253 offset:24
  v_mfma_f32_32x32x16_bf16 v[88:103], v[20:23], v[20:23], v[88:103]
  v_add_f32_dpp v234, v232, v232 quad_perm:[1,0,3,2] row_mask:0xf bank_mask:0xf
  s_waitcnt lgkmcnt(14)
  ds_read_b64_tr_b16 v[172:173], v253 offset:1040
  s_waitcnt lgkmcnt(14)
  ds_read_b64_tr_b16 v[174:175], v253 offset:1048
  v_add_f32_dpp v234, v234, v234 quad_perm:[2,3,0,1] row_mask:0xf bank_mask:0xf
  v_mfma_f32_32x32x16_bf16 v[88:103], v[24:27], v[24:27], v[88:103]
  s_nop 0
  v_add_f32_dpp v234, v234, v234 row_half_mirror row_mask:0xf bank_mask:0xf
  v_rcp_f32 v234, v234
  s_waitcnt lgkmcnt(6)
  v_mfma_f32_32x32x16_bf16 v[88:103], v[28:31], v[28:31], v[88:103]
  v_mul_f32 v235, v232, v234
  v_mul_f32 v237, v237, v235
  v_mul_f32 v238, v238, v235
  v_mul_f32 v239, v239, v235
  v_mul_f32 v240, v240, v235
  v_add_f32_dpp v237, v237, v237 quad_perm:[1,0,3,2] row_mask:0xf bank_mask:0xf
  v_mfma_f32_32x32x16_bf16 v[88:103], v[32:35], v[32:35], v[88:103]
  v_add_f32_dpp v238, v238, v238 quad_perm:[1,0,3,2] row_mask:0xf bank_mask:0xf
  v_add_f32_dpp v239, v239, v239 quad_perm:[1,0,3,2] row_mask:0xf bank_mask:0xf
  v_add_f32_dpp v240, v240, v240 quad_perm:[1,0,3,2] row_mask:0xf bank_mask:0xf
  v_add_f32_dpp v237, v237, v237 quad_perm:[2,3,0,1] row_mask:0xf bank_mask:0xf
  v_add_f32_dpp v238, v238, v238 quad_perm:[2,3,0,1] row_mask:0xf bank_mask:0xf
  v_add_f32_dpp v239, v239, v239 quad_perm:[2,3,0,1] row_mask:0xf bank_mask:0xf
  v_mfma_f32_32x32x16_bf16 v[88:103], v[36:39], v[36:39], v[88:103]
  v_add_f32_dpp v240, v240, v240 quad_perm:[2,3,0,1] row_mask:0xf bank_mask:0xf
  v_add_f32_dpp v237, v237, v237 row_half_mirror row_mask:0xf bank_mask:0xf
  v_add_f32_dpp v238, v238, v238 row_half_mirror row_mask:0xf bank_mask:0xf
  v_add_f32_dpp v239, v239, v239 row_half_mirror row_mask:0xf bank_mask:0xf
  v_add_f32_dpp v240, v240, v240 row_half_mirror row_mask:0xf bank_mask:0xf
  s_add_u32 m0, s31, 2048
  s_add_u32 s3, s29, 3244032
  buffer_load_dwordx4 v6, s[8:11], s3 offen lds
  v_mfma_f32_32x32x16_bf16 v[72:87], a[0:3], v[8:11], 0
  v_mov_b32 v236, v235
  v_cvt_pk_bf16_f32 v245, v237, v238
  v_cvt_pk_bf16_f32 v246, v239, v240
  v_cndmask_b32 v184, v88, v92, s[42:43]
  v_cndmask_b32 v185, v89, v93, s[42:43]
  v_cndmask_b32 v186, v90, v94, s[42:43]
  v_mfma_f32_32x32x16_bf16 v[72:87], a[4:7], v[12:15], v[72:87]
  v_cndmask_b32 v187, v91, v95, s[42:43]
  v_cndmask_b32 v184, v184, v96, s[44:45]
  v_cndmask_b32 v185, v185, v97, s[44:45]
  v_cndmask_b32 v186, v186, v98, s[44:45]
  v_cndmask_b32 v187, v187, v99, s[44:45]
  v_cndmask_b32 v184, v184, v100, s[46:47]
  v_mfma_f32_32x32x16_bf16 v[72:87], a[8:11], v[16:19], v[72:87]
  v_cndmask_b32 v185, v185, v101, s[46:47]
  v_cndmask_b32 v186, v186, v102, s[46:47]
  v_cndmask_b32 v187, v187, v103, s[46:47]
  v_cndmask_b32 v184, v184, v185, s[70:71]
  v_cndmask_b32 v186, v186, v187, s[70:71]
  v_cndmask_b32 v184, v184, v186, s[72:73]
  v_mfma_f32_32x32x16_bf16 v[88:103], a[32:35], v[8:11], 0
  v_mov_b32 v185, v184
  v_mov_b32_dpp v236, v235 row_shr:4 row_mask:0x3 bank_mask:0xa
  v_mov_b32 v249, v245
  v_permlane32_swap_b32 v184, v185
  v_cndmask_b32 v184, v184, v185, s[74:75]
  v_mfma_f32_32x32x16_bf16 v[72:87], a[12:15], v[20:23], v[72:87]
  v_mul_f32 v184, s57, v184
  v_mov_b32 v250, v246
  v_mov_b32_dpp v236, v235 row_shl:4 row_mask:0xc bank_mask:0x5
  v_permlane16_swap_b32 v245, v249
  v_permlane16_swap_b32 v246, v250
  v_mfma_f32_32x32x16_bf16 v[88:103], a[36:39], v[12:15], v[88:103]
  v_mov_b32_dpp v241, v236 quad_perm:[0,0,0,0] row_mask:0xf bank_mask:0xf
  v_mov_b32_dpp v242, v236 quad_perm:[1,1,1,1] row_mask:0xf bank_mask:0xf
  v_mov_b32_dpp v243, v236 quad_perm:[2,2,2,2] row_mask:0xf bank_mask:0xf
  v_mov_b32_dpp v244, v236 quad_perm:[3,3,3,3] row_mask:0xf bank_mask:0xf
  s_add_u32 m0, s31, 3072
  s_add_u32 s3, s29, 4866048
  buffer_load_dwordx4 v6, s[8:11], s3 offen lds
  v_mfma_f32_32x32x16_bf16 v[72:87], a[16:19], v[24:27], v[72:87]
  v_cndmask_b32 v216, 0, v245, s[48:49]
  v_cndmask_b32 v217, 0, v246, s[48:49]
  v_cndmask_b32 v218, 0, v245, s[50:51]
  v_cndmask_b32 v219, 0, v246, s[50:51]
  v_cvt_pk_bf16_f32 v247, v241, v242
  v_cvt_pk_bf16_f32 v248, v243, v244
  v_mfma_f32_32x32x16_bf16 v[88:103], a[40:43], v[16:19], v[88:103]
  v_mov_b32 v251, v247
  v_mov_b32 v252, v248
  v_cndmask_b32 v220, 0, v249, s[52:53]
  v_cndmask_b32 v221, 0, v250, s[52:53]
  v_cndmask_b32 v222, 0, v249, s[54:55]
  v_cndmask_b32 v223, 0, v250, s[54:55]
  v_mfma_f32_32x32x16_bf16 v[72:87], a[20:23], v[28:31], v[72:87]
  v_permlane16_swap_b32 v247, v251
  v_permlane16_swap_b32 v248, v252
  v_cndmask_b32 v224, 0, v247, s[48:49]
  v_cndmask_b32 v225, 0, v248, s[48:49]
  v_mfma_f32_32x32x16_bf16 v[88:103], a[44:47], v[20:23], v[88:103]
  v_cndmask_b32 v226, 0, v247, s[50:51]
  v_cndmask_b32 v227, 0, v248, s[50:51]
  v_cndmask_b32 v228, 0, v251, s[52:53]
  v_cndmask_b32 v229, 0, v252, s[52:53]
  v_cndmask_b32 v230, 0, v251, s[54:55]
  v_cndmask_b32 v231, 0, v252, s[54:55]
  v_mfma_f32_32x32x16_bf16 v[72:87], a[24:27], v[32:35], v[72:87]
  v_mfma_f32_32x32x16_bf16 v[88:103], a[48:51], v[24:27], v[88:103]
  s_add_u32 m0, s31, 4128
  s_add_u32 s3, s29, 6488064
  buffer_load_dwordx4 v6, s[8:11], s3 offen lds
  v_mfma_f32_32x32x16_bf16 v[72:87], a[28:31], v[36:39], v[72:87]
  v_mfma_f32_32x32x16_bf16 v[88:103], a[52:55], v[28:31], v[88:103]
  v_mfma_f32_16x16x32_bf16 v[144:147], v[152:155], v[8:11], 0
  ds_read_b128 v[152:155], v4 offset:2048
  v_mfma_f32_16x16x32_bf16 v[144:147], v[156:159], v[12:15], v[144:147]
  ds_read_b128 v[156:159], v4 offset:3072
  v_mfma_f32_32x32x16_bf16 v[88:103], a[56:59], v[32:35], v[88:103]
  v_mfma_f32_32x32x16_bf16 v[88:103], a[60:63], v[36:39], v[88:103]
  s_nop 4
  v_cvt_pk_bf16_f32 v120, v72, v73
  v_mfma_f32_16x16x32_bf16 v[176:179], v[40:43], v[216:219], 0
  v_cvt_pk_bf16_f32 v121, v74, v75
  v_cvt_pk_bf16_f32 v122, v76, v77
  v_mfma_f32_16x16x32_bf16 v[180:183], v[48:51], v[216:219], 0
  v_cvt_pk_bf16_f32 v123, v78, v79
  s_add_u32 m0, s31, 5152
  s_add_u32 s3, s29, 8110080
  buffer_load_dwordx4 v6, s[8:11], s3 offen lds
  v_mfma_f32_32x32x16_bf16 v[104:119], v[8:11], v[120:123], 0
  v_cvt_pk_bf16_f32 v124, v80, v81
  v_cvt_pk_bf16_f32 v125, v82, v83
  v_cvt_pk_bf16_f32 v126, v84, v85
  v_cvt_pk_bf16_f32 v127, v86, v87
  v_cvt_pk_bf16_f32 v128, v88, v89
  v_cvt_pk_bf16_f32 v129, v90, v91
  v_mfma_f32_32x32x16_bf16 v[72:87], a[64:67], v[8:11], 0
  v_cvt_pk_bf16_f32 v130, v92, v93
  v_cvt_pk_bf16_f32 v131, v94, v95
  v_cvt_pk_bf16_f32 v132, v96, v97
  v_cvt_pk_bf16_f32 v133, v98, v99
  v_cvt_pk_bf16_f32 v134, v100, v101
  v_cvt_pk_bf16_f32 v135, v102, v103
  v_mfma_f32_32x32x16_bf16 v[72:87], a[68:71], v[12:15], v[72:87]
  v_mfma_f32_32x32x16_bf16 v[88:103], a[96:99], v[8:11], 0
  v_mfma_f32_32x32x16_bf16 v[72:87], a[72:75], v[16:19], v[72:87]
  s_waitcnt lgkmcnt(0)
  v_mfma_f32_16x16x32_bf16 v[144:147], v[152:155], v[16:19], v[144:147]
  ds_read_b128 v[152:155], v4 offset:4096
  v_mfma_f32_16x16x32_bf16 v[144:147], v[156:159], v[20:23], v[144:147]
  ds_read_b128 v[156:159], v4 offset:5120
  s_add_u32 m0, s31, 6176
  s_add_u32 s3, s29, 9732096
  buffer_load_dwordx4 v6, s[8:11], s3 offen lds
  v_mfma_f32_32x32x16_bf16 v[88:103], a[100:103], v[12:15], v[88:103]
  v_mfma_f32_32x32x16_bf16 v[72:87], a[76:79], v[20:23], v[72:87]
  v_mfma_f32_32x32x16_bf16 v[88:103], a[104:107], v[16:19], v[88:103]
  v_mfma_f32_32x32x16_bf16 v[72:87], a[80:83], v[24:27], v[72:87]
  v_mfma_f32_32x32x16_bf16 v[88:103], a[108:111], v[20:23], v[88:103]
  v_mfma_f32_32x32x16_bf16 v[72:87], a[84:87], v[28:31], v[72:87]
  s_add_u32 m0, s31, 7200
  s_add_u32 s3, s29, 11354112
  buffer_load_dwordx4 v6, s[8:11], s3 offen lds
  s_waitcnt lgkmcnt(0)
  v_mfma_f32_16x16x32_bf16 v[144:147], v[152:155], v[24:27], v[144:147]
  ds_read_b128 v[152:155], v4 offset:6144
  v_mfma_f32_32x32x16_bf16 v[104:119], v[12:15], v[124:127], v[104:119]
  v_mfma_f32_32x32x16_bf16 v[88:103], a[112:115], v[24:27], v[88:103]
  v_mfma_f32_32x32x16_bf16 v[72:87], a[88:91], v[32:35], v[72:87]
  v_mfma_f32_16x16x32_bf16 v[144:147], v[156:159], v[28:31], v[144:147]
  ds_read_b128 v[156:159], v4 offset:7168
  v_mfma_f32_32x32x16_bf16 v[104:119], v[16:19], v[128:131], v[104:119]
  v_mfma_f32_32x32x16_bf16 v[88:103], a[116:119], v[28:31], v[88:103]
  v_mfma_f32_32x32x16_bf16 v[72:87], a[92:95], v[36:39], v[72:87]
  v_mfma_f32_32x32x16_bf16 v[104:119], v[20:23], v[132:135], v[104:119]
  v_mfma_f32_32x32x16_bf16 v[88:103], a[120:123], v[32:35], v[88:103]
  v_mfma_f32_32x32x16_bf16 v[88:103], a[124:127], v[36:39], v[88:103]
  s_waitcnt lgkmcnt(0)
  v_mfma_f32_16x16x32_bf16 v[144:147], v[152:155], v[32:35], v[144:147]
  ds_read_b128 v[152:155], v4 offset:0
  v_mfma_f32_16x16x32_bf16 v[144:147], v[156:159], v[36:39], v[144:147]
  ds_read_b128 v[156:159], v4 offset:1024
  v_mfma_f32_16x16x32_bf16 v[176:179], v[44:47], v[220:223], v[176:179]
  v_mfma_f32_16x16x32_bf16 v[180:183], v[52:55], v[220:223], v[180:183]
  v_mfma_f32_16x16x32_bf16 v[176:179], v[160:163], v[224:227], v[176:179]
  ds_read_b64_tr_b16 v[160:161], v253 offset:2048
  ds_read_b64_tr_b16 v[162:163], v253 offset:2056
  v_mfma_f32_16x16x32_bf16 v[180:183], v[168:171], v[224:227], v[180:183]
  v_cvt_pk_bf16_f32 v120, v72, v73
  v_cvt_pk_bf16_f32 v121, v74, v75
  v_mfma_f32_16x16x32_bf16 v[176:179], v[164:167], v[228:231], v[176:179]
  v_cvt_pk_bf16_f32 v122, v76, v77
  v_cvt_pk_bf16_f32 v123, v78, v79
  v_mfma_f32_16x16x32_bf16 v[180:183], v[172:175], v[228:231], v[180:183]
  v_cvt_pk_bf16_f32 v124, v80, v81
  v_cvt_pk_bf16_f32 v125, v82, v83
  v_mfma_f32_32x32x16_bf16 v[104:119], v[24:27], v[120:123], v[104:119]
  v_cvt_pk_bf16_f32 v126, v84, v85
  v_cvt_pk_bf16_f32 v127, v86, v87
  v_cvt_pk_bf16_f32 v128, v88, v89
  v_cvt_pk_bf16_f32 v129, v90, v91
  v_cvt_pk_bf16_f32 v130, v92, v93
  v_cvt_pk_bf16_f32 v131, v94, v95
  v_mfma_f32_32x32x16_bf16 v[72:87], v[8:11], a[128:131], 0
  v_mul_f32 v185, s57, v144
  v_cvt_pk_bf16_f32 v132, v96, v97
  v_cvt_pk_bf16_f32 v133, v98, v99
  v_cvt_pk_bf16_f32 v134, v100, v101
  v_cvt_pk_bf16_f32 v135, v102, v103
  v_fma_f32 v184, -v185, v185, v184
  v_mfma_f32_32x32x16_bf16 v[104:119], v[28:31], v[124:127], v[104:119]
  v_add_f32 v184, s58, v184
  v_rsq_f32 v7, v184
  ds_read_b64_tr_b16 v[168:169], v253 offset:3072
  v_mov_b32 v188, v7
  ds_read_b64_tr_b16 v[170:171], v253 offset:3080
  v_mfma_f32_32x32x16_bf16 v[72:87], v[12:15], a[132:135], v[72:87]
  v_mov_b32_dpp v188, v7 row_shr:4 row_mask:0x3 bank_mask:0xa
  ds_read_b64_tr_b16 v[164:165], v253 offset:2064
  ds_read_b64_tr_b16 v[166:167], v253 offset:2072
  v_mov_b32_dpp v188, v7 row_shl:4 row_mask:0xc bank_mask:0x5
  ds_read_b64_tr_b16 v[172:173], v253 offset:3088
  ds_read_b64_tr_b16 v[174:175], v253 offset:3096
  v_mfma_f32_32x32x16_bf16 v[104:119], v[32:35], v[128:131], v[104:119]
  v_mov_b32_dpp v196, v188 quad_perm:[0,0,0,0] row_mask:0xf bank_mask:0xf
  v_mov_b32_dpp v197, v188 quad_perm:[1,1,1,1] row_mask:0xf bank_mask:0xf
  v_mov_b32_dpp v198, v188 quad_perm:[2,2,2,2] row_mask:0xf bank_mask:0xf
  v_mov_b32_dpp v199, v188 quad_perm:[3,3,3,3] row_mask:0xf bank_mask:0xf
  v_mul_f32 v189, v196, v7
  v_mul_f32 v190, v197, v7
  v_mfma_f32_32x32x16_bf16 v[72:87], v[16:19], a[136:139], v[72:87]
  v_mul_f32 v191, v198, v7
  v_mul_f32 v206, v199, v7
  v_cvt_pk_bf16_f32 v238, v176, v177
  v_cvt_pk_bf16_f32 v239, v178, v179
  v_cvt_pk_bf16_f32 v242, v180, v181
  v_cvt_pk_bf16_f32 v243, v182, v183
  v_mfma_f32_32x32x16_bf16 v[104:119], v[36:39], v[132:135], v[104:119]
  buffer_store_dwordx2 v[238:239], v5, s[12:15], s59 offen offset:0
  buffer_store_dwordx2 v[242:243], v5, s[12:15], s59 offen offset:64
  v_mfma_f32_32x32x16_bf16 v[72:87], v[20:23], a[140:143], v[72:87]
  v_mfma_f32_32x32x16_bf16 v[88:103], v[8:11], a[160:163], 0
  v_mfma_f32_32x32x16_bf16 v[72:87], v[24:27], a[144:147], v[72:87]
  v_mfma_f32_32x32x16_bf16 v[88:103], v[12:15], a[164:167], v[88:103]
  v_mfma_f32_32x32x16_bf16 v[72:87], v[28:31], a[148:151], v[72:87]
  s_nop 4
  v_cndmask_b32 v192, v104, v108, s[42:43]
  v_mfma_f32_32x32x16_bf16 v[88:103], v[16:19], a[168:171], v[88:103]
  v_cndmask_b32 v193, v105, v109, s[42:43]
  v_cndmask_b32 v194, v106, v110, s[42:43]
  v_cndmask_b32 v192, v192, v112, s[44:45]
  v_cndmask_b32 v193, v193, v113, s[44:45]
  v_cndmask_b32 v194, v194, v114, s[44:45]
  v_cndmask_b32 v195, v107, v111, s[42:43]
  v_mfma_f32_32x32x16_bf16 v[72:87], v[32:35], a[152:155], v[72:87]
  v_cndmask_b32 v192, v192, v116, s[46:47]
  v_cndmask_b32 v193, v193, v117, s[46:47]
  v_cndmask_b32 v194, v194, v118, s[46:47]
  v_cndmask_b32 v195, v195, v115, s[44:45]
  v_cndmask_b32 v195, v195, v119, s[46:47]
  v_mul_f32 v192, v192, v189
  v_mfma_f32_32x32x16_bf16 v[88:103], v[20:23], a[172:175], v[88:103]
  v_mul_f32 v193, v193, v190
  v_mul_f32 v194, v194, v191
  v_mul_f32 v195, v195, v206
  v_max3_f32 v200, v192, v193, v194
  v_max_f32 v200, v200, v195
  v_mov_b32 v201, v200
  v_mfma_f32_32x32x16_bf16 v[72:87], v[36:39], a[156:159], v[72:87]
  v_lshlrev_b32 v104, 16, v8
  v_permlane32_swap_b32 v200, v201
  v_max_f32 v200, v200, v201
  v_sub_f32 v192, v192, v200
  v_sub_f32 v193, v193, v200
  v_mfma_f32_32x32x16_bf16 v[88:103], v[24:27], a[176:179], v[88:103]
  v_sub_f32 v194, v194, v200
  v_sub_f32 v195, v195, v200
  v_exp_f32 v192, v192
  v_exp_f32 v193, v193
  v_mfma_f32_32x32x16_bf16 v[88:103], v[28:31], a[180:183], v[88:103]
  v_exp_f32 v194, v194
  v_exp_f32 v195, v195
  v_add_f32 v202, v192, v193
  v_add_f32 v203, v194, v195
  v_mfma_f32_32x32x16_bf16 v[88:103], v[32:35], a[184:187], v[88:103]
  v_add_f32 v202, v202, v203
  v_mov_b32 v203, v202
  v_cvt_pk_bf16_f32 v40, v72, v73
  v_cvt_pk_bf16_f32 v41, v74, v75
  v_permlane32_swap_b32 v202, v203
  v_mfma_f32_32x32x16_bf16 v[88:103], v[36:39], a[188:191], v[88:103]
  v_add_f32 v202, v202, v203
  v_cvt_pk_bf16_f32 v42, v76, v77
  v_cvt_pk_bf16_f32 v43, v78, v79
  v_cvt_pk_bf16_f32 v44, v80, v81
  v_cvt_pk_bf16_f32 v45, v82, v83
  v_cvt_pk_bf16_f32 v46, v84, v85
  v_mfma_f32_16x16x32_bf16 v[176:179], v[56:59], v[216:219], 0
  v_cvt_pk_bf16_f32 v47, v86, v87
  v_rcp_f32 v202, v202
  v_mfma_f32_32x32x16_bf16 v[72:87], v[8:11], a[192:195], 0
  v_mul_f32 v196, v196, v202
  v_mul_f32 v197, v197, v202
  v_mul_f32 v198, v198, v202
  v_mul_f32 v199, v199, v202
  v_mul_f32 v212, v192, v196
  v_mul_f32 v213, v193, v197
  v_mfma_f32_32x32x16_bf16 v[72:87], v[12:15], a[196:199], v[72:87]
  v_mul_f32 v214, v194, v198
  v_mul_f32 v215, v195, v199
  v_cvt_pk_bf16_f32 v204, v212, v213
  v_cvt_pk_bf16_f32 v205, v214, v215
  v_cndmask_b32 v136, 0, v204, s[40:41]
  v_cndmask_b32 v137, 0, v205, s[40:41]
  v_mfma_f32_32x32x16_bf16 v[72:87], v[16:19], a[200:203], v[72:87]
  v_cndmask_b32 v138, 0, v204, s[42:43]
  v_cndmask_b32 v139, 0, v205, s[42:43]
  v_and_b32 v105, s56, v8
  v_lshlrev_b32 v106, 16, v9
  v_and_b32 v107, s56, v9
  v_lshlrev_b32 v108, 16, v10
  v_mfma_f32_16x16x32_bf16 v[180:183], v[64:67], v[216:219], 0
  v_and_b32 v109, s56, v10
  v_lshlrev_b32 v110, 16, v11
  v_mfma_f32_32x32x16_bf16 v[72:87], v[20:23], a[204:207], v[72:87]
  v_and_b32 v111, s56, v11
  v_lshlrev_b32 v112, 16, v12
  v_and_b32 v113, s56, v12
  v_lshlrev_b32 v114, 16, v13
  v_and_b32 v115, s56, v13
  v_lshlrev_b32 v116, 16, v14
  v_mfma_f32_16x16x32_bf16 v[176:179], v[60:63], v[220:223], v[176:179]
  v_and_b32 v117, s56, v14
  v_lshlrev_b32 v118, 16, v15
  v_mfma_f32_16x16x32_bf16 v[180:183], v[68:71], v[220:223], v[180:183]
  v_and_b32 v119, s56, v15
  v_cndmask_b32 v140, 0, v204, s[44:45]
  s_waitcnt lgkmcnt(0)
  v_mfma_f32_16x16x32_bf16 v[176:179], v[160:163], v[224:227], v[176:179]
  v_cndmask_b32 v141, 0, v205, s[44:45]
  v_cndmask_b32 v142, 0, v204, s[46:47]
  v_mfma_f32_32x32x16_bf16 v[104:119], v[40:43], v[136:139], v[104:119]
  v_cndmask_b32 v143, 0, v205, s[46:47]
  v_cvt_pk_bf16_f32 v48, v88, v89
  v_cvt_pk_bf16_f32 v49, v90, v91
  v_cvt_pk_bf16_f32 v50, v92, v93
  v_cvt_pk_bf16_f32 v51, v94, v95
  v_cvt_pk_bf16_f32 v52, v96, v97
  v_mfma_f32_32x32x16_bf16 v[104:119], v[44:47], v[140:143], v[104:119]
  v_cvt_pk_bf16_f32 v53, v98, v99
  v_cvt_pk_bf16_f32 v54, v100, v101
  v_cvt_pk_bf16_f32 v55, v102, v103
  v_lshlrev_b32 v216, 16, v16
  v_and_b32 v217, s56, v16
  v_lshlrev_b32 v218, 16, v17
  v_mfma_f32_32x32x16_bf16 v[88:103], v[8:11], a[224:227], 0
  v_and_b32 v219, s56, v17
  v_lshlrev_b32 v220, 16, v18
  v_and_b32 v221, s56, v18
  v_lshlrev_b32 v222, 16, v19
  v_and_b32 v223, s56, v19
  v_cvt_pk_bf16_f32 v120, v104, v105
  v_mfma_f32_16x16x32_bf16 v[180:183], v[168:171], v[224:227], v[180:183]
  v_cvt_pk_bf16_f32 v121, v106, v107
  v_cvt_pk_bf16_f32 v122, v108, v109
  v_mfma_f32_32x32x16_bf16 v[72:87], v[24:27], a[208:211], v[72:87]
  v_cvt_pk_bf16_f32 v123, v110, v111
  v_cvt_pk_bf16_f32 v124, v112, v113
  v_cvt_pk_bf16_f32 v125, v114, v115
  v_cvt_pk_bf16_f32 v126, v116, v117
  v_cvt_pk_bf16_f32 v127, v118, v119
  v_lshlrev_b32 v224, 16, v20
  v_mfma_f32_16x16x32_bf16 v[176:179], v[164:167], v[228:231], v[176:179]
  v_and_b32 v225, s56, v20
  v_lshlrev_b32 v226, 16, v21
  v_mfma_f32_16x16x32_bf16 v[180:183], v[172:175], v[228:231], v[180:183]
  v_and_b32 v227, s56, v21
  v_lshlrev_b32 v228, 16, v22
  v_mfma_f32_16x16x32_bf16 v[148:151], v[152:155], v[120:123], 0
  v_and_b32 v229, s56, v22
  v_lshlrev_b32 v230, 16, v23
  v_mfma_f32_32x32x16_bf16 v[88:103], v[12:15], a[228:231], v[88:103]
  v_and_b32 v231, s56, v23
  ds_read_b128 v[152:155], v4 offset:2048
  v_mul_f32 v208, v104, v104
  v_mul_f32 v209, v105, v105
  v_mul_f32 v210, v106, v106
  v_mul_f32 v211, v107, v107
  v_mfma_f32_32x32x16_bf16 v[72:87], v[28:31], a[212:215], v[72:87]
  v_fmac_f32 v208, v108, v108
  v_fmac_f32 v209, v109, v109
  v_fmac_f32 v210, v110, v110
  v_fmac_f32 v211, v111, v111
  v_fmac_f32 v208, v112, v112
  v_fmac_f32 v209, v113, v113
  v_mfma_f32_16x16x32_bf16 v[148:151], v[156:159], v[124:127], v[148:151]
  ds_read_b128 v[156:159], v4 offset:3072
  v_fmac_f32 v210, v114, v114
  v_mfma_f32_32x32x16_bf16 v[216:231], v[48:51], v[136:139], v[216:231]
  v_fmac_f32 v211, v115, v115
  v_fmac_f32 v208, v116, v116
  v_fmac_f32 v209, v117, v117
  v_fmac_f32 v210, v118, v118
  v_fmac_f32 v211, v119, v119
  v_lshlrev_b32 v104, 16, v24
  v_mfma_f32_32x32x16_bf16 v[88:103], v[16:19], a[232:235], v[88:103]
  v_and_b32 v105, s56, v24
  v_lshlrev_b32 v106, 16, v25
  v_and_b32 v107, s56, v25
  v_lshlrev_b32 v108, 16, v26
  v_and_b32 v109, s56, v26
  v_lshlrev_b32 v110, 16, v27
  v_mfma_f32_32x32x16_bf16 v[72:87], v[32:35], a[216:219], v[72:87]
  v_and_b32 v111, s56, v27
  v_lshlrev_b32 v112, 16, v28
  v_and_b32 v113, s56, v28
  v_lshlrev_b32 v114, 16, v29
  v_and_b32 v115, s56, v29
  v_lshlrev_b32 v116, 16, v30
  v_mfma_f32_32x32x16_bf16 v[216:231], v[52:55], v[140:143], v[216:231]
  v_and_b32 v117, s56, v30
  v_lshlrev_b32 v118, 16, v31
  v_and_b32 v119, s56, v31
  v_cvt_pk_bf16_f32 v238, v176, v177
  v_cvt_pk_bf16_f32 v239, v178, v179
  buffer_store_dwordx2 v[238:239], v5, s[12:15], s59 offen offset:128
  v_mfma_f32_32x32x16_bf16 v[88:103], v[20:23], a[236:239], v[88:103]
  v_cvt_pk_bf16_f32 v242, v180, v181
  v_cvt_pk_bf16_f32 v243, v182, v183
  buffer_store_dwordx2 v[242:243], v5, s[12:15], s59 offen offset:192
  s_nop 1
  v_cvt_pk_bf16_f32 v128, v216, v217
  v_mfma_f32_32x32x16_bf16 v[72:87], v[36:39], a[220:223], v[72:87]
  v_cvt_pk_bf16_f32 v129, v218, v219
  v_cvt_pk_bf16_f32 v130, v220, v221
  v_cvt_pk_bf16_f32 v131, v222, v223
  v_cvt_pk_bf16_f32 v132, v224, v225
  v_cvt_pk_bf16_f32 v133, v226, v227
  v_cvt_pk_bf16_f32 v134, v228, v229
  v_mfma_f32_32x32x16_bf16 v[88:103], v[24:27], a[240:243], v[88:103]
  v_cvt_pk_bf16_f32 v135, v230, v231
  v_fmac_f32 v208, v216, v216
  v_fmac_f32 v209, v217, v217
  v_fmac_f32 v210, v218, v218
  v_fmac_f32 v211, v219, v219
  v_cvt_pk_bf16_f32 v56, v72, v73
  s_waitcnt lgkmcnt(0)
  v_mfma_f32_16x16x32_bf16 v[148:151], v[152:155], v[128:131], v[148:151]
  v_cvt_pk_bf16_f32 v57, v74, v75
  v_cvt_pk_bf16_f32 v58, v76, v77
  v_mfma_f32_32x32x16_bf16 v[88:103], v[28:31], a[244:247], v[88:103]
  v_cvt_pk_bf16_f32 v59, v78, v79
  ds_read_b128 v[152:155], v4 offset:4096
  v_cvt_pk_bf16_f32 v60, v80, v81
  v_cvt_pk_bf16_f32 v61, v82, v83
  v_cvt_pk_bf16_f32 v62, v84, v85
  v_cvt_pk_bf16_f32 v63, v86, v87
  v_mfma_f32_16x16x32_bf16 v[148:151], v[156:159], v[132:135], v[148:151]
  ds_read_b128 v[156:159], v4 offset:5120
  v_fmac_f32 v208, v220, v220
  v_mfma_f32_32x32x16_bf16 v[104:119], v[56:59], v[136:139], v[104:119]
  v_fmac_f32 v209, v221, v221
  v_fmac_f32 v210, v222, v222
  v_fmac_f32 v211, v223, v223
  v_fmac_f32 v208, v224, v224
  v_fmac_f32 v209, v225, v225
  v_fmac_f32 v210, v226, v226
  v_mfma_f32_32x32x16_bf16 v[88:103], v[32:35], a[248:251], v[88:103]
  v_fmac_f32 v211, v227, v227
  v_fmac_f32 v208, v228, v228
  v_fmac_f32 v209, v229, v229
  v_fmac_f32 v210, v230, v230
  v_fmac_f32 v211, v231, v231
  v_lshlrev_b32 v216, 16, v32
  v_mfma_f32_32x32x16_bf16 v[104:119], v[60:63], v[140:143], v[104:119]
  v_and_b32 v217, s56, v32
  v_lshlrev_b32 v218, 16, v33
  v_and_b32 v219, s56, v33
  v_lshlrev_b32 v220, 16, v34
  v_and_b32 v221, s56, v34
  v_lshlrev_b32 v222, 16, v35
  v_mfma_f32_32x32x16_bf16 v[88:103], v[36:39], a[252:255], v[88:103]
  v_and_b32 v223, s56, v35
  v_lshlrev_b32 v224, 16, v36
  v_and_b32 v225, s56, v36
  v_lshlrev_b32 v226, 16, v37
  v_and_b32 v227, s56, v37
  v_cvt_pk_bf16_f32 v120, v104, v105
  v_cvt_pk_bf16_f32 v121, v106, v107
  v_cvt_pk_bf16_f32 v122, v108, v109
  v_cvt_pk_bf16_f32 v123, v110, v111
  v_cvt_pk_bf16_f32 v124, v112, v113
  v_cvt_pk_bf16_f32 v125, v114, v115
  s_waitcnt lgkmcnt(0)
  v_mfma_f32_16x16x32_bf16 v[148:151], v[152:155], v[120:123], v[148:151]
  v_cvt_pk_bf16_f32 v126, v116, v117
  v_cvt_pk_bf16_f32 v127, v118, v119
  v_cvt_pk_bf16_f32 v64, v88, v89
  v_cvt_pk_bf16_f32 v65, v90, v91
  v_mfma_f32_16x16x32_bf16 v[148:151], v[156:159], v[124:127], v[148:151]
  v_cvt_pk_bf16_f32 v66, v92, v93
  v_cvt_pk_bf16_f32 v67, v94, v95
  v_lshlrev_b32 v228, 16, v38
  v_and_b32 v229, s56, v38
  v_lshlrev_b32 v230, 16, v39
  v_and_b32 v231, s56, v39
  ds_read_b128 v[152:155], v4 offset:6144
  ds_read_b128 v[156:159], v4 offset:7168
  v_mfma_f32_32x32x16_bf16 v[216:231], v[64:67], v[136:139], v[216:231]
  v_cvt_pk_bf16_f32 v68, v96, v97
  v_cvt_pk_bf16_f32 v69, v98, v99
  v_cvt_pk_bf16_f32 v70, v100, v101
  v_cvt_pk_bf16_f32 v71, v102, v103
  v_fmac_f32 v208, v104, v104
  v_fmac_f32 v209, v105, v105
  v_mfma_f32_32x32x16_bf16 v[216:231], v[68:71], v[140:143], v[216:231]
  v_fmac_f32 v210, v106, v106
  v_fmac_f32 v211, v107, v107
  v_fmac_f32 v208, v108, v108
  v_fmac_f32 v209, v109, v109
  v_fmac_f32 v210, v110, v110
  v_fmac_f32 v211, v111, v111
  v_fmac_f32 v208, v112, v112
  v_fmac_f32 v209, v113, v113
  v_fmac_f32 v210, v114, v114
  v_fmac_f32 v211, v115, v115
  v_fmac_f32 v208, v116, v116
  v_fmac_f32 v209, v117, v117
  v_cvt_pk_bf16_f32 v128, v216, v217
  v_cvt_pk_bf16_f32 v129, v218, v219
  v_cvt_pk_bf16_f32 v130, v220, v221
  v_cvt_pk_bf16_f32 v131, v222, v223
  v_fmac_f32 v210, v118, v118
  v_fmac_f32 v211, v119, v119
  v_fmac_f32 v208, v216, v216
  v_fmac_f32 v209, v217, v217
  v_fmac_f32 v210, v218, v218
  s_waitcnt lgkmcnt(1)
  v_mfma_f32_16x16x32_bf16 v[148:151], v[152:155], v[128:131], v[148:151]
  v_fmac_f32 v211, v219, v219
  v_cvt_pk_bf16_f32 v132, v224, v225
  v_cvt_pk_bf16_f32 v133, v226, v227
  v_cvt_pk_bf16_f32 v134, v228, v229
  v_cvt_pk_bf16_f32 v135, v230, v231
  v_fmac_f32 v208, v220, v220
  v_fmac_f32 v209, v221, v221
  s_waitcnt lgkmcnt(0)
  v_mfma_f32_16x16x32_bf16 v[148:151], v[156:159], v[132:135], v[148:151]
  v_fmac_f32 v210, v222, v222
  v_fmac_f32 v211, v223, v223
  v_fmac_f32 v208, v224, v224
  v_fmac_f32 v209, v225, v225
  v_fmac_f32 v210, v226, v226
  v_fmac_f32 v211, v227, v227
  v_fmac_f32 v208, v228, v228
  v_fmac_f32 v209, v229, v229
  v_fmac_f32 v210, v230, v230
  v_fmac_f32 v211, v231, v231
  s_branch K4_ROUND
K4_LAST:
  v_add_f32 v232, v208, v209
  v_add_f32 v233, v210, v211
  v_add_f32 v232, v232, v233
  v_mov_b32 v233, v232
  v_add_f32 v234, v149, v150
  v_mov_b32 v237, v212
  v_permlane32_swap_b32 v232, v233
  v_add_f32 v232, v232, v233
  v_mul_f32 v233, s57, v148
  v_mul_f32 v232, s57, v232
  v_fma_f32 v232, -v233, v233, v232
  v_add_f32 v232, s58, v232
  v_rsq_f32 v232, v232
  v_mov_b32 v238, v213
  v_mul_f32 v232, v232, v234
  v_mov_b32 v239, v214
  v_mov_b32 v240, v215
  v_max_f32_dpp v233, v232, v232 quad_perm:[1,0,3,2] row_mask:0xf bank_mask:0xf
  ds_read_b64_tr_b16 v[160:161], v253 offset:0
  ds_read_b64_tr_b16 v[162:163], v253 offset:8
  v_max_f32_dpp v233, v233, v233 quad_perm:[2,3,0,1] row_mask:0xf bank_mask:0xf
  ds_read_b64_tr_b16 v[168:169], v253 offset:1024
  ds_read_b64_tr_b16 v[170:171], v253 offset:1032
  v_max_f32_dpp v233, v233, v233 row_half_mirror row_mask:0xf bank_mask:0xf
  v_sub_f32 v232, v232, v233
  v_exp_f32 v232, v232
  ds_read_b64_tr_b16 v[164:165], v253 offset:16
  ds_read_b64_tr_b16 v[166:167], v253 offset:24
  v_add_f32_dpp v234, v232, v232 quad_perm:[1,0,3,2] row_mask:0xf bank_mask:0xf
  ds_read_b64_tr_b16 v[172:173], v253 offset:1040
  ds_read_b64_tr_b16 v[174:175], v253 offset:1048
  v_add_f32_dpp v234, v234, v234 quad_perm:[2,3,0,1] row_mask:0xf bank_mask:0xf
  s_nop 1
  v_add_f32_dpp v234, v234, v234 row_half_mirror row_mask:0xf bank_mask:0xf
  v_rcp_f32 v234, v234
  s_nop 0
  v_mul_f32 v235, v232, v234
  v_mul_f32 v237, v237, v235
  v_mul_f32 v238, v238, v235
  v_mul_f32 v239, v239, v235
  v_mul_f32 v240, v240, v235
  v_add_f32_dpp v237, v237, v237 quad_perm:[1,0,3,2] row_mask:0xf bank_mask:0xf
  v_add_f32_dpp v238, v238, v238 quad_perm:[1,0,3,2] row_mask:0xf bank_mask:0xf
  v_add_f32_dpp v239, v239, v239 quad_perm:[1,0,3,2] row_mask:0xf bank_mask:0xf
  v_add_f32_dpp v240, v240, v240 quad_perm:[1,0,3,2] row_mask:0xf bank_mask:0xf
  v_add_f32_dpp v237, v237, v237 quad_perm:[2,3,0,1] row_mask:0xf bank_mask:0xf
  v_add_f32_dpp v238, v238, v238 quad_perm:[2,3,0,1] row_mask:0xf bank_mask:0xf
  v_add_f32_dpp v239, v239, v239 quad_perm:[2,3,0,1] row_mask:0xf bank_mask:0xf
  v_add_f32_dpp v240, v240, v240 quad_perm:[2,3,0,1] row_mask:0xf bank_mask:0xf
  v_add_f32_dpp v237, v237, v237 row_half_mirror row_mask:0xf bank_mask:0xf
  v_add_f32_dpp v238, v238, v238 row_half_mirror row_mask:0xf bank_mask:0xf
  v_add_f32_dpp v239, v239, v239 row_half_mirror row_mask:0xf bank_mask:0xf
  v_add_f32_dpp v240, v240, v240 row_half_mirror row_mask:0xf bank_mask:0xf
  v_mov_b32 v236, v235
  v_cvt_pk_bf16_f32 v245, v237, v238
  v_cvt_pk_bf16_f32 v246, v239, v240
  v_mov_b32_dpp v236, v235 row_shr:4 row_mask:0x3 bank_mask:0xa
  v_mov_b32 v249, v245
  v_mov_b32 v250, v246
  v_mov_b32_dpp v236, v235 row_shl:4 row_mask:0xc bank_mask:0x5
  v_permlane16_swap_b32 v245, v249
  v_permlane16_swap_b32 v246, v250
  v_mov_b32_dpp v241, v236 quad_perm:[0,0,0,0] row_mask:0xf bank_mask:0xf
  v_mov_b32_dpp v242, v236 quad_perm:[1,1,1,1] row_mask:0xf bank_mask:0xf
  v_mov_b32_dpp v243, v236 quad_perm:[2,2,2,2] row_mask:0xf bank_mask:0xf
  v_mov_b32_dpp v244, v236 quad_perm:[3,3,3,3] row_mask:0xf bank_mask:0xf
  v_cndmask_b32 v216, 0, v245, s[48:49]
  v_cndmask_b32 v217, 0, v246, s[48:49]
  v_cndmask_b32 v218, 0, v245, s[50:51]
  v_cndmask_b32 v219, 0, v246, s[50:51]
  v_cvt_pk_bf16_f32 v247, v241, v242
  v_cvt_pk_bf16_f32 v248, v243, v244
  v_mfma_f32_16x16x32_bf16 v[176:179], v[40:43], v[216:219], 0
  v_mov_b32 v251, v247
  v_mov_b32 v252, v248
  v_mfma_f32_16x16x32_bf16 v[180:183], v[48:51], v[216:219], 0
  v_cndmask_b32 v220, 0, v249, s[52:53]
  v_cndmask_b32 v221, 0, v250, s[52:53]
  v_cndmask_b32 v222, 0, v249, s[54:55]
  v_cndmask_b32 v223, 0, v250, s[54:55]
  v_permlane16_swap_b32 v247, v251
  v_permlane16_swap_b32 v248, v252
  v_mfma_f32_16x16x32_bf16 v[176:179], v[44:47], v[220:223], v[176:179]
  v_cndmask_b32 v224, 0, v247, s[48:49]
  v_cndmask_b32 v225, 0, v248, s[48:49]
  v_mfma_f32_16x16x32_bf16 v[180:183], v[52:55], v[220:223], v[180:183]
  v_cndmask_b32 v226, 0, v247, s[50:51]
  v_cndmask_b32 v227, 0, v248, s[50:51]
  v_cndmask_b32 v228, 0, v251, s[52:53]
  v_cndmask_b32 v229, 0, v252, s[52:53]
  s_waitcnt lgkmcnt(0)
  v_mfma_f32_16x16x32_bf16 v[176:179], v[160:163], v[224:227], v[176:179]
  v_cndmask_b32 v230, 0, v251, s[54:55]
  v_cndmask_b32 v231, 0, v252, s[54:55]
  v_mfma_f32_16x16x32_bf16 v[180:183], v[168:171], v[224:227], v[180:183]
  ds_read_b64_tr_b16 v[160:161], v253 offset:2048
  ds_read_b64_tr_b16 v[162:163], v253 offset:2056
  v_mfma_f32_16x16x32_bf16 v[176:179], v[164:167], v[228:231], v[176:179]
  ds_read_b64_tr_b16 v[168:169], v253 offset:3072
  ds_read_b64_tr_b16 v[170:171], v253 offset:3080
  v_mfma_f32_16x16x32_bf16 v[180:183], v[172:175], v[228:231], v[180:183]
  ds_read_b64_tr_b16 v[164:165], v253 offset:2064
  ds_read_b64_tr_b16 v[166:167], v253 offset:2072
  ds_read_b64_tr_b16 v[172:173], v253 offset:3088
  ds_read_b64_tr_b16 v[174:175], v253 offset:3096
  s_nop 0
  v_cvt_pk_bf16_f32 v238, v176, v177
  v_cvt_pk_bf16_f32 v239, v178, v179
  v_mfma_f32_16x16x32_bf16 v[176:179], v[56:59], v[216:219], 0
  v_cvt_pk_bf16_f32 v242, v180, v181
  v_cvt_pk_bf16_f32 v243, v182, v183
  v_mfma_f32_16x16x32_bf16 v[180:183], v[64:67], v[216:219], 0
  buffer_store_dwordx2 v[238:239], v5, s[12:15], s59 offen offset:0
  buffer_store_dwordx2 v[242:243], v5, s[12:15], s59 offen offset:64
  v_mfma_f32_16x16x32_bf16 v[176:179], v[60:63], v[220:223], v[176:179]
  v_mfma_f32_16x16x32_bf16 v[180:183], v[68:71], v[220:223], v[180:183]
  s_waitcnt lgkmcnt(6)
  v_mfma_f32_16x16x32_bf16 v[176:179], v[160:163], v[224:227], v[176:179]
  s_waitcnt lgkmcnt(4)
  v_mfma_f32_16x16x32_bf16 v[180:183], v[168:171], v[224:227], v[180:183]
  s_waitcnt lgkmcnt(2)
  v_mfma_f32_16x16x32_bf16 v[176:179], v[164:167], v[228:231], v[176:179]
  s_waitcnt lgkmcnt(0)
  v_mfma_f32_16x16x32_bf16 v[180:183], v[172:175], v[228:231], v[180:183]
  s_nop 5
  v_cvt_pk_bf16_f32 v238, v176, v177
  v_cvt_pk_bf16_f32 v239, v178, v179
  buffer_store_dwordx2 v[238:239], v5, s[12:15], s59 offen offset:128
  v_cvt_pk_bf16_f32 v242, v180, v181
  v_cvt_pk_bf16_f32 v243, v182, v183
  buffer_store_dwordx2 v[242:243], v5, s[12:15], s59 offen offset:192
K4_END:
  s_endpgm
.section .rodata,"a"
.p2align 6
.amdhsa_kernel final_kernel
  .amdhsa_next_free_vgpr 512
  .amdhsa_next_free_sgpr 100
  .amdhsa_accum_offset 256
  .amdhsa_group_segment_fixed_size 0
  .amdhsa_kernarg_size 96
  .amdhsa_user_sgpr_count 2
  .amdhsa_user_sgpr_kernarg_segment_ptr 1
  .amdhsa_system_sgpr_workgroup_id_x 1
  .amdhsa_float_denorm_mode_32 3
.end_amdhsa_kernel
```
